```python
import torch

def _softmax(x, axis=-1):
    return torch.softmax(x, dim=axis)

def _gelu(x):
    return torch.nn.functional.gelu(x, approximate='tanh')

def _silu(x):
    return torch.nn.functional.silu(x)

def _sigmoid(x):
    return torch.sigmoid(x)

def _layernorm(x, axis=-1, eps=1e-05):
    m = x.mean(dim=axis, keepdim=True)
    v = x.var(dim=axis, keepdim=True, unbiased=False)
    return (x - m) / torch.sqrt(v + eps)

def _scatter_add(tgt, idx, src, axis=0):
    return tgt.clone().index_add_(axis, idx, src)

def _segment_sum(src, seg, n):
    out = torch.zeros((n,) + src.shape[1:], dtype=src.dtype)
    return out.index_add_(0, seg, src)

def _pad(x, pw):
    flat = tuple((v for pair in reversed(pw) for v in pair))
    return torch.nn.functional.pad(x, flat)
kernel_name = 'gated_mix__softmax_full_mha__mixer_gmlp__prompt'

def setup_inputs():

    _w = lambda a: (lambda t: t.to(torch.bfloat16) if t.is_floating_point() else t)(torch.as_tensor(a))

    def _A_setup():
        B, S, D = (1, 2048, 512)
        return {'x': _w((lambda *s: torch.randn(*s, dtype=torch.bfloat16) * 0.05)(B, S, D)), 'wqkv': _w((lambda *s: torch.randn(*s, dtype=torch.bfloat16) * 1.6)(D, 3 * D)), 'wo': _w((lambda *s: torch.randn(*s, dtype=torch.bfloat16) * 0.1)(D, D))}
    _A_in = _A_setup()

    def _B_setup():
        B, S, D, F = (1, 2048, 512, 1792)
        Fh = F // 2
        return {'x': _w((lambda *s: torch.randn(*s, dtype=torch.bfloat16) * 0.05)(B, S, D)), 'w_in': _w((lambda *s: torch.randn(*s, dtype=torch.bfloat16) * 0.8)(D, 2 * Fh)), 'w_sp': _w(0.01 * (lambda *s: torch.randn(*s, dtype=torch.bfloat16) * 0.8)(S, S)), 'b_sp': _w(1.0 + 0.01 * (lambda *s: torch.randn(*s, dtype=torch.bfloat16) * 0.05)(S)), 'w_out': _w((lambda *s: torch.randn(*s, dtype=torch.bfloat16) * 0.05)(Fh, D))}
    _B_in = _B_setup()
    return {'A_x': _A_in['x'], 'A_wqkv': _A_in['wqkv'], 'A_wo': _A_in['wo'], 'B_x': _B_in['x'], 'B_w_in': _B_in['w_in'], 'B_w_sp': _B_in['w_sp'], 'B_b_sp': _B_in['b_sp'], 'B_w_out': _B_in['w_out'], 'gate_w': _w((lambda *s: torch.randn(*s, dtype=torch.bfloat16) * 0.05)(512) * 16.0)}

def reference(A_x, A_wqkv, A_wo, B_x, B_w_in, B_w_sp, B_b_sp, B_w_out, gate_w):

    def _A_ref(x, wqkv, wo):
        B, S, D = x.shape
        H = 32
        Dh = D // H
        qkv = (lambda x, *d: x.permute(*d))((x @ wqkv).reshape(B, S, 3, H, Dh), 2, 0, 3, 1, 4)
        q, k, v = (qkv[0], qkv[1], qkv[2])
        scale = Dh ** (-0.5)
        scores = torch.einsum('bhqd,bhkd->bhqk', q, k) * scale
        p = _softmax(scores, axis=-1)
        o = torch.einsum('bhqk,bhkd->bhqd', p, v)
        return (lambda x, *d: x.permute(*d))(o, 0, 2, 1, 3).reshape(B, S, D) @ wo

    def _B_ref(x, w_in, w_sp, b_sp, w_out):
        B, S, D = x.shape
        F = w_in.shape[-1]
        Fh = F // 2
        z = _gelu(torch.einsum('bsd,df->bsf', x, w_in))
        z1 = z[..., :Fh].clone()
        z2 = _layernorm(z[..., Fh:], axis=-1)
        g = torch.einsum('ts,bsf->btf', w_sp, z2) + b_sp[None, :, None]
        return torch.einsum('bsf,fd->bsd', z1 * g, w_out)
    x = A_x
    g = _sigmoid((x * gate_w).sum(-1, keepdims=True))
    a = _A_ref(x, A_wqkv, A_wo)
    b = _B_ref(x, B_w_in, B_w_sp, B_b_sp, B_w_out)
    return g * a + (1 - g) * b
```

```asm
; @launch grid=(256,1,1) block=(512,1,1) lds=163840
.amdgcn_target "amdgcn-amd-amdhsa--gfx950"
.text
.globl gated_mix__softmax_full_mha__mixer_gmlp__prompt_kernel
.p2align 8
.type gated_mix__softmax_full_mha__mixer_gmlp__prompt_kernel,@function
gated_mix__softmax_full_mha__mixer_gmlp__prompt_kernel:
    s_cmp_ge_u32 s2, 256
    s_cbranch_scc1 L_end
    s_load_dwordx16 s[4:19], s[0:1], 0
    s_load_dwordx8 s[20:27], s[0:1], 64
    v_cmp_gt_u32 vcc, 16, v0
    s_getpc_b64 s[48:49]
L_pc:
    s_and_saveexec_b64 s[60:61], vcc
    s_cbranch_execz L_nopc
    s_sub_u32 s48, s48, L_pc-gated_mix__softmax_full_mha__mixer_gmlp__prompt_kernel
    s_subb_u32 s49, s49, 0
    s_mov_b32 s50, L_end-gated_mix__softmax_full_mha__mixer_gmlp__prompt_kernel
    s_mov_b32 s51, 0x20000
    v_lshlrev_b32 v1, 12, v0
    s_lshr_b32 s59, s2, 3
    s_lshl_b32 s59, s59, 7
    buffer_load_dword v125, v1, s[48:51], s59 offen
L_nopc:
    s_mov_b64 exec, -1
    v_lshrrev_b32 v1, 6, v0
    s_and_b32 s52, s2, 7
    v_readfirstlane_b32 s56, v1
    s_lshr_b32 s53, s2, 3
    v_and_b32 v0, 63, v0
    s_and_b32 s57, s56, 3
    s_and_b32 s63, s53, 3
    s_lshr_b32 s54, s52, 1
    s_lshl_b32 s54, s54, 2
    s_add_u32 s54, s54, s63
    s_lshr_b32 s61, s53, 2
    s_and_b32 s59, s52, 1
    s_lshl_b32 s55, s59, 3
    s_add_u32 s55, s55, s61
    s_sub_u32 s62, s55, s59
    s_xor_b32 s63, s63, s61
    s_and_b32 s63, s63, 1
    s_lshl_b32 s63, s63, 2
    s_add_u32 s63, s63, s52
    s_and_b32 s63, s63, 7
    s_lshl_b32 s58, s54, 2
    s_add_u32 s58, s58, s57
    s_lshl_b32 s60, s57, 12
    s_mov_b32 s90, 23592960
    s_cmp_lt_u32 s56, 4
    s_cbranch_scc1 L_g1
    v_lshrrev_b32 v1, 4, v0
    v_and_b32 v5, 7, v0
    v_xor_b32 v5, v5, v1
    v_lshrrev_b32 v1, 3, v0
    v_lshlrev_b32 v1, 10, v1
    v_lshl_add_u32 v2, v5, 4, v1
    v_xor_b32 v3, 64, v2
    v_add_u32 v3, 7168, v3
    v_add_u32 v4, 14336, v2
    v_add_u32 v5, 14336, v3
    v_lshrrev_b32 v1, 2, v0
    v_mul_u32_u24 v10, 3072, v1
    v_and_b32 v1, 4, v1
    v_and_b32 v11, 7, v0
    v_xor_b32 v11, v11, v1
    v_lshlrev_b32 v11, 4, v11
    v_lshrrev_b32 v1, 3, v0
    v_mul_u32_u24 v6, 3072, v1
    v_mul_u32_u24 v12, 3584, v1
    v_add_u32 v6, v6, v11
    v_add_u32 v12, v12, v11
    v_add_u32 v7, 22528, v6
    v_add_u32 v8, 768, v12
    v_add_u32 v9, 27392, v12
    v_and_b32 v1, 3, v0
    v_lshl_add_u32 v10, v1, 4, v10
    s_lshl_b32 s64, s58, 15
    s_mul_i32 s65, s57, 49152
    s_lshl_b32 s59, s55, 6
    s_add_u32 s66, s65, s59
    s_add_u32 s66, s66, 2048
    s_and_b32 s59, s55, 1
    s_lshl_b32 s59, s59, 10
    s_add_u32 s65, s65, s59
    s_lshr_b32 s59, s55, 1
    s_lshl_b32 s59, s59, 7
    s_add_u32 s65, s65, s59
    s_mul_i32 s67, s57, 57344
    s_lshl_b32 s68, s62, 7
    s_add_u32 s67, s67, s68
    s_lshl_b32 s69, s57, 10
    s_waitcnt lgkmcnt(0)
    s_mov_b32 s36, s4
    s_mov_b32 s37, s5
    s_mov_b32 s38, 2097152
    s_mov_b32 s39, 0x20000
    s_mov_b32 s40, s6
    s_mov_b32 s41, s7
    s_mov_b32 s42, 1572864
    s_mov_b32 s43, 0x20000
    s_mov_b32 s44, s12
    s_mov_b32 s45, s13
    s_mov_b32 s46, 1835008
    s_mov_b32 s47, 0x20000
    s_cmp_eq_u32 s61, 7
    s_cbranch_scc1 L_light
    s_add_u32 s70, s63, 0
    s_and_b32 s70, s70, 7
    s_lshl_b32 s59, s70, 7
    s_add_u32 m0, s60, 37888
    s_add_u32 s59, s59, s64
    buffer_load_dwordx4 v2, s[36:39], s59 offen offset:0 lds
    buffer_load_dwordx4 v3, s[36:39], s59 offen offset:1024 lds
    buffer_load_dwordx4 v4, s[36:39], s59 offen offset:2048 lds
    buffer_load_dwordx4 v5, s[36:39], s59 offen offset:3072 lds
    s_mul_i32 s71, s70, 196608
    s_add_u32 m0, s69, 70656
    s_add_u32 s59, s71, s66
    buffer_load_dwordx4 v10, s[40:43], s59 offen lds
    s_add_u32 m0, s60, 54272
    s_add_u32 s59, s71, s65
    buffer_load_dwordx4 v6, s[40:43], s59 offen offset:0 lds
    buffer_load_dwordx4 v7, s[40:43], s59 offen offset:2048 lds
    s_mul_i32 s59, s70, 229376
    s_add_u32 s59, s59, s67
    buffer_load_dwordx4 v8, s[44:47], s59 offen offset:1024 lds
    buffer_load_dwordx4 v9, s[44:47], s59 offen offset:3072 lds
    s_mov_b32 s28, s26
    s_mov_b32 s29, s27
    s_mov_b32 s30, 29360128
    s_mov_b32 s31, 0x20000
    v_add_u32 v13, 27648, v12
    v_add_u32 v14, 55296, v12
    v_add_u32 v15, 82944, v12
    v_bfe_u32 v1, v0, 1, 3
    v_lshrrev_b32 v19, 5, v0
    v_xor_b32 v1, v1, v19
    v_lshlrev_b32 v1, 4, v1
    v_and_b32 v19, 31, v0
    v_lshl_add_u32 v1, v19, 7, v1
    v_add_u32 v16, s60, v1
    v_xor_b32 v17, 32, v16
    v_xor_b32 v18, 64, v16
    v_xor_b32 v19, 96, v16
    v_lshrrev_b32 v1, 5, v0
    v_lshlrev_b32 v20, 11, v1
    v_bfe_u32 v1, v0, 2, 2
    v_lshl_add_u32 v20, v1, 7, v20
    v_bfe_u32 v1, v0, 3, 1
    v_lshl_add_u32 v20, v1, 6, v20
    v_bfe_u32 v1, v0, 4, 1
    v_lshl_add_u32 v20, v1, 5, v20
    v_and_b32 v1, 3, v0
    v_lshl_add_u32 v20, v1, 3, v20
    v_add_u32 v20, 17408, v20
    v_xor_b32 v21, 64, v20
    s_add_u32 s70, s63, 1
    s_and_b32 s70, s70, 7
    s_lshl_b32 s59, s70, 7
    s_add_u32 m0, s60, 74752
    s_add_u32 s59, s59, s64
    buffer_load_dwordx4 v2, s[36:39], s59 offen offset:0 lds
    buffer_load_dwordx4 v3, s[36:39], s59 offen offset:1024 lds
    buffer_load_dwordx4 v4, s[36:39], s59 offen offset:2048 lds
    buffer_load_dwordx4 v5, s[36:39], s59 offen offset:3072 lds
    s_mul_i32 s71, s70, 196608
    s_add_u32 m0, s69, 107520
    s_add_u32 s59, s71, s66
    buffer_load_dwordx4 v10, s[40:43], s59 offen lds
    s_waitcnt vmcnt(5)
    s_barrier
    ds_read_b128 v[128:131], v16 offset:37888
    ds_read_b64_tr_b16 v[32:33], v20 offset:37888
    ds_read_b64_tr_b16 v[34:35], v20 offset:38400
    ds_read_b64_tr_b16 v[36:37], v21 offset:37888
    ds_read_b64_tr_b16 v[38:39], v21 offset:38400
    s_add_u32 m0, s60, 91136
    s_add_u32 s59, s71, s65
    buffer_load_dwordx4 v6, s[40:43], s59 offen offset:0 lds
    buffer_load_dwordx4 v7, s[40:43], s59 offen offset:2048 lds
    s_mul_i32 s59, s70, 229376
    s_add_u32 s59, s59, s67
    buffer_load_dwordx4 v8, s[44:47], s59 offen offset:1024 lds
    buffer_load_dwordx4 v9, s[44:47], s59 offen offset:3072 lds
    s_waitcnt lgkmcnt(2)
    v_mfma_f32_32x32x16_bf16 v[64:79], v[32:35], v[128:131], 0
    ds_read_b128 v[132:135], v17 offset:37888
    ds_read_b64_tr_b16 v[40:41], v20 offset:41984
    ds_read_b64_tr_b16 v[42:43], v20 offset:42496
    s_waitcnt lgkmcnt(3)
    v_mfma_f32_32x32x16_bf16 v[80:95], v[36:39], v[128:131], 0
    ds_read_b64_tr_b16 v[44:45], v21 offset:41984
    ds_read_b64_tr_b16 v[46:47], v21 offset:42496
    s_add_u32 s70, s63, 2
    s_and_b32 s70, s70, 7
    s_lshl_b32 s59, s70, 7
    s_add_u32 m0, s60, 111616
    s_add_u32 s59, s59, s64
    buffer_load_dwordx4 v2, s[36:39], s59 offen offset:0 lds
    buffer_load_dwordx4 v3, s[36:39], s59 offen offset:1024 lds
    buffer_load_dwordx4 v4, s[36:39], s59 offen offset:2048 lds
    buffer_load_dwordx4 v5, s[36:39], s59 offen offset:3072 lds
    s_mul_i32 s71, s70, 196608
    s_add_u32 m0, s69, 144384
    s_add_u32 s59, s71, s66
    buffer_load_dwordx4 v10, s[40:43], s59 offen lds
    s_lshr_b32 s76, s52, 1
    s_lshl_b32 s76, s76, 3
    s_and_b32 s88, s53, 7
    s_add_u32 s76, s76, s88
    s_and_b32 s77, s52, 1
    s_lshl_b32 s77, s77, 2
    s_lshr_b32 s88, s53, 3
    s_add_u32 s77, s77, s88
    s_waitcnt lgkmcnt(2)
    v_mfma_f32_32x32x16_bf16 v[64:79], v[40:43], v[132:135], v[64:79]
    ds_read_b128 v[136:139], v18 offset:37888
    ds_read_b64_tr_b16 v[32:33], v20 offset:46080
    ds_read_b64_tr_b16 v[34:35], v20 offset:46592
    s_waitcnt lgkmcnt(3)
    v_mfma_f32_32x32x16_bf16 v[80:95], v[44:47], v[132:135], v[80:95]
    ds_read_b64_tr_b16 v[36:37], v21 offset:46080
    ds_read_b64_tr_b16 v[38:39], v21 offset:46592
    s_add_u32 m0, s60, 128000
    s_add_u32 s59, s71, s65
    buffer_load_dwordx4 v6, s[40:43], s59 offen offset:0 lds
    buffer_load_dwordx4 v7, s[40:43], s59 offen offset:2048 lds
    s_lshl_b32 s93, s88, 1
    s_mov_b32 s93, 0
    s_and_b32 s88, s77, 1
    s_lshl_b32 s74, s76, 1
    s_add_u32 s74, s74, s88
    s_xor_b32 s75, s74, 1
    s_lshl_b32 s88, s57, 10
    s_lshl_b32 s74, s74, 17
    s_waitcnt lgkmcnt(2)
    v_mfma_f32_32x32x16_bf16 v[64:79], v[32:35], v[136:139], v[64:79]
    ds_read_b128 v[140:143], v19 offset:37888
    ds_read_b64_tr_b16 v[40:41], v20 offset:50176
    ds_read_b64_tr_b16 v[42:43], v20 offset:50688
    s_waitcnt lgkmcnt(3)
    v_mfma_f32_32x32x16_bf16 v[80:95], v[36:39], v[136:139], v[80:95]
    ds_read_b64_tr_b16 v[44:45], v21 offset:50176
    ds_read_b64_tr_b16 v[46:47], v21 offset:50688
    s_mul_i32 s59, s70, 229376
    s_add_u32 s59, s59, s67
    buffer_load_dwordx4 v8, s[44:47], s59 offen offset:1024 lds
    buffer_load_dwordx4 v9, s[44:47], s59 offen offset:3072 lds
    s_add_u32 s74, s74, s88
    s_lshl_b32 s75, s75, 17
    s_add_u32 s75, s75, s88
    s_lshl_b32 s72, s57, 13
    s_add_u32 s72, s72, 0x20000
    s_add_u32 s73, s72, 4096
    s_mov_b32 s32, s14
    s_mov_b32 s33, s15
    s_waitcnt lgkmcnt(2)
    v_mfma_f32_32x32x16_bf16 v[64:79], v[40:43], v[140:143], v[64:79]
    s_waitcnt vmcnt(9)
    s_barrier
    v_add_u32 v16, 74752, v16
    v_add_u32 v17, 74752, v17
    v_add_u32 v18, 74752, v18
    v_add_u32 v19, 74752, v19
    v_add_u32 v20, 74752, v20
    v_add_u32 v21, 74752, v21
    ds_read_b128 v[144:147], v16 offset:0
    ds_read_b64_tr_b16 v[32:33], v20 offset:0
    ds_read_b64_tr_b16 v[34:35], v20 offset:512
    s_waitcnt lgkmcnt(3)
    v_mfma_f32_32x32x16_bf16 v[80:95], v[44:47], v[140:143], v[80:95]
    ds_read_b64_tr_b16 v[36:37], v21 offset:0
    ds_read_b64_tr_b16 v[38:39], v21 offset:512
    s_add_u32 s70, s63, 3
    s_and_b32 s70, s70, 7
    s_lshl_b32 s59, s70, 7
    s_add_u32 m0, s60, 1024
    s_add_u32 s59, s59, s64
    buffer_load_dwordx4 v2, s[36:39], s59 offen offset:0 lds
    buffer_load_dwordx4 v3, s[36:39], s59 offen offset:1024 lds
    s_mov_b32 s34, 8388608
    s_mov_b32 s35, 0x20000
    v_lshrrev_b32 v1, 4, v0
    v_and_b32 v111, 7, v0
    v_xor_b32 v111, v111, v1
    v_lshrrev_b32 v1, 3, v0
    v_lshlrev_b32 v1, 12, v1
    v_lshl_add_u32 v108, v111, 4, v1
    s_waitcnt lgkmcnt(2)
    v_mfma_f32_32x32x16_bf16 v[64:79], v[32:35], v[144:147], v[64:79]
    ds_read_b128 v[148:151], v17 offset:0
    ds_read_b64_tr_b16 v[40:41], v20 offset:4096
    ds_read_b64_tr_b16 v[42:43], v20 offset:4608
    s_waitcnt lgkmcnt(3)
    v_mfma_f32_32x32x16_bf16 v[80:95], v[36:39], v[144:147], v[80:95]
    ds_read_b64_tr_b16 v[44:45], v21 offset:4096
    ds_read_b64_tr_b16 v[46:47], v21 offset:4608
    buffer_load_dwordx4 v4, s[36:39], s59 offen offset:2048 lds
    buffer_load_dwordx4 v5, s[36:39], s59 offen offset:3072 lds
    s_mul_i32 s71, s70, 196608
    s_add_u32 m0, s69, 33792
    s_add_u32 s59, s71, s66
    buffer_load_dwordx4 v10, s[40:43], s59 offen lds
    v_xor_b32 v109, 64, v108
    v_add_u32 v109, 31744, v109
    v_add_u32 v110, 63488, v108
    v_add_u32 v111, 63488, v109
    s_mov_b32 s0, 1.0
    s_mov_b32 s1, 1.0
    v_mov_b32 v24, 0xc0135761
    v_mov_b32 v26, 0xbdd2d3e8
    s_waitcnt lgkmcnt(2)
    v_mfma_f32_32x32x16_bf16 v[64:79], v[40:43], v[148:151], v[64:79]
    ds_read_b128 v[152:155], v18 offset:0
    ds_read_b64_tr_b16 v[32:33], v20 offset:8192
    ds_read_b64_tr_b16 v[34:35], v20 offset:8704
    s_waitcnt lgkmcnt(3)
    v_mfma_f32_32x32x16_bf16 v[80:95], v[44:47], v[148:151], v[80:95]
    ds_read_b64_tr_b16 v[36:37], v21 offset:8192
    ds_read_b64_tr_b16 v[38:39], v21 offset:8704
    s_add_u32 m0, s60, 17408
    s_add_u32 s59, s71, s65
    buffer_load_dwordx4 v6, s[40:43], s59 offen offset:0 lds
    buffer_load_dwordx4 v7, s[40:43], s59 offen offset:2048 lds
    v_mov_b32 v25, 0xc0135761
    v_mov_b32 v27, 0xbdd2d3e8
    v_mov_b32 v116, 0
    v_mov_b32 v117, 0
    v_mov_b32 v118, 0
    v_mov_b32 v119, 0
    v_lshlrev_b32 v96, 4, v0
    v_and_b32 v1, 31, v0
    s_waitcnt lgkmcnt(2)
    v_mfma_f32_32x32x16_bf16 v[64:79], v[32:35], v[152:155], v[64:79]
    ds_read_b128 v[156:159], v19 offset:0
    ds_read_b64_tr_b16 v[40:41], v20 offset:12288
    ds_read_b64_tr_b16 v[42:43], v20 offset:12800
    s_waitcnt lgkmcnt(3)
    v_mfma_f32_32x32x16_bf16 v[80:95], v[36:39], v[152:155], v[80:95]
    ds_read_b64_tr_b16 v[44:45], v21 offset:12288
    ds_read_b64_tr_b16 v[46:47], v21 offset:12800
    s_mul_i32 s59, s70, 229376
    s_add_u32 s59, s59, s67
    buffer_load_dwordx4 v8, s[44:47], s59 offen offset:1024 lds
    buffer_load_dwordx4 v9, s[44:47], s59 offen offset:3072 lds
    v_lshlrev_b32 v97, 3, v1
    v_lshrrev_b32 v98, 5, v0
    v_mul_u32_u24 v98, 7168, v98
    v_add_u32 v98, v98, v97
    v_bfe_u32 v1, v0, 1, 3
    v_lshrrev_b32 v99, 5, v0
    v_xor_b32 v1, v1, v99
    v_and_b32 v99, 31, v0
    s_waitcnt lgkmcnt(2)
    v_mfma_f32_32x32x16_bf16 v[64:79], v[40:43], v[156:159], v[64:79]
    s_waitcnt vmcnt(9)
    s_barrier
    ds_read_b128 v[160:163], v16 offset:36864
    ds_read_b64_tr_b16 v[32:33], v20 offset:36864
    ds_read_b64_tr_b16 v[34:35], v20 offset:37376
    s_waitcnt lgkmcnt(3)
    v_mfma_f32_32x32x16_bf16 v[80:95], v[44:47], v[156:159], v[80:95]
    ds_read_b64_tr_b16 v[36:37], v21 offset:36864
    ds_read_b64_tr_b16 v[38:39], v21 offset:37376
    s_add_u32 s70, s63, 4
    s_and_b32 s70, s70, 7
    s_lshl_b32 s59, s70, 7
    s_add_u32 m0, s60, 37888
    s_add_u32 s59, s59, s64
    buffer_load_dwordx4 v2, s[36:39], s59 offen offset:0 lds
    buffer_load_dwordx4 v3, s[36:39], s59 offen offset:1024 lds
    v_lshlrev_b32 v99, 6, v99
    v_lshl_add_u32 v99, v1, 3, v99
    s_add_u32 s88, s60, 114688
    v_add_u32 v99, s88, v99
    v_xor_b32 v100, 16, v99
    v_xor_b32 v101, 32, v99
    v_xor_b32 v102, 48, v99
    v_lshrrev_b32 v1, 5, v0
    s_waitcnt lgkmcnt(2)
    v_mfma_f32_32x32x16_bf16 v[64:79], v[32:35], v[160:163], v[64:79]
    ds_read_b128 v[164:167], v17 offset:36864
    ds_read_b64_tr_b16 v[40:41], v20 offset:40960
    ds_read_b64_tr_b16 v[42:43], v20 offset:41472
    s_waitcnt lgkmcnt(3)
    v_mfma_f32_32x32x16_bf16 v[80:95], v[36:39], v[160:163], v[80:95]
    ds_read_b64_tr_b16 v[44:45], v21 offset:40960
    ds_read_b64_tr_b16 v[46:47], v21 offset:41472
    buffer_load_dwordx4 v4, s[36:39], s59 offen offset:2048 lds
    buffer_load_dwordx4 v5, s[36:39], s59 offen offset:3072 lds
    s_mul_i32 s71, s70, 196608
    s_add_u32 m0, s69, 70656
    s_add_u32 s59, s71, s66
    buffer_load_dwordx4 v10, s[40:43], s59 offen lds
    v_lshlrev_b32 v103, 9, v1
    v_bfe_u32 v1, v0, 2, 2
    v_lshl_add_u32 v103, v1, 6, v103
    v_bfe_u32 v1, v0, 4, 1
    v_lshl_add_u32 v103, v1, 5, v103
    v_and_b32 v1, 3, v0
    v_lshl_add_u32 v103, v1, 3, v103
    v_bfe_u32 v1, v0, 3, 1
    s_waitcnt lgkmcnt(2)
    v_mfma_f32_32x32x16_bf16 v[64:79], v[40:43], v[164:167], v[64:79]
    ds_read_b128 v[168:171], v18 offset:36864
    ds_read_b64_tr_b16 v[32:33], v20 offset:45056
    ds_read_b64_tr_b16 v[34:35], v20 offset:45568
    s_waitcnt lgkmcnt(3)
    v_mfma_f32_32x32x16_bf16 v[80:95], v[44:47], v[164:167], v[80:95]
    ds_read_b64_tr_b16 v[36:37], v21 offset:45056
    ds_read_b64_tr_b16 v[38:39], v21 offset:45568
    s_add_u32 m0, s60, 54272
    s_add_u32 s59, s71, s65
    buffer_load_dwordx4 v6, s[40:43], s59 offen offset:0 lds
    buffer_load_dwordx4 v7, s[40:43], s59 offen offset:2048 lds
    v_lshrrev_b32 v104, 5, v0
    v_lshl_or_b32 v1, v104, 2, v1
    v_lshlrev_b32 v1, 3, v1
    v_xor_b32 v103, v103, v1
    v_add_u32 v103, s88, v103
    v_xor_b32 v104, 16, v103
    v_mul_u32_u24 v105, 256, v0
    v_mov_b32 v106, 1
    s_waitcnt lgkmcnt(2)
    v_mfma_f32_32x32x16_bf16 v[64:79], v[32:35], v[168:171], v[64:79]
    ds_read_b128 v[172:175], v19 offset:36864
    ds_read_b64_tr_b16 v[40:41], v20 offset:49152
    ds_read_b64_tr_b16 v[42:43], v20 offset:49664
    s_waitcnt lgkmcnt(3)
    v_mfma_f32_32x32x16_bf16 v[80:95], v[36:39], v[168:171], v[80:95]
    ds_read_b64_tr_b16 v[44:45], v21 offset:49152
    ds_read_b64_tr_b16 v[46:47], v21 offset:49664
    s_mul_i32 s59, s70, 229376
    s_add_u32 s59, s59, s67
    buffer_load_dwordx4 v8, s[44:47], s59 offen offset:1024 lds
    buffer_load_dwordx4 v9, s[44:47], s59 offen offset:3072 lds
    v_and_b32 v113, 15, v0
    v_lshlrev_b32 v113, 2, v113
    s_mul_i32 s88, s58, 512
    s_add_u32 s88, s88, 65536
    s_and_b32 s3, s62, 1
    v_xor_b32 v107, s3, v0
    v_mul_u32_u24 v107, 256, v107
    v_add_u32 v107, s88, v107
    s_waitcnt lgkmcnt(2)
    v_mfma_f32_32x32x16_bf16 v[64:79], v[40:43], v[172:175], v[64:79]
    s_waitcnt vmcnt(9)
    s_barrier
    v_add_u32 v16, 4294893568, v16
    v_add_u32 v17, 4294893568, v17
    v_add_u32 v18, 4294893568, v18
    v_add_u32 v19, 4294893568, v19
    v_add_u32 v20, 4294893568, v20
    v_add_u32 v21, 4294893568, v21
    ds_read_b128 v[176:179], v16 offset:0
    ds_read_b64_tr_b16 v[32:33], v20 offset:0
    ds_read_b64_tr_b16 v[34:35], v20 offset:512
    s_waitcnt lgkmcnt(3)
    v_mfma_f32_32x32x16_bf16 v[80:95], v[44:47], v[172:175], v[80:95]
    ds_read_b64_tr_b16 v[36:37], v21 offset:0
    ds_read_b64_tr_b16 v[38:39], v21 offset:512
    s_add_u32 s70, s63, 5
    s_and_b32 s70, s70, 7
    s_lshl_b32 s59, s70, 7
    s_add_u32 m0, s60, 74752
    s_add_u32 s59, s59, s64
    buffer_load_dwordx4 v2, s[36:39], s59 offen offset:0 lds
    buffer_load_dwordx4 v3, s[36:39], s59 offen offset:1024 lds
    s_mul_i32 s79, s54, 14336
    s_lshl_b32 s88, s57, 8
    s_add_u32 s79, s79, s88
    s_add_u32 s79, s79, 23134208
    s_add_u32 s80, s79, 4096
    s_lshl_b32 s88, s62, 10
    s_add_u32 s81, s79, s88
    s_lshl_b32 s82, s62, 18
    s_waitcnt lgkmcnt(2)
    v_mfma_f32_32x32x16_bf16 v[64:79], v[32:35], v[176:179], v[64:79]
    ds_read_b128 v[180:183], v17 offset:0
    ds_read_b64_tr_b16 v[40:41], v20 offset:4096
    ds_read_b64_tr_b16 v[42:43], v20 offset:4608
    s_waitcnt lgkmcnt(3)
    v_mfma_f32_32x32x16_bf16 v[80:95], v[36:39], v[176:179], v[80:95]
    ds_read_b64_tr_b16 v[44:45], v21 offset:4096
    ds_read_b64_tr_b16 v[46:47], v21 offset:4608
    buffer_load_dwordx4 v4, s[36:39], s59 offen offset:2048 lds
    buffer_load_dwordx4 v5, s[36:39], s59 offen offset:3072 lds
    s_mul_i32 s71, s70, 196608
    s_add_u32 m0, s69, 107520
    s_add_u32 s59, s71, s66
    buffer_load_dwordx4 v10, s[40:43], s59 offen lds
    s_lshl_b32 s88, s58, 11
    s_add_u32 s82, s82, s88
    s_add_u32 s82, s82, 10485760
    s_add_u32 s83, s82, 131072
    s_lshl_b32 s78, s62, 2
    s_lshr_b32 s88, s54, 2
    s_add_u32 s78, s78, s88
    s_lshl_b32 s78, s78, 3
    s_waitcnt lgkmcnt(2)
    v_mfma_f32_32x32x16_bf16 v[64:79], v[40:43], v[180:183], v[64:79]
    ds_read_b128 v[184:187], v18 offset:0
    ds_read_b64_tr_b16 v[32:33], v20 offset:8192
    ds_read_b64_tr_b16 v[34:35], v20 offset:8704
    s_waitcnt lgkmcnt(3)
    v_mfma_f32_32x32x16_bf16 v[80:95], v[44:47], v[180:183], v[80:95]
    ds_read_b64_tr_b16 v[36:37], v21 offset:8192
    ds_read_b64_tr_b16 v[38:39], v21 offset:8704
    s_add_u32 m0, s60, 91136
    s_add_u32 s59, s71, s65
    buffer_load_dwordx4 v6, s[40:43], s59 offen offset:0 lds
    buffer_load_dwordx4 v7, s[40:43], s59 offen offset:2048 lds
    s_add_u32 s78, s78, 384
    s_mul_i32 s84, s58, 28
    s_lshl_b32 s88, s62, 1
    s_add_u32 s84, s84, s88
    s_lshl_b32 s84, s84, 11
    s_add_u32 s84, s84, 6291456
    s_lshl_b32 s85, s62, 4
    s_add_u32 s85, s85, s54
    s_waitcnt lgkmcnt(2)
    v_mfma_f32_32x32x16_bf16 v[64:79], v[32:35], v[184:187], v[64:79]
    ds_read_b128 v[188:191], v19 offset:0
    ds_read_b64_tr_b16 v[40:41], v20 offset:12288
    ds_read_b64_tr_b16 v[42:43], v20 offset:12800
    s_waitcnt lgkmcnt(3)
    v_mfma_f32_32x32x16_bf16 v[80:95], v[36:39], v[184:187], v[80:95]
    ds_read_b64_tr_b16 v[44:45], v21 offset:12288
    ds_read_b64_tr_b16 v[46:47], v21 offset:12800
    s_mul_i32 s59, s70, 229376
    s_add_u32 s59, s59, s67
    buffer_load_dwordx4 v8, s[44:47], s59 offen offset:1024 lds
    buffer_load_dwordx4 v9, s[44:47], s59 offen offset:3072 lds
    s_add_u32 s85, s85, 1024
    v_lshrrev_b32 v1, 5, v0
    v_lshlrev_b32 v30, 10, v1
    v_bfe_u32 v1, v0, 2, 2
    v_lshl_add_u32 v30, v1, 7, v30
    v_bfe_u32 v1, v0, 3, 1
    v_lshl_add_u32 v30, v1, 6, v30
    v_bfe_u32 v1, v0, 4, 1
    s_waitcnt lgkmcnt(2)
    v_mfma_f32_32x32x16_bf16 v[64:79], v[40:43], v[188:191], v[64:79]
    s_waitcnt vmcnt(9)
    s_barrier
    ds_read_b128 v[192:195], v16 offset:36864
    ds_read_b64_tr_b16 v[32:33], v20 offset:36864
    ds_read_b64_tr_b16 v[34:35], v20 offset:37376
    s_waitcnt lgkmcnt(3)
    v_mfma_f32_32x32x16_bf16 v[80:95], v[44:47], v[188:191], v[80:95]
    ds_read_b64_tr_b16 v[36:37], v21 offset:36864
    ds_read_b64_tr_b16 v[38:39], v21 offset:37376
    s_add_u32 s70, s63, 6
    s_and_b32 s70, s70, 7
    s_lshl_b32 s59, s70, 7
    s_add_u32 m0, s60, 111616
    s_add_u32 s59, s59, s64
    buffer_load_dwordx4 v2, s[36:39], s59 offen offset:0 lds
    buffer_load_dwordx4 v3, s[36:39], s59 offen offset:1024 lds
    v_lshl_add_u32 v30, v1, 5, v30
    v_and_b32 v1, 3, v0
    v_lshl_add_u32 v30, v1, 3, v30
    v_add_u32 v30, 37888, v30
    v_xor_b32 v11, 64, v30
    s_lshl_b32 s88, s57, 2
    v_mov_b32 v22, s88
    v_mov_b32 v23, 0
    s_waitcnt lgkmcnt(2)
    v_mfma_f32_32x32x16_bf16 v[64:79], v[32:35], v[192:195], v[64:79]
    ds_read_b128 v[196:199], v17 offset:36864
    ds_read_b64_tr_b16 v[40:41], v20 offset:40960
    ds_read_b64_tr_b16 v[42:43], v20 offset:41472
    s_waitcnt lgkmcnt(3)
    v_mfma_f32_32x32x16_bf16 v[80:95], v[36:39], v[192:195], v[80:95]
    ds_read_b64_tr_b16 v[44:45], v21 offset:40960
    ds_read_b64_tr_b16 v[46:47], v21 offset:41472
    buffer_load_dwordx4 v4, s[36:39], s59 offen offset:2048 lds
    buffer_load_dwordx4 v5, s[36:39], s59 offen offset:3072 lds
    s_mul_i32 s71, s70, 196608
    s_add_u32 m0, s69, 144384
    s_add_u32 s59, s71, s66
    buffer_load_dwordx4 v10, s[40:43], s59 offen lds
    s_waitcnt lgkmcnt(2)
    v_mfma_f32_32x32x16_bf16 v[64:79], v[40:43], v[196:199], v[64:79]
    ds_read_b128 v[200:203], v18 offset:36864
    ds_read_b64_tr_b16 v[32:33], v20 offset:45056
    ds_read_b64_tr_b16 v[34:35], v20 offset:45568
    s_waitcnt lgkmcnt(3)
    v_mfma_f32_32x32x16_bf16 v[80:95], v[44:47], v[196:199], v[80:95]
    ds_read_b64_tr_b16 v[36:37], v21 offset:45056
    ds_read_b64_tr_b16 v[38:39], v21 offset:45568
    s_add_u32 m0, s60, 128000
    s_add_u32 s59, s71, s65
    buffer_load_dwordx4 v6, s[40:43], s59 offen offset:0 lds
    buffer_load_dwordx4 v7, s[40:43], s59 offen offset:2048 lds
    s_waitcnt lgkmcnt(2)
    v_mfma_f32_32x32x16_bf16 v[64:79], v[32:35], v[200:203], v[64:79]
    ds_read_b128 v[204:207], v19 offset:36864
    ds_read_b64_tr_b16 v[40:41], v20 offset:49152
    ds_read_b64_tr_b16 v[42:43], v20 offset:49664
    s_waitcnt lgkmcnt(3)
    v_mfma_f32_32x32x16_bf16 v[80:95], v[36:39], v[200:203], v[80:95]
    ds_read_b64_tr_b16 v[44:45], v21 offset:49152
    ds_read_b64_tr_b16 v[46:47], v21 offset:49664
    s_mul_i32 s59, s70, 229376
    s_add_u32 s59, s59, s67
    buffer_load_dwordx4 v8, s[44:47], s59 offen offset:1024 lds
    buffer_load_dwordx4 v9, s[44:47], s59 offen offset:3072 lds
    s_waitcnt lgkmcnt(2)
    v_mfma_f32_32x32x16_bf16 v[64:79], v[40:43], v[204:207], v[64:79]
    s_waitcnt vmcnt(9)
    s_barrier
    v_add_u32 v16, 73728, v16
    v_add_u32 v17, 73728, v17
    v_add_u32 v18, 73728, v18
    v_add_u32 v19, 73728, v19
    v_add_u32 v20, 73728, v20
    v_add_u32 v21, 73728, v21
    ds_read_b128 v[208:211], v16 offset:0
    ds_read_b64_tr_b16 v[32:33], v20 offset:0
    ds_read_b64_tr_b16 v[34:35], v20 offset:512
    s_waitcnt lgkmcnt(3)
    v_mfma_f32_32x32x16_bf16 v[80:95], v[44:47], v[204:207], v[80:95]
    ds_read_b64_tr_b16 v[36:37], v21 offset:0
    ds_read_b64_tr_b16 v[38:39], v21 offset:512
    s_add_u32 s70, s63, 7
    s_and_b32 s70, s70, 7
    s_lshl_b32 s59, s70, 7
    s_add_u32 m0, s60, 1024
    s_add_u32 s59, s59, s64
    buffer_load_dwordx4 v2, s[36:39], s59 offen offset:0 lds
    buffer_load_dwordx4 v3, s[36:39], s59 offen offset:1024 lds
    s_waitcnt lgkmcnt(2)
    v_mfma_f32_32x32x16_bf16 v[64:79], v[32:35], v[208:211], v[64:79]
    ds_read_b128 v[212:215], v17 offset:0
    ds_read_b64_tr_b16 v[40:41], v20 offset:4096
    ds_read_b64_tr_b16 v[42:43], v20 offset:4608
    s_waitcnt lgkmcnt(3)
    v_mfma_f32_32x32x16_bf16 v[80:95], v[36:39], v[208:211], v[80:95]
    ds_read_b64_tr_b16 v[44:45], v21 offset:4096
    ds_read_b64_tr_b16 v[46:47], v21 offset:4608
    buffer_load_dwordx4 v4, s[36:39], s59 offen offset:2048 lds
    buffer_load_dwordx4 v5, s[36:39], s59 offen offset:3072 lds
    s_mul_i32 s71, s70, 196608
    s_add_u32 m0, s69, 33792
    s_add_u32 s59, s71, s66
    buffer_load_dwordx4 v10, s[40:43], s59 offen lds
    s_waitcnt lgkmcnt(2)
    v_mfma_f32_32x32x16_bf16 v[64:79], v[40:43], v[212:215], v[64:79]
    ds_read_b128 v[216:219], v18 offset:0
    ds_read_b64_tr_b16 v[32:33], v20 offset:8192
    ds_read_b64_tr_b16 v[34:35], v20 offset:8704
    s_waitcnt lgkmcnt(3)
    v_mfma_f32_32x32x16_bf16 v[80:95], v[44:47], v[212:215], v[80:95]
    ds_read_b64_tr_b16 v[36:37], v21 offset:8192
    ds_read_b64_tr_b16 v[38:39], v21 offset:8704
    s_add_u32 m0, s60, 17408
    s_add_u32 s59, s71, s65
    buffer_load_dwordx4 v6, s[40:43], s59 offen offset:0 lds
    buffer_load_dwordx4 v7, s[40:43], s59 offen offset:2048 lds
    s_waitcnt lgkmcnt(2)
    v_mfma_f32_32x32x16_bf16 v[64:79], v[32:35], v[216:219], v[64:79]
    ds_read_b128 v[220:223], v19 offset:0
    ds_read_b64_tr_b16 v[40:41], v20 offset:12288
    ds_read_b64_tr_b16 v[42:43], v20 offset:12800
    s_waitcnt lgkmcnt(3)
    v_mfma_f32_32x32x16_bf16 v[80:95], v[36:39], v[216:219], v[80:95]
    ds_read_b64_tr_b16 v[44:45], v21 offset:12288
    ds_read_b64_tr_b16 v[46:47], v21 offset:12800
    s_mul_i32 s59, s70, 229376
    s_add_u32 s59, s59, s67
    buffer_load_dwordx4 v8, s[44:47], s59 offen offset:1024 lds
    buffer_load_dwordx4 v9, s[44:47], s59 offen offset:3072 lds
    s_waitcnt lgkmcnt(2)
    v_mfma_f32_32x32x16_bf16 v[64:79], v[40:43], v[220:223], v[64:79]
    s_waitcnt vmcnt(9)
    s_barrier
    s_add_u32 s70, s63, 0
    s_add_u32 s70, s70, s57
    s_and_b32 s70, s70, 7
    s_mul_i32 s70, s70, 229376
    s_add_u32 s70, s70, s68
    s_lshl_b32 s71, s57, 13
    s_add_u32 m0, s71, 37888
    s_add_u32 s59, s70, 0
    buffer_load_dwordx4 v12, s[44:47], s59 offen offset:0 lds
    buffer_load_dwordx4 v13, s[44:47], s59 offen offset:1024 lds
    buffer_load_dwordx4 v14, s[44:47], s59 offen offset:2048 lds
    buffer_load_dwordx4 v15, s[44:47], s59 offen offset:3072 lds
    s_add_u32 m0, s71, 41984
    s_add_u32 s59, s70, 114688
    buffer_load_dwordx4 v12, s[44:47], s59 offen offset:0 lds
    buffer_load_dwordx4 v13, s[44:47], s59 offen offset:1024 lds
    buffer_load_dwordx4 v14, s[44:47], s59 offen offset:2048 lds
    buffer_load_dwordx4 v15, s[44:47], s59 offen offset:3072 lds
    ds_read_b128 v[224:227], v16 offset:36864
    ds_read_b64_tr_b16 v[32:33], v20 offset:36864
    ds_read_b64_tr_b16 v[34:35], v20 offset:37376
    s_waitcnt lgkmcnt(3)
    v_mfma_f32_32x32x16_bf16 v[80:95], v[44:47], v[220:223], v[80:95]
    ds_read_b64_tr_b16 v[36:37], v21 offset:36864
    ds_read_b64_tr_b16 v[38:39], v21 offset:37376
    s_waitcnt lgkmcnt(2)
    v_mfma_f32_32x32x16_bf16 v[64:79], v[32:35], v[224:227], v[64:79]
    ds_read_b128 v[228:231], v17 offset:36864
    ds_read_b64_tr_b16 v[40:41], v20 offset:40960
    ds_read_b64_tr_b16 v[42:43], v20 offset:41472
    s_waitcnt lgkmcnt(3)
    v_mfma_f32_32x32x16_bf16 v[80:95], v[36:39], v[224:227], v[80:95]
    ds_read_b64_tr_b16 v[44:45], v21 offset:40960
    ds_read_b64_tr_b16 v[46:47], v21 offset:41472
    s_waitcnt lgkmcnt(2)
    v_mfma_f32_32x32x16_bf16 v[64:79], v[40:43], v[228:231], v[64:79]
    ds_read_b128 v[232:235], v18 offset:36864
    ds_read_b64_tr_b16 v[32:33], v20 offset:45056
    ds_read_b64_tr_b16 v[34:35], v20 offset:45568
    s_waitcnt lgkmcnt(3)
    v_mfma_f32_32x32x16_bf16 v[80:95], v[44:47], v[228:231], v[80:95]
    ds_read_b64_tr_b16 v[36:37], v21 offset:45056
    ds_read_b64_tr_b16 v[38:39], v21 offset:45568
    s_waitcnt lgkmcnt(2)
    v_mfma_f32_32x32x16_bf16 v[64:79], v[32:35], v[232:235], v[64:79]
    ds_read_b128 v[236:239], v19 offset:36864
    ds_read_b64_tr_b16 v[40:41], v20 offset:49152
    ds_read_b64_tr_b16 v[42:43], v20 offset:49664
    s_waitcnt lgkmcnt(3)
    v_mfma_f32_32x32x16_bf16 v[80:95], v[36:39], v[232:235], v[80:95]
    ds_read_b64_tr_b16 v[44:45], v21 offset:49152
    ds_read_b64_tr_b16 v[46:47], v21 offset:49664
    s_waitcnt lgkmcnt(2)
    v_mfma_f32_32x32x16_bf16 v[64:79], v[40:43], v[236:239], v[64:79]
    s_waitcnt vmcnt(8)
    s_barrier
    s_add_u32 s70, s63, 4
    s_add_u32 s70, s70, s57
    s_and_b32 s70, s70, 7
    s_mul_i32 s70, s70, 229376
    s_add_u32 s70, s70, s68
    s_lshl_b32 s71, s57, 13
    s_add_u32 m0, s71, 74752
    s_add_u32 s59, s70, 0
    buffer_load_dwordx4 v12, s[44:47], s59 offen offset:0 lds
    buffer_load_dwordx4 v13, s[44:47], s59 offen offset:1024 lds
    buffer_load_dwordx4 v14, s[44:47], s59 offen offset:2048 lds
    buffer_load_dwordx4 v15, s[44:47], s59 offen offset:3072 lds
    s_add_u32 m0, s71, 78848
    s_add_u32 s59, s70, 114688
    buffer_load_dwordx4 v12, s[44:47], s59 offen offset:0 lds
    buffer_load_dwordx4 v13, s[44:47], s59 offen offset:1024 lds
    buffer_load_dwordx4 v14, s[44:47], s59 offen offset:2048 lds
    buffer_load_dwordx4 v15, s[44:47], s59 offen offset:3072 lds
    v_add_u32 v16, 4294893568, v16
    v_add_u32 v17, 4294893568, v17
    v_add_u32 v18, 4294893568, v18
    v_add_u32 v19, 4294893568, v19
    v_add_u32 v20, 4294893568, v20
    v_add_u32 v21, 4294893568, v21
    ds_read_b128 v[240:243], v16 offset:0
    ds_read_b64_tr_b16 v[32:33], v20 offset:0
    ds_read_b64_tr_b16 v[34:35], v20 offset:512
    s_waitcnt lgkmcnt(3)
    v_mfma_f32_32x32x16_bf16 v[80:95], v[44:47], v[236:239], v[80:95]
    ds_read_b64_tr_b16 v[36:37], v21 offset:0
    ds_read_b64_tr_b16 v[38:39], v21 offset:512
    s_mov_b32 s36, s24
    s_mov_b32 s37, s25
    s_mov_b32 s38, 256
    s_mov_b32 s39, 0x20000
    buffer_load_dword v114, v113, s[36:39], 0 offen sc1
    s_waitcnt lgkmcnt(2)
    v_mfma_f32_32x32x16_bf16 v[64:79], v[32:35], v[240:243], v[64:79]
    ds_read_b128 v[244:247], v17 offset:0
    ds_read_b64_tr_b16 v[40:41], v20 offset:4096
    ds_read_b64_tr_b16 v[42:43], v20 offset:4608
    s_waitcnt lgkmcnt(3)
    v_mfma_f32_32x32x16_bf16 v[80:95], v[36:39], v[240:243], v[80:95]
    ds_read_b64_tr_b16 v[44:45], v21 offset:4096
    ds_read_b64_tr_b16 v[46:47], v21 offset:4608
    s_waitcnt lgkmcnt(2)
    v_mfma_f32_32x32x16_bf16 v[64:79], v[40:43], v[244:247], v[64:79]
    ds_read_b128 v[248:251], v18 offset:0
    ds_read_b64_tr_b16 v[32:33], v20 offset:8192
    ds_read_b64_tr_b16 v[34:35], v20 offset:8704
    s_waitcnt lgkmcnt(3)
    v_mfma_f32_32x32x16_bf16 v[80:95], v[44:47], v[244:247], v[80:95]
    ds_read_b64_tr_b16 v[36:37], v21 offset:8192
    ds_read_b64_tr_b16 v[38:39], v21 offset:8704
    s_waitcnt lgkmcnt(2)
    v_mfma_f32_32x32x16_bf16 v[64:79], v[32:35], v[248:251], v[64:79]
    ds_read_b128 v[252:255], v19 offset:0
    ds_read_b64_tr_b16 v[40:41], v20 offset:12288
    ds_read_b64_tr_b16 v[42:43], v20 offset:12800
    s_waitcnt lgkmcnt(3)
    v_mfma_f32_32x32x16_bf16 v[80:95], v[36:39], v[248:251], v[80:95]
    ds_read_b64_tr_b16 v[44:45], v21 offset:12288
    ds_read_b64_tr_b16 v[46:47], v21 offset:12800
    s_waitcnt lgkmcnt(2)
    v_mfma_f32_32x32x16_bf16 v[64:79], v[40:43], v[252:255], v[64:79]
    s_waitcnt lgkmcnt(0)
    v_mfma_f32_32x32x16_bf16 v[80:95], v[44:47], v[252:255], v[80:95]
    s_nop 7
    s_nop 2
    v_pk_mul_f32 v[48:49], v[64:65], v[64:65]
    v_pk_mul_f32 v[50:51], v[66:67], v[66:67]
    v_pk_mul_f32 v[52:53], v[68:69], v[68:69]
    v_pk_mul_f32 v[54:55], v[70:71], v[70:71]
    v_pk_mul_f32 v[56:57], v[72:73], v[72:73]
    v_pk_mul_f32 v[58:59], v[74:75], v[74:75]
    v_pk_mul_f32 v[60:61], v[76:77], v[76:77]
    v_pk_mul_f32 v[62:63], v[78:79], v[78:79]
    v_pk_fma_f32 v[48:49], v[48:49], v[26:27], v[24:25]
    v_pk_fma_f32 v[50:51], v[50:51], v[26:27], v[24:25]
    v_pk_fma_f32 v[52:53], v[52:53], v[26:27], v[24:25]
    v_pk_fma_f32 v[54:55], v[54:55], v[26:27], v[24:25]
    v_pk_fma_f32 v[56:57], v[56:57], v[26:27], v[24:25]
    v_pk_fma_f32 v[58:59], v[58:59], v[26:27], v[24:25]
    v_pk_fma_f32 v[60:61], v[60:61], v[26:27], v[24:25]
    v_pk_fma_f32 v[62:63], v[62:63], v[26:27], v[24:25]
    v_pk_mul_f32 v[48:49], v[48:49], v[64:65]
    v_pk_mul_f32 v[50:51], v[50:51], v[66:67]
    v_pk_mul_f32 v[52:53], v[52:53], v[68:69]
    v_pk_mul_f32 v[54:55], v[54:55], v[70:71]
    v_pk_mul_f32 v[56:57], v[56:57], v[72:73]
    v_pk_mul_f32 v[58:59], v[58:59], v[74:75]
    v_pk_mul_f32 v[60:61], v[60:61], v[76:77]
    v_pk_mul_f32 v[62:63], v[62:63], v[78:79]
    v_exp_f32 v48, v48
    v_exp_f32 v49, v49
    v_exp_f32 v50, v50
    v_exp_f32 v51, v51
    v_exp_f32 v52, v52
    v_exp_f32 v53, v53
    v_exp_f32 v54, v54
    v_exp_f32 v55, v55
    v_exp_f32 v56, v56
    v_exp_f32 v57, v57
    v_exp_f32 v58, v58
    v_exp_f32 v59, v59
    v_exp_f32 v60, v60
    v_exp_f32 v61, v61
    v_exp_f32 v62, v62
    v_exp_f32 v63, v63
    v_pk_add_f32 v[48:49], v[48:49], s[0:1]
    v_pk_add_f32 v[50:51], v[50:51], s[0:1]
    v_pk_add_f32 v[52:53], v[52:53], s[0:1]
    v_pk_add_f32 v[54:55], v[54:55], s[0:1]
    v_pk_add_f32 v[56:57], v[56:57], s[0:1]
    v_pk_add_f32 v[58:59], v[58:59], s[0:1]
    v_pk_add_f32 v[60:61], v[60:61], s[0:1]
    v_pk_add_f32 v[62:63], v[62:63], s[0:1]
    v_rcp_f32 v48, v48
    v_rcp_f32 v49, v49
    v_rcp_f32 v50, v50
    v_rcp_f32 v51, v51
    v_rcp_f32 v52, v52
    v_rcp_f32 v53, v53
    v_rcp_f32 v54, v54
    v_rcp_f32 v55, v55
    v_rcp_f32 v56, v56
    v_rcp_f32 v57, v57
    v_rcp_f32 v58, v58
    v_rcp_f32 v59, v59
    v_rcp_f32 v60, v60
    v_rcp_f32 v61, v61
    v_rcp_f32 v62, v62
    v_rcp_f32 v63, v63
    v_pk_mul_f32 v[64:65], v[64:65], v[48:49]
    v_pk_mul_f32 v[66:67], v[66:67], v[50:51]
    v_pk_mul_f32 v[68:69], v[68:69], v[52:53]
    v_pk_mul_f32 v[70:71], v[70:71], v[54:55]
    v_pk_mul_f32 v[72:73], v[72:73], v[56:57]
    v_pk_mul_f32 v[74:75], v[74:75], v[58:59]
    v_pk_mul_f32 v[76:77], v[76:77], v[60:61]
    v_pk_mul_f32 v[78:79], v[78:79], v[62:63]
    v_pk_add_f32 v[116:117], v[116:117], v[64:65]
    v_pk_fma_f32 v[118:119], v[64:65], v[64:65], v[118:119]
    v_pk_add_f32 v[116:117], v[116:117], v[66:67]
    v_pk_fma_f32 v[118:119], v[66:67], v[66:67], v[118:119]
    v_pk_add_f32 v[116:117], v[116:117], v[68:69]
    v_pk_fma_f32 v[118:119], v[68:69], v[68:69], v[118:119]
    v_pk_add_f32 v[116:117], v[116:117], v[70:71]
    v_pk_fma_f32 v[118:119], v[70:71], v[70:71], v[118:119]
    v_pk_add_f32 v[116:117], v[116:117], v[72:73]
    v_pk_fma_f32 v[118:119], v[72:73], v[72:73], v[118:119]
    v_pk_add_f32 v[116:117], v[116:117], v[74:75]
    v_pk_fma_f32 v[118:119], v[74:75], v[74:75], v[118:119]
    v_pk_add_f32 v[116:117], v[116:117], v[76:77]
    v_pk_fma_f32 v[118:119], v[76:77], v[76:77], v[118:119]
    v_pk_add_f32 v[116:117], v[116:117], v[78:79]
    v_pk_fma_f32 v[118:119], v[78:79], v[78:79], v[118:119]
    v_pk_mul_f32 v[48:49], v[80:81], v[80:81]
    v_pk_mul_f32 v[50:51], v[82:83], v[82:83]
    v_pk_mul_f32 v[52:53], v[84:85], v[84:85]
    v_pk_mul_f32 v[54:55], v[86:87], v[86:87]
    v_pk_mul_f32 v[56:57], v[88:89], v[88:89]
    v_pk_mul_f32 v[58:59], v[90:91], v[90:91]
    v_pk_mul_f32 v[60:61], v[92:93], v[92:93]
    v_pk_mul_f32 v[62:63], v[94:95], v[94:95]
    v_pk_fma_f32 v[48:49], v[48:49], v[26:27], v[24:25]
    v_pk_fma_f32 v[50:51], v[50:51], v[26:27], v[24:25]
    v_pk_fma_f32 v[52:53], v[52:53], v[26:27], v[24:25]
    v_pk_fma_f32 v[54:55], v[54:55], v[26:27], v[24:25]
    v_pk_fma_f32 v[56:57], v[56:57], v[26:27], v[24:25]
    v_pk_fma_f32 v[58:59], v[58:59], v[26:27], v[24:25]
    v_pk_fma_f32 v[60:61], v[60:61], v[26:27], v[24:25]
    v_pk_fma_f32 v[62:63], v[62:63], v[26:27], v[24:25]
    v_pk_mul_f32 v[48:49], v[48:49], v[80:81]
    v_pk_mul_f32 v[50:51], v[50:51], v[82:83]
    v_pk_mul_f32 v[52:53], v[52:53], v[84:85]
    v_pk_mul_f32 v[54:55], v[54:55], v[86:87]
    v_pk_mul_f32 v[56:57], v[56:57], v[88:89]
    v_pk_mul_f32 v[58:59], v[58:59], v[90:91]
    v_pk_mul_f32 v[60:61], v[60:61], v[92:93]
    v_pk_mul_f32 v[62:63], v[62:63], v[94:95]
    v_exp_f32 v48, v48
    v_exp_f32 v49, v49
    v_exp_f32 v50, v50
    v_exp_f32 v51, v51
    v_exp_f32 v52, v52
    v_exp_f32 v53, v53
    v_exp_f32 v54, v54
    v_exp_f32 v55, v55
    v_exp_f32 v56, v56
    v_exp_f32 v57, v57
    v_exp_f32 v58, v58
    v_exp_f32 v59, v59
    v_exp_f32 v60, v60
    v_exp_f32 v61, v61
    v_exp_f32 v62, v62
    v_exp_f32 v63, v63
    v_pk_add_f32 v[48:49], v[48:49], s[0:1]
    v_pk_add_f32 v[50:51], v[50:51], s[0:1]
    v_pk_add_f32 v[52:53], v[52:53], s[0:1]
    v_pk_add_f32 v[54:55], v[54:55], s[0:1]
    v_pk_add_f32 v[56:57], v[56:57], s[0:1]
    v_pk_add_f32 v[58:59], v[58:59], s[0:1]
    v_pk_add_f32 v[60:61], v[60:61], s[0:1]
    v_pk_add_f32 v[62:63], v[62:63], s[0:1]
    v_rcp_f32 v48, v48
    v_rcp_f32 v49, v49
    v_rcp_f32 v50, v50
    v_rcp_f32 v51, v51
    v_rcp_f32 v52, v52
    v_rcp_f32 v53, v53
    v_rcp_f32 v54, v54
    v_rcp_f32 v55, v55
    v_rcp_f32 v56, v56
    v_rcp_f32 v57, v57
    v_rcp_f32 v58, v58
    v_rcp_f32 v59, v59
    v_rcp_f32 v60, v60
    v_rcp_f32 v61, v61
    v_rcp_f32 v62, v62
    v_rcp_f32 v63, v63
    v_pk_mul_f32 v[80:81], v[80:81], v[48:49]
    v_pk_mul_f32 v[82:83], v[82:83], v[50:51]
    v_pk_mul_f32 v[84:85], v[84:85], v[52:53]
    v_pk_mul_f32 v[86:87], v[86:87], v[54:55]
    v_pk_mul_f32 v[88:89], v[88:89], v[56:57]
    v_pk_mul_f32 v[90:91], v[90:91], v[58:59]
    v_pk_mul_f32 v[92:93], v[92:93], v[60:61]
    v_pk_mul_f32 v[94:95], v[94:95], v[62:63]
    s_waitcnt vmcnt(0)
    ds_write_b32 v22, v106 offset:176
    v_pk_add_f32 v[116:117], v[116:117], v[80:81]
    v_pk_fma_f32 v[118:119], v[80:81], v[80:81], v[118:119]
    v_pk_add_f32 v[116:117], v[116:117], v[82:83]
    v_pk_fma_f32 v[118:119], v[82:83], v[82:83], v[118:119]
    v_pk_add_f32 v[116:117], v[116:117], v[84:85]
    v_pk_fma_f32 v[118:119], v[84:85], v[84:85], v[118:119]
    v_pk_add_f32 v[116:117], v[116:117], v[86:87]
    v_pk_fma_f32 v[118:119], v[86:87], v[86:87], v[118:119]
    v_pk_add_f32 v[116:117], v[116:117], v[88:89]
    v_pk_fma_f32 v[118:119], v[88:89], v[88:89], v[118:119]
    v_pk_add_f32 v[116:117], v[116:117], v[90:91]
    v_pk_fma_f32 v[118:119], v[90:91], v[90:91], v[118:119]
    v_pk_add_f32 v[116:117], v[116:117], v[92:93]
    v_pk_fma_f32 v[118:119], v[92:93], v[92:93], v[118:119]
    v_pk_add_f32 v[116:117], v[116:117], v[94:95]
    v_pk_fma_f32 v[118:119], v[94:95], v[94:95], v[118:119]
    v_add_f32 v116, v116, v117
    v_add_f32 v117, v118, v119
    v_mov_b32 v48, v116
    s_nop 1
    v_permlane32_swap_b32 v116, v48
    v_add_f32 v116, v116, v48
    v_mov_b32 v49, v117
    s_nop 1
    v_permlane32_swap_b32 v117, v49
    v_add_f32 v117, v117, v49
    v_and_b32 v117, 0x7fffffff, v117
    s_mov_b32 s91, 65536
L_clr2:
    s_waitcnt vmcnt(0)
    v_cmp_eq_u32 vcc, 0, v114
    s_sub_u32 s91, s91, 1
    s_cbranch_scc1 L_clr2d
    s_cmp_eq_u64 vcc, 0
    s_cbranch_scc1 L_clr2d
    buffer_load_dword v114, v113, s[36:39], 0 offen sc1
    s_branch L_clr2
L_clr2d:
    buffer_store_dwordx2 v[116:117], v97, s[28:31], s81 offen sc1
    s_mov_b64 exec, 3
    buffer_atomic_add v106, v107, s[28:31], s90 offen sc1
    s_mov_b64 exec, -1
    ds_read_b128 v[36:39], v23 offset:192
    s_mov_b32 s91, 65536
L_bz1:
    ds_read_b128 v[48:51], v23 offset:176
    s_waitcnt lgkmcnt(0)
    v_and_b32 v48, v48, v49
    v_and_b32 v50, v50, v51
    v_and_b32 v48, v48, v50
    s_sub_u32 s91, s91, 1
    v_readfirstlane_b32 s3, v48
    s_cbranch_scc1 L_bz1d
    s_cmp_lg_u32 s3, 0
    s_cbranch_scc1 L_bz1d
    s_sleep 2
    s_branch L_bz1
L_bz1d:
    v_min3_u32 v36, v36, v37, v38
    v_and_b32 v36, v36, v39
    v_cmp_eq_u32 vcc, 0, v36
    s_mov_b32 s36, s84
    s_mov_b32 s37, s85
    s_cmp_eq_u64 vcc, 0
    s_cbranch_scc1 L_bz2d
    s_mov_b32 s91, 65536
L_bz2:
    ds_read_b128 v[48:51], v23 offset:192
    s_waitcnt lgkmcnt(0)
    v_and_b32 v48, v48, v49
    v_and_b32 v50, v50, v51
    v_and_b32 v48, v48, v50
    s_sub_u32 s91, s91, 1
    v_readfirstlane_b32 s3, v48
    s_cbranch_scc1 L_bz2d
    s_cmp_lg_u32 s3, 0
    s_cbranch_scc1 L_bz2d
    s_sleep 2
    s_branch L_bz2
L_bz2d:
    s_setprio 2
    ds_read_b64_tr_b16 v[32:33], v30 offset:0
    ds_read_b64_tr_b16 v[34:35], v30 offset:512
    ds_read_b64_tr_b16 v[36:37], v11 offset:0
    ds_read_b64_tr_b16 v[38:39], v11 offset:512
    ds_read_b64_tr_b16 v[40:41], v30 offset:2048
    ds_read_b64_tr_b16 v[42:43], v30 offset:2560
    ds_read_b64_tr_b16 v[44:45], v11 offset:2048
    ds_read_b64_tr_b16 v[46:47], v11 offset:2560
    s_waitcnt lgkmcnt(6)
    v_mfma_f32_32x32x16_bf16 v[48:63], v[32:35], v[128:131], 0
    ds_read_b64_tr_b16 v[32:33], v30 offset:4096
    ds_read_b64_tr_b16 v[34:35], v30 offset:4608
    s_add_u32 s3, s93, 0
    s_and_b32 s3, s3, 7
    s_lshl_b32 s3, s3, 7
    s_mov_b32 m0, s72
    s_add_u32 s59, s3, s74
    buffer_load_dwordx4 v108, s[32:35], s59 offen offset:0 lds
    s_waitcnt lgkmcnt(6)
    v_mfma_f32_32x32x16_bf16 v[112:127], v[36:39], v[128:131], 0
    ds_read_b64_tr_b16 v[36:37], v11 offset:4096
    ds_read_b64_tr_b16 v[38:39], v11 offset:4608
    buffer_load_dwordx4 v109, s[32:35], s59 offen offset:1024 lds
    s_waitcnt lgkmcnt(6)
    v_mfma_f32_32x32x16_bf16 v[48:63], v[40:43], v[132:135], v[48:63]
    ds_read_b64_tr_b16 v[40:41], v30 offset:6144
    ds_read_b64_tr_b16 v[42:43], v30 offset:6656
    buffer_load_dwordx4 v110, s[32:35], s59 offen offset:2048 lds
    s_waitcnt lgkmcnt(6)
    v_mfma_f32_32x32x16_bf16 v[112:127], v[44:47], v[132:135], v[112:127]
    ds_read_b64_tr_b16 v[44:45], v11 offset:6144
    ds_read_b64_tr_b16 v[46:47], v11 offset:6656
    buffer_load_dwordx4 v111, s[32:35], s59 offen offset:3072 lds
    s_waitcnt lgkmcnt(6)
    v_mfma_f32_32x32x16_bf16 v[48:63], v[32:35], v[136:139], v[48:63]
    ds_read_b64_tr_b16 v[32:33], v30 offset:8192
    ds_read_b64_tr_b16 v[34:35], v30 offset:8704
    s_add_u32 s3, s93, 0
    s_and_b32 s3, s3, 7
    s_lshl_b32 s3, s3, 7
    s_mov_b32 m0, s73
    s_add_u32 s59, s3, s75
    buffer_load_dwordx4 v108, s[32:35], s59 offen offset:0 lds
    s_waitcnt lgkmcnt(6)
    v_mfma_f32_32x32x16_bf16 v[112:127], v[36:39], v[136:139], v[112:127]
    ds_read_b64_tr_b16 v[36:37], v11 offset:8192
    ds_read_b64_tr_b16 v[38:39], v11 offset:8704
    buffer_load_dwordx4 v109, s[32:35], s59 offen offset:1024 lds
    s_waitcnt lgkmcnt(6)
    v_mfma_f32_32x32x16_bf16 v[48:63], v[40:43], v[140:143], v[48:63]
    ds_read_b64_tr_b16 v[40:41], v30 offset:10240
    ds_read_b64_tr_b16 v[42:43], v30 offset:10752
    buffer_load_dwordx4 v110, s[32:35], s59 offen offset:2048 lds
    s_waitcnt lgkmcnt(6)
    v_mfma_f32_32x32x16_bf16 v[112:127], v[44:47], v[140:143], v[112:127]
    ds_read_b64_tr_b16 v[44:45], v11 offset:10240
    ds_read_b64_tr_b16 v[46:47], v11 offset:10752
    buffer_load_dwordx4 v111, s[32:35], s59 offen offset:3072 lds
    s_waitcnt lgkmcnt(6)
    v_mfma_f32_32x32x16_bf16 v[48:63], v[32:35], v[144:147], v[48:63]
    ds_read_b64_tr_b16 v[32:33], v30 offset:12288
    ds_read_b64_tr_b16 v[34:35], v30 offset:12800
    s_mov_b32 s54, s76
    s_mov_b32 s55, s77
    s_and_b32 s58, s55, 1
    s_waitcnt lgkmcnt(6)
    v_mfma_f32_32x32x16_bf16 v[112:127], v[36:39], v[144:147], v[112:127]
    ds_read_b64_tr_b16 v[36:37], v11 offset:12288
    ds_read_b64_tr_b16 v[38:39], v11 offset:12800
    s_lshl_b32 s60, s54, 1
    s_add_u32 s60, s60, s58
    s_xor_b32 s61, s60, 1
    s_waitcnt lgkmcnt(6)
    v_mfma_f32_32x32x16_bf16 v[48:63], v[40:43], v[148:151], v[48:63]
    ds_read_b64_tr_b16 v[40:41], v30 offset:14336
    ds_read_b64_tr_b16 v[42:43], v30 offset:14848
    s_lshr_b32 s59, s55, 1
    s_mul_i32 s59, s59, 7
    s_add_u32 s65, s59, 3
    s_waitcnt lgkmcnt(6)
    v_mfma_f32_32x32x16_bf16 v[112:127], v[44:47], v[148:151], v[112:127]
    ds_read_b64_tr_b16 v[44:45], v11 offset:14336
    ds_read_b64_tr_b16 v[46:47], v11 offset:14848
    s_lshl_b32 s62, s58, 2
    s_add_u32 s62, s62, s59
    s_add_u32 s63, s62, 1
    s_waitcnt lgkmcnt(6)
    v_mfma_f32_32x32x16_bf16 v[48:63], v[32:35], v[152:155], v[48:63]
    ds_read_b64_tr_b16 v[32:33], v30 offset:16384
    ds_read_b64_tr_b16 v[34:35], v30 offset:16896
    s_add_u32 s64, s62, 2
    s_lshl_b32 s59, s57, 15
    s_add_u32 s59, s59, 10485760
    s_waitcnt lgkmcnt(6)
    v_mfma_f32_32x32x16_bf16 v[112:127], v[36:39], v[152:155], v[112:127]
    ds_read_b64_tr_b16 v[36:37], v11 offset:16384
    ds_read_b64_tr_b16 v[38:39], v11 offset:16896
    s_lshl_b32 s66, s62, 17
    s_add_u32 s66, s66, s59
    s_lshl_b32 s67, s63, 17
    s_waitcnt lgkmcnt(6)
    v_mfma_f32_32x32x16_bf16 v[48:63], v[40:43], v[156:159], v[48:63]
    ds_read_b64_tr_b16 v[40:41], v30 offset:18432
    ds_read_b64_tr_b16 v[42:43], v30 offset:18944
    s_add_u32 s67, s67, s59
    s_lshl_b32 s68, s64, 17
    s_add_u32 s68, s68, s59
    s_waitcnt lgkmcnt(6)
    v_mfma_f32_32x32x16_bf16 v[112:127], v[44:47], v[156:159], v[112:127]
    ds_read_b64_tr_b16 v[44:45], v11 offset:18432
    ds_read_b64_tr_b16 v[46:47], v11 offset:18944
    s_lshl_b32 s69, s65, 17
    s_add_u32 s69, s69, s59
    s_mov_b32 s40, s16
    s_waitcnt lgkmcnt(6)
    v_mfma_f32_32x32x16_bf16 v[48:63], v[32:35], v[160:163], v[48:63]
    ds_read_b64_tr_b16 v[32:33], v30 offset:20480
    ds_read_b64_tr_b16 v[34:35], v30 offset:20992
    s_mov_b32 s41, s17
    s_mov_b32 s42, 4096
    s_mov_b32 s43, 0x20000
    s_waitcnt lgkmcnt(6)
    v_mfma_f32_32x32x16_bf16 v[112:127], v[36:39], v[160:163], v[112:127]
    ds_read_b64_tr_b16 v[36:37], v11 offset:20480
    ds_read_b64_tr_b16 v[38:39], v11 offset:20992
    v_lshlrev_b32 v1, 4, v0
    v_mov_b32 v2, v108
    v_mov_b32 v3, v109
    s_waitcnt lgkmcnt(6)
    v_mfma_f32_32x32x16_bf16 v[48:63], v[40:43], v[164:167], v[48:63]
    ds_read_b64_tr_b16 v[40:41], v30 offset:22528
    ds_read_b64_tr_b16 v[42:43], v30 offset:23040
    v_mov_b32 v4, v110
    v_mov_b32 v5, v111
    v_bfe_u32 v10, v0, 1, 3
    s_waitcnt lgkmcnt(6)
    v_mfma_f32_32x32x16_bf16 v[112:127], v[44:47], v[164:167], v[112:127]
    ds_read_b64_tr_b16 v[44:45], v11 offset:22528
    ds_read_b64_tr_b16 v[46:47], v11 offset:23040
    v_lshrrev_b32 v9, 5, v0
    v_xor_b32 v10, v10, v9
    v_lshlrev_b32 v10, 4, v10
    s_waitcnt lgkmcnt(6)
    v_mfma_f32_32x32x16_bf16 v[48:63], v[32:35], v[168:171], v[48:63]
    ds_read_b64_tr_b16 v[32:33], v30 offset:24576
    ds_read_b64_tr_b16 v[34:35], v30 offset:25088
    v_and_b32 v9, 31, v0
    v_lshl_add_u32 v10, v9, 7, v10
    v_add_u32 v6, s72, v10
    s_waitcnt lgkmcnt(6)
    v_mfma_f32_32x32x16_bf16 v[112:127], v[36:39], v[168:171], v[112:127]
    ds_read_b64_tr_b16 v[36:37], v11 offset:24576
    ds_read_b64_tr_b16 v[38:39], v11 offset:25088
    v_xor_b32 v7, 32, v6
    v_xor_b32 v8, 64, v6
    v_xor_b32 v9, 96, v6
    s_waitcnt lgkmcnt(6)
    v_mfma_f32_32x32x16_bf16 v[48:63], v[40:43], v[172:175], v[48:63]
    ds_read_b64_tr_b16 v[40:41], v30 offset:26624
    ds_read_b64_tr_b16 v[42:43], v30 offset:27136
    v_mov_b32 v14, 0
    v_mov_b32 v15, 1
    s_lshl_b32 s59, s57, 2
    s_waitcnt lgkmcnt(6)
    v_mfma_f32_32x32x16_bf16 v[112:127], v[44:47], v[172:175], v[112:127]
    ds_read_b64_tr_b16 v[44:45], v11 offset:26624
    ds_read_b64_tr_b16 v[46:47], v11 offset:27136
    s_add_u32 s59, s59, 32
    v_mov_b32 v13, s59
    v_lshrrev_b32 v10, 4, v0
    s_waitcnt lgkmcnt(6)
    v_mfma_f32_32x32x16_bf16 v[48:63], v[32:35], v[176:179], v[48:63]
    ds_read_b64_tr_b16 v[32:33], v30 offset:28672
    ds_read_b64_tr_b16 v[34:35], v30 offset:29184
    s_lshr_b32 s59, s62, 1
    v_mov_b32 v18, s59
    s_lshr_b32 s59, s64, 1
    s_waitcnt lgkmcnt(6)
    v_mfma_f32_32x32x16_bf16 v[112:127], v[36:39], v[176:179], v[112:127]
    ds_read_b64_tr_b16 v[36:37], v11 offset:28672
    ds_read_b64_tr_b16 v[38:39], v11 offset:29184
    v_mov_b32 v16, s59
    v_cmp_eq_u32 vcc, 1, v10
    s_lshr_b32 s59, s65, 1
    s_waitcnt lgkmcnt(6)
    v_mfma_f32_32x32x16_bf16 v[48:63], v[40:43], v[180:183], v[48:63]
    ds_read_b64_tr_b16 v[40:41], v30 offset:30720
    ds_read_b64_tr_b16 v[42:43], v30 offset:31232
    v_mov_b32 v17, s59
    v_cndmask_b32 v18, v18, v16, vcc
    v_cmp_eq_u32 vcc, 2, v10
    s_waitcnt lgkmcnt(6)
    v_mfma_f32_32x32x16_bf16 v[112:127], v[44:47], v[180:183], v[112:127]
    ds_read_b64_tr_b16 v[44:45], v11 offset:30720
    ds_read_b64_tr_b16 v[46:47], v11 offset:31232
    s_lshl_b32 s59, s57, 3
    s_and_b32 s3, s53, 7
    v_cndmask_b32 v18, v18, v17, vcc
    s_waitcnt lgkmcnt(6)
    v_mfma_f32_32x32x16_bf16 v[48:63], v[32:35], v[184:187], v[48:63]
    v_add_u32 v30, 36864, v30
    ds_read_b64_tr_b16 v[32:33], v30 offset:0
    ds_read_b64_tr_b16 v[34:35], v30 offset:512
    s_add_u32 s59, s59, s3
    v_lshl_add_u32 v10, v18, 5, s59
    v_mul_u32_u24 v10, 256, v10
    s_waitcnt lgkmcnt(6)
    v_mfma_f32_32x32x16_bf16 v[112:127], v[36:39], v[184:187], v[112:127]
    v_add_u32 v11, 36864, v11
    ds_read_b64_tr_b16 v[36:37], v11 offset:0
    ds_read_b64_tr_b16 v[38:39], v11 offset:512
    v_add_u32 v10, 98304, v10
    v_and_b32 v16, 3, v0
    s_lshr_b32 s59, s54, 1
    s_waitcnt lgkmcnt(6)
    v_mfma_f32_32x32x16_bf16 v[48:63], v[40:43], v[188:191], v[48:63]
    ds_read_b64_tr_b16 v[40:41], v30 offset:2048
    ds_read_b64_tr_b16 v[42:43], v30 offset:2560
    s_add_u32 s59, s59, 1024
    v_lshl_add_u32 v12, v18, 4, s59
    s_lshl_b32 s38, s52, 2
    s_waitcnt lgkmcnt(6)
    v_mfma_f32_32x32x16_bf16 v[112:127], v[44:47], v[188:191], v[112:127]
    ds_read_b64_tr_b16 v[44:45], v11 offset:2048
    ds_read_b64_tr_b16 v[46:47], v11 offset:2560
    s_and_b32 s59, s53, 3
    s_add_u32 s38, s38, s59
    s_lshr_b32 s39, s53, 2
    s_waitcnt lgkmcnt(6)
    v_mfma_f32_32x32x16_bf16 v[48:63], v[32:35], v[192:195], v[48:63]
    ds_read_b64_tr_b16 v[32:33], v30 offset:4096
    ds_read_b64_tr_b16 v[34:35], v30 offset:4608
    s_lshl_b32 s59, s39, 4
    s_add_u32 s59, s59, 848
    v_cmp_lt_u32 vcc, 47, v0
    s_waitcnt lgkmcnt(6)
    v_mfma_f32_32x32x16_bf16 v[112:127], v[36:39], v[192:195], v[112:127]
    ds_read_b64_tr_b16 v[36:37], v11 offset:4096
    ds_read_b64_tr_b16 v[38:39], v11 offset:4608
    v_add_u32 v17, s59, v0
    s_nop 0
    v_cndmask_b32 v12, v12, v17, vcc
    s_waitcnt lgkmcnt(6)
    v_mfma_f32_32x32x16_bf16 v[48:63], v[40:43], v[196:199], v[48:63]
    ds_read_b64_tr_b16 v[40:41], v30 offset:6144
    ds_read_b64_tr_b16 v[42:43], v30 offset:6656
    v_mul_u32_u24 v12, 256, v12
    s_lshl_b32 s48, s39, 1
    s_and_b32 s59, s57, 1
    s_waitcnt lgkmcnt(6)
    v_mfma_f32_32x32x16_bf16 v[112:127], v[44:47], v[196:199], v[112:127]
    ds_read_b64_tr_b16 v[44:45], v11 offset:6144
    ds_read_b64_tr_b16 v[46:47], v11 offset:6656
    s_add_u32 s48, s48, s59
    s_xor_b32 s49, s48, 1
    s_mul_i32 s59, s57, 14336
    s_waitcnt lgkmcnt(6)
    v_mfma_f32_32x32x16_bf16 v[48:63], v[32:35], v[200:203], v[48:63]
    ds_read_b64_tr_b16 v[32:33], v30 offset:8192
    ds_read_b64_tr_b16 v[34:35], v30 offset:8704
    s_add_u32 s59, s59, 21004288
    s_mul_i32 s48, s48, 90112
    s_add_u32 s48, s48, s59
    s_waitcnt lgkmcnt(6)
    v_mfma_f32_32x32x16_bf16 v[112:127], v[36:39], v[200:203], v[112:127]
    ds_read_b64_tr_b16 v[36:37], v11 offset:8192
    ds_read_b64_tr_b16 v[38:39], v11 offset:8704
    s_mul_i32 s49, s49, 90112
    s_add_u32 s49, s49, s59
    v_mov_b32 v180, v24
    s_waitcnt lgkmcnt(6)
    v_mfma_f32_32x32x16_bf16 v[48:63], v[40:43], v[204:207], v[48:63]
    ds_read_b64_tr_b16 v[40:41], v30 offset:10240
    ds_read_b64_tr_b16 v[42:43], v30 offset:10752
    v_mov_b32 v181, v25
    v_mov_b32 v182, v26
    v_mov_b32 v183, v27
    s_waitcnt lgkmcnt(6)
    v_mfma_f32_32x32x16_bf16 v[112:127], v[44:47], v[204:207], v[112:127]
    ds_read_b64_tr_b16 v[44:45], v11 offset:10240
    ds_read_b64_tr_b16 v[46:47], v11 offset:10752
    s_waitcnt lgkmcnt(6)
    v_mfma_f32_32x32x16_bf16 v[48:63], v[32:35], v[208:211], v[48:63]
    ds_read_b64_tr_b16 v[32:33], v30 offset:12288
    ds_read_b64_tr_b16 v[34:35], v30 offset:12800
    s_waitcnt lgkmcnt(6)
    v_mfma_f32_32x32x16_bf16 v[112:127], v[36:39], v[208:211], v[112:127]
    ds_read_b64_tr_b16 v[36:37], v11 offset:12288
    ds_read_b64_tr_b16 v[38:39], v11 offset:12800
    buffer_load_dwordx2 v[128:129], v98, s[28:31], s79 offen offset:0 sc1
    buffer_load_dwordx2 v[130:131], v98, s[28:31], s79 offen offset:1024 sc1
    buffer_load_dwordx2 v[132:133], v98, s[28:31], s79 offen offset:2048 sc1
    buffer_load_dwordx2 v[134:135], v98, s[28:31], s79 offen offset:3072 sc1
    buffer_load_dwordx2 v[136:137], v98, s[28:31], s80 offen offset:0 sc1
    buffer_load_dwordx2 v[138:139], v98, s[28:31], s80 offen offset:1024 sc1
    buffer_load_dwordx2 v[140:141], v98, s[28:31], s80 offen offset:2048 sc1
    s_waitcnt lgkmcnt(6)
    v_mfma_f32_32x32x16_bf16 v[48:63], v[40:43], v[212:215], v[48:63]
    ds_read_b64_tr_b16 v[40:41], v30 offset:14336
    ds_read_b64_tr_b16 v[42:43], v30 offset:14848
    s_waitcnt lgkmcnt(6)
    v_mfma_f32_32x32x16_bf16 v[112:127], v[44:47], v[212:215], v[112:127]
    ds_read_b64_tr_b16 v[44:45], v11 offset:14336
    ds_read_b64_tr_b16 v[46:47], v11 offset:14848
    s_waitcnt lgkmcnt(6)
    v_mfma_f32_32x32x16_bf16 v[48:63], v[32:35], v[216:219], v[48:63]
    ds_read_b64_tr_b16 v[32:33], v30 offset:16384
    ds_read_b64_tr_b16 v[34:35], v30 offset:16896
    s_waitcnt lgkmcnt(6)
    v_mfma_f32_32x32x16_bf16 v[112:127], v[36:39], v[216:219], v[112:127]
    ds_read_b64_tr_b16 v[36:37], v11 offset:16384
    ds_read_b64_tr_b16 v[38:39], v11 offset:16896
    s_waitcnt lgkmcnt(6)
    v_mfma_f32_32x32x16_bf16 v[48:63], v[40:43], v[220:223], v[48:63]
    ds_read_b64_tr_b16 v[40:41], v30 offset:18432
    ds_read_b64_tr_b16 v[42:43], v30 offset:18944
    s_waitcnt lgkmcnt(6)
    v_mfma_f32_32x32x16_bf16 v[112:127], v[44:47], v[220:223], v[112:127]
    ds_read_b64_tr_b16 v[44:45], v11 offset:18432
    ds_read_b64_tr_b16 v[46:47], v11 offset:18944
    s_waitcnt lgkmcnt(6)
    v_mfma_f32_32x32x16_bf16 v[48:63], v[32:35], v[224:227], v[48:63]
    ds_read_b64_tr_b16 v[32:33], v30 offset:20480
    ds_read_b64_tr_b16 v[34:35], v30 offset:20992
    s_waitcnt lgkmcnt(6)
    v_mfma_f32_32x32x16_bf16 v[112:127], v[36:39], v[224:227], v[112:127]
    ds_read_b64_tr_b16 v[36:37], v11 offset:20480
    ds_read_b64_tr_b16 v[38:39], v11 offset:20992
    s_waitcnt lgkmcnt(6)
    v_mfma_f32_32x32x16_bf16 v[48:63], v[40:43], v[228:231], v[48:63]
    ds_read_b64_tr_b16 v[40:41], v30 offset:22528
    ds_read_b64_tr_b16 v[42:43], v30 offset:23040
    s_waitcnt lgkmcnt(6)
    v_mfma_f32_32x32x16_bf16 v[112:127], v[44:47], v[228:231], v[112:127]
    ds_read_b64_tr_b16 v[44:45], v11 offset:22528
    ds_read_b64_tr_b16 v[46:47], v11 offset:23040
    s_waitcnt lgkmcnt(6)
    v_mfma_f32_32x32x16_bf16 v[48:63], v[32:35], v[232:235], v[48:63]
    ds_read_b64_tr_b16 v[32:33], v30 offset:24576
    ds_read_b64_tr_b16 v[34:35], v30 offset:25088
    s_waitcnt lgkmcnt(6)
    v_mfma_f32_32x32x16_bf16 v[112:127], v[36:39], v[232:235], v[112:127]
    ds_read_b64_tr_b16 v[36:37], v11 offset:24576
    ds_read_b64_tr_b16 v[38:39], v11 offset:25088
    s_waitcnt lgkmcnt(6)
    v_mfma_f32_32x32x16_bf16 v[48:63], v[40:43], v[236:239], v[48:63]
    ds_read_b64_tr_b16 v[40:41], v30 offset:26624
    ds_read_b64_tr_b16 v[42:43], v30 offset:27136
    s_waitcnt lgkmcnt(6)
    v_mfma_f32_32x32x16_bf16 v[112:127], v[44:47], v[236:239], v[112:127]
    ds_read_b64_tr_b16 v[44:45], v11 offset:26624
    ds_read_b64_tr_b16 v[46:47], v11 offset:27136
    s_waitcnt lgkmcnt(6)
    v_mfma_f32_32x32x16_bf16 v[48:63], v[32:35], v[240:243], v[48:63]
    ds_read_b64_tr_b16 v[32:33], v30 offset:28672
    ds_read_b64_tr_b16 v[34:35], v30 offset:29184
    s_waitcnt lgkmcnt(6)
    v_mfma_f32_32x32x16_bf16 v[112:127], v[36:39], v[240:243], v[112:127]
    ds_read_b64_tr_b16 v[36:37], v11 offset:28672
    ds_read_b64_tr_b16 v[38:39], v11 offset:29184
    s_waitcnt lgkmcnt(6)
    v_mfma_f32_32x32x16_bf16 v[48:63], v[40:43], v[244:247], v[48:63]
    ds_read_b64_tr_b16 v[40:41], v30 offset:30720
    ds_read_b64_tr_b16 v[42:43], v30 offset:31232
    s_waitcnt lgkmcnt(6)
    v_mfma_f32_32x32x16_bf16 v[112:127], v[44:47], v[244:247], v[112:127]
    ds_read_b64_tr_b16 v[44:45], v11 offset:30720
    ds_read_b64_tr_b16 v[46:47], v11 offset:31232
    s_waitcnt lgkmcnt(6)
    v_mfma_f32_32x32x16_bf16 v[48:63], v[32:35], v[248:251], v[48:63]
    s_waitcnt lgkmcnt(4)
    v_mfma_f32_32x32x16_bf16 v[112:127], v[36:39], v[248:251], v[112:127]
    s_waitcnt lgkmcnt(2)
    v_mfma_f32_32x32x16_bf16 v[48:63], v[40:43], v[252:255], v[48:63]
    s_waitcnt lgkmcnt(0)
    v_mfma_f32_32x32x16_bf16 v[112:127], v[44:47], v[252:255], v[112:127]
    s_setprio 2
    s_waitcnt vmcnt(0)
    v_or3_b32 v144, v129, v131, v133
    v_or3_b32 v144, v144, v135, v137
    v_or3_b32 v144, v144, v139, v141
    v_cmp_gt_i32 vcc, 0, v144
    s_nop 0
    s_cmp_eq_u64 vcc, 0
    s_cbranch_scc1 L_stpd
    s_mov_b32 s91, 65536
    s_mov_b64 exec, 1
    v_mov_b32 v176, 0
    buffer_atomic_add v176, v107, s[28:31], s90 offen sc0 sc1
    s_sleep 6
L_spr:
    v_mov_b32 v177, 0
    buffer_atomic_add v177, v107, s[28:31], s90 offen sc0 sc1
    s_sleep 5
    s_waitcnt vmcnt(1)
    v_cmp_gt_u32 vcc, 14, v176
    s_sub_u32 s91, s91, 1
    s_cbranch_scc1 L_sprd
    s_and_b64 exec, exec, vcc
    s_cbranch_scc0 L_sprd
    v_mov_b32 v176, 0
    buffer_atomic_add v176, v107, s[28:31], s90 offen sc0 sc1
    s_sleep 5
    s_waitcnt vmcnt(1)
    v_cmp_gt_u32 vcc, 14, v177
    s_sub_u32 s91, s91, 1
    s_cbranch_scc1 L_sprd
    s_and_b64 exec, exec, vcc
    s_cbranch_scc0 L_sprd
    s_branch L_spr
L_sprd:
    s_mov_b64 exec, -1
    s_mov_b32 s91, 65536
L_stp:
    buffer_load_dwordx2 v[128:129], v98, s[28:31], s79 offen offset:0 sc1
    buffer_load_dwordx2 v[130:131], v98, s[28:31], s79 offen offset:1024 sc1
    buffer_load_dwordx2 v[132:133], v98, s[28:31], s79 offen offset:2048 sc1
    buffer_load_dwordx2 v[134:135], v98, s[28:31], s79 offen offset:3072 sc1
    buffer_load_dwordx2 v[136:137], v98, s[28:31], s80 offen offset:0 sc1
    buffer_load_dwordx2 v[138:139], v98, s[28:31], s80 offen offset:1024 sc1
    buffer_load_dwordx2 v[140:141], v98, s[28:31], s80 offen offset:2048 sc1
    s_waitcnt vmcnt(0)
    v_or3_b32 v144, v129, v131, v133
    v_or3_b32 v144, v144, v135, v137
    v_or3_b32 v144, v144, v139, v141
    v_cmp_gt_i32 vcc, 0, v144
    s_sub_u32 s91, s91, 1
    s_cbranch_scc1 L_stpd
    s_cmp_lg_u64 vcc, 0
    s_cbranch_scc1 L_stp
L_stpd:
    v_pk_add_f32 v[128:129], v[128:129], v[130:131]
    v_pk_add_f32 v[128:129], v[128:129], v[132:133]
    v_pk_add_f32 v[128:129], v[128:129], v[134:135]
    v_pk_add_f32 v[128:129], v[128:129], v[136:137]
    v_pk_add_f32 v[128:129], v[128:129], v[138:139]
    v_pk_add_f32 v[128:129], v[128:129], v[140:141]
    v_mov_b32 v144, v128
    s_nop 1
    v_permlane32_swap_b32 v128, v144
    v_add_f32 v128, v128, v144
    v_mov_b32 v145, v129
    s_nop 1
    v_permlane32_swap_b32 v129, v145
    v_add_f32 v129, v129, v145
    v_mul_f32 v128, 0x3a924925, v128
    v_mul_f32 v129, 0x3a924925, v129
    v_fma_f32 v129, -v128, v128, v129
    v_max_f32 v129, 0, v129
    v_add_f32 v129, 0x3727c5ac, v129
    v_rsq_f32 v130, v129
    s_nop 0
    v_mul_f32 v132, -v128, v130
    v_mov_b32 v131, v130
    v_mov_b32 v133, v132
    v_pk_fma_f32 v[64:65], v[64:65], v[130:131], v[132:133]
    v_pk_fma_f32 v[66:67], v[66:67], v[130:131], v[132:133]
    v_pk_fma_f32 v[68:69], v[68:69], v[130:131], v[132:133]
    v_pk_fma_f32 v[70:71], v[70:71], v[130:131], v[132:133]
    v_pk_fma_f32 v[72:73], v[72:73], v[130:131], v[132:133]
    v_pk_fma_f32 v[74:75], v[74:75], v[130:131], v[132:133]
    v_pk_fma_f32 v[76:77], v[76:77], v[130:131], v[132:133]
    v_pk_fma_f32 v[78:79], v[78:79], v[130:131], v[132:133]
    v_cvt_pk_bf16_f32 v144, v64, v65
    v_cvt_pk_bf16_f32 v145, v66, v67
    v_cvt_pk_bf16_f32 v146, v68, v69
    v_cvt_pk_bf16_f32 v147, v70, v71
    v_cvt_pk_bf16_f32 v148, v72, v73
    v_cvt_pk_bf16_f32 v149, v74, v75
    v_cvt_pk_bf16_f32 v150, v76, v77
    v_cvt_pk_bf16_f32 v151, v78, v79
    ds_write_b64 v99, v[144:145] offset:0
    ds_write_b64 v100, v[146:147] offset:0
    ds_write_b64 v101, v[148:149] offset:0
    ds_write_b64 v102, v[150:151] offset:0
    v_pk_fma_f32 v[80:81], v[80:81], v[130:131], v[132:133]
    v_pk_fma_f32 v[82:83], v[82:83], v[130:131], v[132:133]
    v_pk_fma_f32 v[84:85], v[84:85], v[130:131], v[132:133]
    v_pk_fma_f32 v[86:87], v[86:87], v[130:131], v[132:133]
    v_pk_fma_f32 v[88:89], v[88:89], v[130:131], v[132:133]
    v_pk_fma_f32 v[90:91], v[90:91], v[130:131], v[132:133]
    v_pk_fma_f32 v[92:93], v[92:93], v[130:131], v[132:133]
    v_pk_fma_f32 v[94:95], v[94:95], v[130:131], v[132:133]
    v_cvt_pk_bf16_f32 v152, v80, v81
    v_cvt_pk_bf16_f32 v153, v82, v83
    v_cvt_pk_bf16_f32 v154, v84, v85
    v_cvt_pk_bf16_f32 v155, v86, v87
    v_cvt_pk_bf16_f32 v156, v88, v89
    v_cvt_pk_bf16_f32 v157, v90, v91
    v_cvt_pk_bf16_f32 v158, v92, v93
    v_cvt_pk_bf16_f32 v159, v94, v95
    ds_write_b64 v99, v[152:153] offset:2048
    ds_write_b64 v100, v[154:155] offset:2048
    ds_write_b64 v101, v[156:157] offset:2048
    ds_write_b64 v102, v[158:159] offset:2048
    s_waitcnt lgkmcnt(0)
    ds_read_b64_tr_b16 v[160:161], v103 offset:0
    ds_read_b64_tr_b16 v[162:163], v104 offset:256
    ds_read_b64_tr_b16 v[164:165], v103 offset:1024
    ds_read_b64_tr_b16 v[166:167], v104 offset:1280
    ds_read_b64_tr_b16 v[168:169], v103 offset:2048
    ds_read_b64_tr_b16 v[170:171], v104 offset:2304
    ds_read_b64_tr_b16 v[172:173], v103 offset:3072
    ds_read_b64_tr_b16 v[174:175], v104 offset:3328
    s_waitcnt lgkmcnt(6)
    buffer_store_dwordx4 v[160:163], v96, s[28:31], s82 offen offset:0 sc1
    s_waitcnt lgkmcnt(4)
    buffer_store_dwordx4 v[164:167], v96, s[28:31], s82 offen offset:1024 sc1
    s_waitcnt lgkmcnt(2)
    buffer_store_dwordx4 v[168:171], v96, s[28:31], s83 offen offset:0 sc1
    s_waitcnt lgkmcnt(0)
    buffer_store_dwordx4 v[172:175], v96, s[28:31], s83 offen offset:1024 sc1
    ds_write_b32 v13, v15 offset:128
    s_mov_b32 s70, s78
    s_mul_i32 s59, s60, 28
    s_add_u32 s59, s59, s62
    s_lshl_b32 s59, s59, 11
    s_add_u32 s76, s59, 6291456
    s_mul_i32 s59, s60, 44
    s_add_u32 s59, s59, s62
    s_lshl_b32 s59, s59, 11
    s_add_u32 s83, s59, 14712832
    s_mul_i32 s59, s60, 28
    s_add_u32 s59, s59, s63
    s_lshl_b32 s59, s59, 11
    s_add_u32 s77, s59, 6291456
    s_mul_i32 s59, s60, 44
    s_add_u32 s59, s59, s63
    s_lshl_b32 s59, s59, 11
    s_add_u32 s84, s59, 14712832
    s_mul_i32 s59, s60, 28
    s_add_u32 s59, s59, s64
    s_lshl_b32 s59, s59, 11
    s_add_u32 s78, s59, 6291456
    s_mul_i32 s59, s60, 44
    s_add_u32 s59, s59, s64
    s_lshl_b32 s59, s59, 11
    s_add_u32 s85, s59, 14712832
    s_mul_i32 s59, s60, 28
    s_add_u32 s59, s59, s65
    s_lshl_b32 s59, s59, 11
    s_add_u32 s79, s59, 6291456
    s_mul_i32 s59, s60, 44
    s_add_u32 s59, s59, s65
    s_lshl_b32 s59, s59, 11
    s_add_u32 s86, s59, 14712832
    s_mul_i32 s59, s61, 28
    s_add_u32 s59, s59, s62
    s_lshl_b32 s59, s59, 11
    s_add_u32 s80, s59, 6291456
    s_mul_i32 s59, s61, 44
    s_add_u32 s59, s59, s62
    s_lshl_b32 s59, s59, 11
    s_add_u32 s87, s59, 14712832
    s_mul_i32 s59, s61, 28
    s_add_u32 s59, s59, s63
    s_lshl_b32 s59, s59, 11
    s_add_u32 s81, s59, 6291456
    s_mul_i32 s59, s61, 44
    s_add_u32 s59, s59, s63
    s_lshl_b32 s59, s59, 11
    s_add_u32 s88, s59, 14712832
    s_mul_i32 s59, s61, 28
    s_add_u32 s59, s59, s64
    s_lshl_b32 s59, s59, 11
    s_add_u32 s82, s59, 6291456
    s_mul_i32 s59, s61, 44
    s_add_u32 s59, s59, s64
    s_lshl_b32 s59, s59, 11
    s_add_u32 s89, s59, 14712832
    s_lshl_b32 s59, s52, 2
    s_lshr_b32 s71, s53, 3
    s_add_u32 s59, s59, s71
    s_lshl_b32 s71, s59, 17
    s_lshl_b32 s92, s57, 11
    s_add_u32 s71, s71, s92
    s_add_u32 s71, s71, 2097152
    s_and_b32 s58, s53, 0
    s_lshl_b32 s58, s58, 14
    v_pk_mul_f32 v[144:145], v[48:49], v[48:49]
    v_pk_mul_f32 v[146:147], v[50:51], v[50:51]
    v_pk_mul_f32 v[148:149], v[52:53], v[52:53]
    v_pk_mul_f32 v[150:151], v[54:55], v[54:55]
    v_pk_mul_f32 v[152:153], v[56:57], v[56:57]
    v_pk_mul_f32 v[154:155], v[58:59], v[58:59]
    v_pk_mul_f32 v[156:157], v[60:61], v[60:61]
    v_pk_mul_f32 v[158:159], v[62:63], v[62:63]
    v_pk_fma_f32 v[144:145], v[144:145], v[182:183], v[180:181]
    v_pk_fma_f32 v[146:147], v[146:147], v[182:183], v[180:181]
    v_pk_fma_f32 v[148:149], v[148:149], v[182:183], v[180:181]
    v_pk_fma_f32 v[150:151], v[150:151], v[182:183], v[180:181]
    v_pk_fma_f32 v[152:153], v[152:153], v[182:183], v[180:181]
    v_pk_fma_f32 v[154:155], v[154:155], v[182:183], v[180:181]
    v_pk_fma_f32 v[156:157], v[156:157], v[182:183], v[180:181]
    v_pk_fma_f32 v[158:159], v[158:159], v[182:183], v[180:181]
    v_pk_mul_f32 v[144:145], v[144:145], v[48:49]
    v_pk_mul_f32 v[146:147], v[146:147], v[50:51]
    v_pk_mul_f32 v[148:149], v[148:149], v[52:53]
    v_pk_mul_f32 v[150:151], v[150:151], v[54:55]
    v_pk_mul_f32 v[152:153], v[152:153], v[56:57]
    v_pk_mul_f32 v[154:155], v[154:155], v[58:59]
    v_pk_mul_f32 v[156:157], v[156:157], v[60:61]
    v_pk_mul_f32 v[158:159], v[158:159], v[62:63]
    v_exp_f32 v144, v144
    v_exp_f32 v145, v145
    v_exp_f32 v146, v146
    v_exp_f32 v147, v147
    v_exp_f32 v148, v148
    v_exp_f32 v149, v149
    v_exp_f32 v150, v150
    v_exp_f32 v151, v151
    v_exp_f32 v152, v152
    v_exp_f32 v153, v153
    v_exp_f32 v154, v154
    v_exp_f32 v155, v155
    v_exp_f32 v156, v156
    v_exp_f32 v157, v157
    v_exp_f32 v158, v158
    v_exp_f32 v159, v159
    v_pk_add_f32 v[144:145], v[144:145], s[0:1]
    v_pk_add_f32 v[146:147], v[146:147], s[0:1]
    v_pk_add_f32 v[148:149], v[148:149], s[0:1]
    v_pk_add_f32 v[150:151], v[150:151], s[0:1]
    v_pk_add_f32 v[152:153], v[152:153], s[0:1]
    v_pk_add_f32 v[154:155], v[154:155], s[0:1]
    v_pk_add_f32 v[156:157], v[156:157], s[0:1]
    v_pk_add_f32 v[158:159], v[158:159], s[0:1]
    v_rcp_f32 v144, v144
    v_rcp_f32 v145, v145
    v_rcp_f32 v146, v146
    v_rcp_f32 v147, v147
    v_rcp_f32 v148, v148
    v_rcp_f32 v149, v149
    v_rcp_f32 v150, v150
    v_rcp_f32 v151, v151
    v_rcp_f32 v152, v152
    v_rcp_f32 v153, v153
    v_rcp_f32 v154, v154
    v_rcp_f32 v155, v155
    v_rcp_f32 v156, v156
    v_rcp_f32 v157, v157
    v_rcp_f32 v158, v158
    v_rcp_f32 v159, v159
    v_pk_mul_f32 v[48:49], v[48:49], v[144:145]
    v_pk_mul_f32 v[50:51], v[50:51], v[146:147]
    v_pk_mul_f32 v[52:53], v[52:53], v[148:149]
    v_pk_mul_f32 v[54:55], v[54:55], v[150:151]
    v_pk_mul_f32 v[56:57], v[56:57], v[152:153]
    v_pk_mul_f32 v[58:59], v[58:59], v[154:155]
    v_pk_mul_f32 v[60:61], v[60:61], v[156:157]
    v_pk_mul_f32 v[62:63], v[62:63], v[158:159]
    v_cvt_pk_bf16_f32 v192, v48, v49
    v_cvt_pk_bf16_f32 v193, v50, v51
    v_cvt_pk_bf16_f32 v194, v52, v53
    v_cvt_pk_bf16_f32 v195, v54, v55
    v_cvt_pk_bf16_f32 v196, v56, v57
    v_cvt_pk_bf16_f32 v197, v58, v59
    v_cvt_pk_bf16_f32 v198, v60, v61
    v_cvt_pk_bf16_f32 v199, v62, v63
    s_waitcnt vmcnt(0)
    s_mul_i32 s70, s70, 256
    s_add_u32 s70, s70, 23592960
    s_mov_b64 exec, 255
    buffer_atomic_add v106, v105, s[28:31], s70 offen sc1
    s_mov_b64 exec, -1
    s_branch L_g2b
L_light:
    s_add_u32 s70, s63, 0
    s_and_b32 s70, s70, 7
    s_lshl_b32 s59, s70, 7
    s_add_u32 m0, s60, 37888
    s_add_u32 s59, s59, s64
    buffer_load_dwordx4 v2, s[36:39], s59 offen offset:0 lds
    buffer_load_dwordx4 v3, s[36:39], s59 offen offset:1024 lds
    buffer_load_dwordx4 v4, s[36:39], s59 offen offset:2048 lds
    buffer_load_dwordx4 v5, s[36:39], s59 offen offset:3072 lds
    s_mul_i32 s71, s70, 196608
    s_add_u32 m0, s69, 70656
    s_add_u32 s59, s71, s66
    buffer_load_dwordx4 v10, s[40:43], s59 offen lds
    s_add_u32 m0, s60, 54272
    s_add_u32 s59, s71, s65
    buffer_load_dwordx4 v6, s[40:43], s59 offen offset:0 lds
    buffer_load_dwordx4 v7, s[40:43], s59 offen offset:2048 lds
    s_mov_b32 s28, s26
    s_mov_b32 s29, s27
    s_mov_b32 s30, 29360128
    s_mov_b32 s31, 0x20000
    v_add_u32 v13, 27648, v12
    v_add_u32 v14, 55296, v12
    v_add_u32 v15, 82944, v12
    v_bfe_u32 v1, v0, 1, 3
    v_lshrrev_b32 v19, 5, v0
    v_xor_b32 v1, v1, v19
    v_lshlrev_b32 v1, 4, v1
    v_and_b32 v19, 31, v0
    v_lshl_add_u32 v1, v19, 7, v1
    v_add_u32 v16, s60, v1
    v_xor_b32 v17, 32, v16
    v_xor_b32 v18, 64, v16
    v_xor_b32 v19, 96, v16
    v_lshrrev_b32 v1, 5, v0
    v_lshlrev_b32 v20, 11, v1
    v_bfe_u32 v1, v0, 2, 2
    v_lshl_add_u32 v20, v1, 7, v20
    v_bfe_u32 v1, v0, 3, 1
    v_lshl_add_u32 v20, v1, 6, v20
    v_bfe_u32 v1, v0, 4, 1
    v_lshl_add_u32 v20, v1, 5, v20
    v_and_b32 v1, 3, v0
    v_lshl_add_u32 v20, v1, 3, v20
    v_add_u32 v20, 17408, v20
    v_xor_b32 v21, 64, v20
    s_mov_b32 s48, s20
    s_mov_b32 s49, s21
    s_mov_b32 s50, 1024
    s_mov_b32 s51, 0x20000
    v_lshlrev_b32 v24, 4, v0
    s_lshl_b32 s59, s63, 7
    v_add_u32 v25, s59, v24
    v_and_b32 v25, 1023, v25
    v_lshrrev_b32 v1, 5, v0
    s_add_u32 s59, s69, 148480
    v_lshl_add_u32 v28, v1, 4, s59
    s_add_u32 m0, s69, 148480
    s_nop 0
    buffer_load_dwordx4 v25, s[48:51], 0 offen lds
    s_add_u32 s70, s63, 1
    s_and_b32 s70, s70, 7
    s_lshl_b32 s59, s70, 7
    s_add_u32 m0, s60, 74752
    s_add_u32 s59, s59, s64
    buffer_load_dwordx4 v2, s[36:39], s59 offen offset:0 lds
    buffer_load_dwordx4 v3, s[36:39], s59 offen offset:1024 lds
    buffer_load_dwordx4 v4, s[36:39], s59 offen offset:2048 lds
    buffer_load_dwordx4 v5, s[36:39], s59 offen offset:3072 lds
    s_mul_i32 s71, s70, 196608
    s_add_u32 m0, s69, 107520
    s_add_u32 s59, s71, s66
    buffer_load_dwordx4 v10, s[40:43], s59 offen lds
    s_waitcnt vmcnt(5)
    s_barrier
    ds_read_b128 v[128:131], v16 offset:37888
    ds_read_b128 v[32:35], v28 offset:0
    s_add_u32 m0, s60, 91136
    s_add_u32 s59, s71, s65
    buffer_load_dwordx4 v6, s[40:43], s59 offen offset:0 lds
    buffer_load_dwordx4 v7, s[40:43], s59 offen offset:2048 lds
    s_waitcnt lgkmcnt(0)
    v_mfma_f32_32x32x16_bf16 v[64:79], v[32:35], v[128:131], 0
    ds_read_b128 v[132:135], v17 offset:37888
    ds_read_b128 v[40:43], v28 offset:32
    s_add_u32 s70, s63, 2
    s_and_b32 s70, s70, 7
    s_lshl_b32 s59, s70, 7
    s_add_u32 m0, s60, 111616
    s_add_u32 s59, s59, s64
    buffer_load_dwordx4 v2, s[36:39], s59 offen offset:0 lds
    buffer_load_dwordx4 v3, s[36:39], s59 offen offset:1024 lds
    buffer_load_dwordx4 v4, s[36:39], s59 offen offset:2048 lds
    buffer_load_dwordx4 v5, s[36:39], s59 offen offset:3072 lds
    s_mul_i32 s71, s70, 196608
    s_add_u32 m0, s69, 144384
    s_add_u32 s59, s71, s66
    buffer_load_dwordx4 v10, s[40:43], s59 offen lds
    s_lshr_b32 s76, s52, 1
    s_lshl_b32 s76, s76, 3
    s_and_b32 s88, s53, 7
    s_add_u32 s76, s76, s88
    s_and_b32 s77, s52, 1
    s_lshl_b32 s77, s77, 2
    s_lshr_b32 s88, s53, 3
    s_add_u32 s77, s77, s88
    s_waitcnt lgkmcnt(0)
    v_mfma_f32_32x32x16_bf16 v[64:79], v[40:43], v[132:135], v[64:79]
    ds_read_b128 v[136:139], v18 offset:37888
    ds_read_b128 v[32:35], v28 offset:64
    s_add_u32 m0, s60, 128000
    s_add_u32 s59, s71, s65
    buffer_load_dwordx4 v6, s[40:43], s59 offen offset:0 lds
    buffer_load_dwordx4 v7, s[40:43], s59 offen offset:2048 lds
    s_lshl_b32 s93, s88, 1
    s_mov_b32 s93, 0
    s_and_b32 s88, s77, 1
    s_lshl_b32 s74, s76, 1
    s_add_u32 s74, s74, s88
    s_xor_b32 s75, s74, 1
    s_lshl_b32 s88, s57, 10
    s_lshl_b32 s74, s74, 17
    s_waitcnt lgkmcnt(0)
    v_mfma_f32_32x32x16_bf16 v[64:79], v[32:35], v[136:139], v[64:79]
    ds_read_b128 v[140:143], v19 offset:37888
    ds_read_b128 v[40:43], v28 offset:96
    s_add_u32 s74, s74, s88
    s_lshl_b32 s75, s75, 17
    s_add_u32 s75, s75, s88
    s_lshl_b32 s72, s57, 13
    s_add_u32 s72, s72, 0x20000
    s_add_u32 s73, s72, 4096
    s_mov_b32 s32, s14
    s_mov_b32 s33, s15
    s_waitcnt lgkmcnt(0)
    v_mfma_f32_32x32x16_bf16 v[64:79], v[40:43], v[140:143], v[64:79]
    s_waitcnt vmcnt(7)
    s_barrier
    v_add_u32 v16, 74752, v16
    v_add_u32 v17, 74752, v17
    v_add_u32 v18, 74752, v18
    v_add_u32 v19, 74752, v19
    v_add_u32 v20, 74752, v20
    v_add_u32 v21, 74752, v21
    ds_read_b128 v[144:147], v16 offset:0
    ds_read_b128 v[32:35], v28 offset:128
    s_add_u32 s70, s63, 3
    s_and_b32 s70, s70, 7
    s_lshl_b32 s59, s70, 7
    s_add_u32 m0, s60, 1024
    s_add_u32 s59, s59, s64
    buffer_load_dwordx4 v2, s[36:39], s59 offen offset:0 lds
    buffer_load_dwordx4 v3, s[36:39], s59 offen offset:1024 lds
    s_mov_b32 s34, 8388608
    s_mov_b32 s35, 0x20000
    v_lshrrev_b32 v1, 4, v0
    v_and_b32 v111, 7, v0
    v_xor_b32 v111, v111, v1
    v_lshrrev_b32 v1, 3, v0
    v_lshlrev_b32 v1, 12, v1
    v_lshl_add_u32 v108, v111, 4, v1
    s_waitcnt lgkmcnt(0)
    v_mfma_f32_32x32x16_bf16 v[64:79], v[32:35], v[144:147], v[64:79]
    ds_read_b128 v[148:151], v17 offset:0
    ds_read_b128 v[40:43], v28 offset:160
    buffer_load_dwordx4 v4, s[36:39], s59 offen offset:2048 lds
    buffer_load_dwordx4 v5, s[36:39], s59 offen offset:3072 lds
    s_mul_i32 s71, s70, 196608
    s_add_u32 m0, s69, 33792
    s_add_u32 s59, s71, s66
    buffer_load_dwordx4 v10, s[40:43], s59 offen lds
    v_xor_b32 v109, 64, v108
    v_add_u32 v109, 31744, v109
    v_add_u32 v110, 63488, v108
    v_add_u32 v111, 63488, v109
    s_waitcnt lgkmcnt(0)
    v_mfma_f32_32x32x16_bf16 v[64:79], v[40:43], v[148:151], v[64:79]
    ds_read_b128 v[152:155], v18 offset:0
    ds_read_b128 v[32:35], v28 offset:192
    s_add_u32 m0, s60, 17408
    s_add_u32 s59, s71, s65
    buffer_load_dwordx4 v6, s[40:43], s59 offen offset:0 lds
    buffer_load_dwordx4 v7, s[40:43], s59 offen offset:2048 lds
    s_waitcnt lgkmcnt(0)
    v_mfma_f32_32x32x16_bf16 v[64:79], v[32:35], v[152:155], v[64:79]
    ds_read_b128 v[156:159], v19 offset:0
    ds_read_b128 v[40:43], v28 offset:224
    s_waitcnt lgkmcnt(0)
    v_mfma_f32_32x32x16_bf16 v[64:79], v[40:43], v[156:159], v[64:79]
    s_waitcnt vmcnt(7)
    s_barrier
    ds_read_b128 v[160:163], v16 offset:36864
    ds_read_b128 v[32:35], v28 offset:256
    s_add_u32 s70, s63, 4
    s_and_b32 s70, s70, 7
    s_lshl_b32 s59, s70, 7
    s_add_u32 m0, s60, 37888
    s_add_u32 s59, s59, s64
    buffer_load_dwordx4 v2, s[36:39], s59 offen offset:0 lds
    buffer_load_dwordx4 v3, s[36:39], s59 offen offset:1024 lds
    s_waitcnt lgkmcnt(0)
    v_mfma_f32_32x32x16_bf16 v[64:79], v[32:35], v[160:163], v[64:79]
    ds_read_b128 v[164:167], v17 offset:36864
    ds_read_b128 v[40:43], v28 offset:288
    buffer_load_dwordx4 v4, s[36:39], s59 offen offset:2048 lds
    buffer_load_dwordx4 v5, s[36:39], s59 offen offset:3072 lds
    s_mul_i32 s71, s70, 196608
    s_add_u32 m0, s69, 70656
    s_add_u32 s59, s71, s66
    buffer_load_dwordx4 v10, s[40:43], s59 offen lds
    s_waitcnt lgkmcnt(0)
    v_mfma_f32_32x32x16_bf16 v[64:79], v[40:43], v[164:167], v[64:79]
    ds_read_b128 v[168:171], v18 offset:36864
    ds_read_b128 v[32:35], v28 offset:320
    s_add_u32 m0, s60, 54272
    s_add_u32 s59, s71, s65
    buffer_load_dwordx4 v6, s[40:43], s59 offen offset:0 lds
    buffer_load_dwordx4 v7, s[40:43], s59 offen offset:2048 lds
    s_waitcnt lgkmcnt(0)
    v_mfma_f32_32x32x16_bf16 v[64:79], v[32:35], v[168:171], v[64:79]
    ds_read_b128 v[172:175], v19 offset:36864
    ds_read_b128 v[40:43], v28 offset:352
    s_waitcnt lgkmcnt(0)
    v_mfma_f32_32x32x16_bf16 v[64:79], v[40:43], v[172:175], v[64:79]
    s_waitcnt vmcnt(7)
    s_barrier
    v_add_u32 v16, 4294893568, v16
    v_add_u32 v17, 4294893568, v17
    v_add_u32 v18, 4294893568, v18
    v_add_u32 v19, 4294893568, v19
    v_add_u32 v20, 4294893568, v20
    v_add_u32 v21, 4294893568, v21
    ds_read_b128 v[176:179], v16 offset:0
    ds_read_b128 v[32:35], v28 offset:384
    s_add_u32 s70, s63, 5
    s_and_b32 s70, s70, 7
    s_lshl_b32 s59, s70, 7
    s_add_u32 m0, s60, 74752
    s_add_u32 s59, s59, s64
    buffer_load_dwordx4 v2, s[36:39], s59 offen offset:0 lds
    buffer_load_dwordx4 v3, s[36:39], s59 offen offset:1024 lds
    s_waitcnt lgkmcnt(0)
    v_mfma_f32_32x32x16_bf16 v[64:79], v[32:35], v[176:179], v[64:79]
    ds_read_b128 v[180:183], v17 offset:0
    ds_read_b128 v[40:43], v28 offset:416
    buffer_load_dwordx4 v4, s[36:39], s59 offen offset:2048 lds
    buffer_load_dwordx4 v5, s[36:39], s59 offen offset:3072 lds
    s_mul_i32 s71, s70, 196608
    s_add_u32 m0, s69, 107520
    s_add_u32 s59, s71, s66
    buffer_load_dwordx4 v10, s[40:43], s59 offen lds
    s_waitcnt lgkmcnt(0)
    v_mfma_f32_32x32x16_bf16 v[64:79], v[40:43], v[180:183], v[64:79]
    ds_read_b128 v[184:187], v18 offset:0
    ds_read_b128 v[32:35], v28 offset:448
    s_add_u32 m0, s60, 91136
    s_add_u32 s59, s71, s65
    buffer_load_dwordx4 v6, s[40:43], s59 offen offset:0 lds
    buffer_load_dwordx4 v7, s[40:43], s59 offen offset:2048 lds
    s_waitcnt lgkmcnt(0)
    v_mfma_f32_32x32x16_bf16 v[64:79], v[32:35], v[184:187], v[64:79]
    ds_read_b128 v[188:191], v19 offset:0
    ds_read_b128 v[40:43], v28 offset:480
    s_waitcnt lgkmcnt(0)
    v_mfma_f32_32x32x16_bf16 v[64:79], v[40:43], v[188:191], v[64:79]
    s_waitcnt vmcnt(7)
    s_barrier
    ds_read_b128 v[192:195], v16 offset:36864
    ds_read_b128 v[32:35], v28 offset:512
    s_add_u32 s70, s63, 6
    s_and_b32 s70, s70, 7
    s_lshl_b32 s59, s70, 7
    s_add_u32 m0, s60, 111616
    s_add_u32 s59, s59, s64
    buffer_load_dwordx4 v2, s[36:39], s59 offen offset:0 lds
    buffer_load_dwordx4 v3, s[36:39], s59 offen offset:1024 lds
    s_waitcnt lgkmcnt(0)
    v_mfma_f32_32x32x16_bf16 v[64:79], v[32:35], v[192:195], v[64:79]
    ds_read_b128 v[196:199], v17 offset:36864
    ds_read_b128 v[40:43], v28 offset:544
    buffer_load_dwordx4 v4, s[36:39], s59 offen offset:2048 lds
    buffer_load_dwordx4 v5, s[36:39], s59 offen offset:3072 lds
    s_mul_i32 s71, s70, 196608
    s_add_u32 m0, s69, 144384
    s_add_u32 s59, s71, s66
    buffer_load_dwordx4 v10, s[40:43], s59 offen lds
    s_waitcnt lgkmcnt(0)
    v_mfma_f32_32x32x16_bf16 v[64:79], v[40:43], v[196:199], v[64:79]
    ds_read_b128 v[200:203], v18 offset:36864
    ds_read_b128 v[32:35], v28 offset:576
    s_add_u32 m0, s60, 128000
    s_add_u32 s59, s71, s65
    buffer_load_dwordx4 v6, s[40:43], s59 offen offset:0 lds
    buffer_load_dwordx4 v7, s[40:43], s59 offen offset:2048 lds
    s_waitcnt lgkmcnt(0)
    v_mfma_f32_32x32x16_bf16 v[64:79], v[32:35], v[200:203], v[64:79]
    ds_read_b128 v[204:207], v19 offset:36864
    ds_read_b128 v[40:43], v28 offset:608
    s_waitcnt lgkmcnt(0)
    v_mfma_f32_32x32x16_bf16 v[64:79], v[40:43], v[204:207], v[64:79]
    s_waitcnt vmcnt(7)
    s_barrier
    v_add_u32 v16, 73728, v16
    v_add_u32 v17, 73728, v17
    v_add_u32 v18, 73728, v18
    v_add_u32 v19, 73728, v19
    v_add_u32 v20, 73728, v20
    v_add_u32 v21, 73728, v21
    ds_read_b128 v[208:211], v16 offset:0
    ds_read_b128 v[32:35], v28 offset:640
    s_add_u32 s70, s63, 7
    s_and_b32 s70, s70, 7
    s_lshl_b32 s59, s70, 7
    s_add_u32 m0, s60, 1024
    s_add_u32 s59, s59, s64
    buffer_load_dwordx4 v2, s[36:39], s59 offen offset:0 lds
    buffer_load_dwordx4 v3, s[36:39], s59 offen offset:1024 lds
    s_waitcnt lgkmcnt(0)
    v_mfma_f32_32x32x16_bf16 v[64:79], v[32:35], v[208:211], v[64:79]
    ds_read_b128 v[212:215], v17 offset:0
    ds_read_b128 v[40:43], v28 offset:672
    buffer_load_dwordx4 v4, s[36:39], s59 offen offset:2048 lds
    buffer_load_dwordx4 v5, s[36:39], s59 offen offset:3072 lds
    s_mul_i32 s71, s70, 196608
    s_add_u32 m0, s69, 33792
    s_add_u32 s59, s71, s66
    buffer_load_dwordx4 v10, s[40:43], s59 offen lds
    s_waitcnt lgkmcnt(0)
    v_mfma_f32_32x32x16_bf16 v[64:79], v[40:43], v[212:215], v[64:79]
    ds_read_b128 v[216:219], v18 offset:0
    ds_read_b128 v[32:35], v28 offset:704
    s_add_u32 m0, s60, 17408
    s_add_u32 s59, s71, s65
    buffer_load_dwordx4 v6, s[40:43], s59 offen offset:0 lds
    buffer_load_dwordx4 v7, s[40:43], s59 offen offset:2048 lds
    s_waitcnt lgkmcnt(0)
    v_mfma_f32_32x32x16_bf16 v[64:79], v[32:35], v[216:219], v[64:79]
    ds_read_b128 v[220:223], v19 offset:0
    ds_read_b128 v[40:43], v28 offset:736
    s_waitcnt lgkmcnt(0)
    v_mfma_f32_32x32x16_bf16 v[64:79], v[40:43], v[220:223], v[64:79]
    s_waitcnt vmcnt(7)
    s_barrier
    ds_read_b128 v[224:227], v16 offset:36864
    ds_read_b128 v[32:35], v28 offset:768
    s_waitcnt lgkmcnt(0)
    v_mfma_f32_32x32x16_bf16 v[64:79], v[32:35], v[224:227], v[64:79]
    ds_read_b128 v[228:231], v17 offset:36864
    ds_read_b128 v[40:43], v28 offset:800
    s_waitcnt lgkmcnt(0)
    v_mfma_f32_32x32x16_bf16 v[64:79], v[40:43], v[228:231], v[64:79]
    ds_read_b128 v[232:235], v18 offset:36864
    ds_read_b128 v[32:35], v28 offset:832
    s_waitcnt lgkmcnt(0)
    v_mfma_f32_32x32x16_bf16 v[64:79], v[32:35], v[232:235], v[64:79]
    ds_read_b128 v[236:239], v19 offset:36864
    ds_read_b128 v[40:43], v28 offset:864
    s_waitcnt lgkmcnt(0)
    v_mfma_f32_32x32x16_bf16 v[64:79], v[40:43], v[236:239], v[64:79]
    s_waitcnt vmcnt(0)
    s_barrier
    v_add_u32 v16, 4294893568, v16
    v_add_u32 v17, 4294893568, v17
    v_add_u32 v18, 4294893568, v18
    v_add_u32 v19, 4294893568, v19
    v_add_u32 v20, 4294893568, v20
    v_add_u32 v21, 4294893568, v21
    ds_read_b128 v[240:243], v16 offset:0
    ds_read_b128 v[32:35], v28 offset:896
    s_waitcnt lgkmcnt(0)
    v_mfma_f32_32x32x16_bf16 v[64:79], v[32:35], v[240:243], v[64:79]
    ds_read_b128 v[244:247], v17 offset:0
    ds_read_b128 v[40:43], v28 offset:928
    s_waitcnt lgkmcnt(0)
    v_mfma_f32_32x32x16_bf16 v[64:79], v[40:43], v[244:247], v[64:79]
    ds_read_b128 v[248:251], v18 offset:0
    ds_read_b128 v[32:35], v28 offset:960
    s_waitcnt lgkmcnt(0)
    v_mfma_f32_32x32x16_bf16 v[64:79], v[32:35], v[248:251], v[64:79]
    ds_read_b128 v[252:255], v19 offset:0
    ds_read_b128 v[40:43], v28 offset:992
    s_waitcnt lgkmcnt(0)
    v_mfma_f32_32x32x16_bf16 v[64:79], v[40:43], v[252:255], v[64:79]
    v_lshlrev_b32 v96, 4, v0
    s_nop 7
    s_nop 2
    v_mul_f32 v4, 0xbfb8aa3b, v64
    v_exp_f32 v4, v4
    v_and_b32 v5, 31, v0
    v_add_f32 v4, 1.0, v4
    v_rcp_f32 v4, v4
    v_lshlrev_b32 v5, 2, v5
    v_and_b32 v4, 0x7fffffff, v4
    s_lshl_b32 s59, s57, 2
    v_mov_b32 v22, s59
    v_mov_b32 v23, 0
    v_mov_b32 v24, 1
    ds_write_b32 v22, v24 offset:176
    s_setprio 2
    s_mov_b32 s91, 65536
L_bz3:
    ds_read_b128 v[48:51], v23 offset:176
    s_waitcnt lgkmcnt(0)
    v_and_b32 v48, v48, v49
    v_and_b32 v50, v50, v51
    v_and_b32 v48, v48, v50
    s_sub_u32 s91, s91, 1
    v_readfirstlane_b32 s3, v48
    s_cbranch_scc1 L_bz3d
    s_cmp_lg_u32 s3, 0
    s_cbranch_scc1 L_bz3d
    s_sleep 2
    s_branch L_bz3
L_bz3d:
    s_mov_b32 s91, 65536
L_bz4:
    ds_read_b128 v[48:51], v23 offset:192
    s_waitcnt lgkmcnt(0)
    v_and_b32 v48, v48, v49
    v_and_b32 v50, v50, v51
    v_and_b32 v48, v48, v50
    s_sub_u32 s91, s91, 1
    v_readfirstlane_b32 s3, v48
    s_cbranch_scc1 L_bz4d
    s_cmp_lg_u32 s3, 0
    s_cbranch_scc1 L_bz4d
    s_sleep 2
    s_branch L_bz4
L_bz4d:
    s_bitcmp1_b32 s52, 0
    s_cbranch_scc1 L_nog
    s_lshl_b32 s59, s58, 7
    s_add_u32 s59, s59, 23068672
    buffer_store_dword v4, v5, s[28:31], s59 offen sc1
L_nog:
    s_add_u32 s3, s93, 0
    s_and_b32 s3, s3, 7
    s_lshl_b32 s3, s3, 7
    s_mov_b32 m0, s72
    s_add_u32 s59, s3, s74
    buffer_load_dwordx4 v108, s[32:35], s59 offen offset:0 lds
    buffer_load_dwordx4 v109, s[32:35], s59 offen offset:1024 lds
    buffer_load_dwordx4 v110, s[32:35], s59 offen offset:2048 lds
    buffer_load_dwordx4 v111, s[32:35], s59 offen offset:3072 lds
    s_add_u32 s3, s93, 0
    s_and_b32 s3, s3, 7
    s_lshl_b32 s3, s3, 7
    s_mov_b32 m0, s73
    s_add_u32 s59, s3, s75
    buffer_load_dwordx4 v108, s[32:35], s59 offen offset:0 lds
    buffer_load_dwordx4 v109, s[32:35], s59 offen offset:1024 lds
    buffer_load_dwordx4 v110, s[32:35], s59 offen offset:2048 lds
    buffer_load_dwordx4 v111, s[32:35], s59 offen offset:3072 lds
    s_mov_b32 s54, s76
    s_mov_b32 s55, s77
    s_and_b32 s58, s55, 1
    s_lshl_b32 s60, s54, 1
    s_add_u32 s60, s60, s58
    s_xor_b32 s61, s60, 1
    s_lshr_b32 s59, s55, 1
    s_mul_i32 s59, s59, 7
    s_add_u32 s65, s59, 3
    s_lshl_b32 s62, s58, 2
    s_add_u32 s62, s62, s59
    s_add_u32 s63, s62, 1
    s_add_u32 s64, s62, 2
    s_lshl_b32 s59, s57, 15
    s_add_u32 s59, s59, 10485760
    s_lshl_b32 s66, s62, 17
    s_add_u32 s66, s66, s59
    s_lshl_b32 s67, s63, 17
    s_add_u32 s67, s67, s59
    s_lshl_b32 s68, s64, 17
    s_add_u32 s68, s68, s59
    s_lshl_b32 s69, s65, 17
    s_add_u32 s69, s69, s59
    s_mov_b32 s40, s16
    s_mov_b32 s41, s17
    s_mov_b32 s42, 4096
    s_mov_b32 s43, 0x20000
    v_lshlrev_b32 v1, 4, v0
    v_mov_b32 v2, v108
    v_mov_b32 v3, v109
    v_mov_b32 v4, v110
    v_mov_b32 v5, v111
    v_bfe_u32 v10, v0, 1, 3
    v_lshrrev_b32 v9, 5, v0
    v_xor_b32 v10, v10, v9
    v_lshlrev_b32 v10, 4, v10
    v_and_b32 v9, 31, v0
    v_lshl_add_u32 v10, v9, 7, v10
    v_add_u32 v6, s72, v10
    v_xor_b32 v7, 32, v6
    v_xor_b32 v8, 64, v6
    v_xor_b32 v9, 96, v6
    v_mov_b32 v14, 0
    v_mov_b32 v15, 1
    s_lshl_b32 s59, s57, 2
    s_add_u32 s59, s59, 32
    v_mov_b32 v13, s59
    v_lshrrev_b32 v10, 4, v0
    s_lshr_b32 s59, s62, 1
    v_mov_b32 v18, s59
    s_lshr_b32 s59, s64, 1
    v_mov_b32 v16, s59
    v_cmp_eq_u32 vcc, 1, v10
    s_lshr_b32 s59, s65, 1
    v_mov_b32 v17, s59
    v_cndmask_b32 v18, v18, v16, vcc
    v_cmp_eq_u32 vcc, 2, v10
    s_lshl_b32 s59, s57, 3
    s_and_b32 s3, s53, 7
    v_cndmask_b32 v18, v18, v17, vcc
    s_add_u32 s59, s59, s3
    v_lshl_add_u32 v10, v18, 5, s59
    v_mul_u32_u24 v10, 256, v10
    v_add_u32 v10, 98304, v10
    v_and_b32 v16, 3, v0
    s_lshr_b32 s59, s54, 1
    s_add_u32 s59, s59, 1024
    v_lshl_add_u32 v12, v18, 4, s59
    s_lshl_b32 s38, s52, 2
    s_and_b32 s59, s53, 3
    s_add_u32 s38, s38, s59
    s_lshr_b32 s39, s53, 2
    s_lshl_b32 s59, s39, 4
    s_add_u32 s59, s59, 848
    v_cmp_lt_u32 vcc, 47, v0
    v_add_u32 v17, s59, v0
    s_nop 0
    v_cndmask_b32 v12, v12, v17, vcc
    v_mul_u32_u24 v12, 256, v12
    s_lshl_b32 s48, s39, 1
    s_and_b32 s59, s57, 1
    s_add_u32 s48, s48, s59
    s_xor_b32 s49, s48, 1
    s_mul_i32 s59, s57, 14336
    s_add_u32 s59, s59, 21004288
    s_mul_i32 s48, s48, 90112
    s_add_u32 s48, s48, s59
    s_mul_i32 s49, s49, 90112
    s_add_u32 s49, s49, s59
    s_mul_i32 s59, s60, 28
    s_add_u32 s59, s59, s62
    s_lshl_b32 s59, s59, 11
    s_add_u32 s76, s59, 6291456
    s_mul_i32 s59, s60, 44
    s_add_u32 s59, s59, s62
    s_lshl_b32 s59, s59, 11
    s_add_u32 s83, s59, 14712832
    s_mul_i32 s59, s60, 28
    s_add_u32 s59, s59, s63
    s_lshl_b32 s59, s59, 11
    s_add_u32 s77, s59, 6291456
    s_mul_i32 s59, s60, 44
    s_add_u32 s59, s59, s63
    s_lshl_b32 s59, s59, 11
    s_add_u32 s84, s59, 14712832
    s_mul_i32 s59, s60, 28
    s_add_u32 s59, s59, s64
    s_lshl_b32 s59, s59, 11
    s_add_u32 s78, s59, 6291456
    s_mul_i32 s59, s60, 44
    s_add_u32 s59, s59, s64
    s_lshl_b32 s59, s59, 11
    s_add_u32 s85, s59, 14712832
    s_mul_i32 s59, s60, 28
    s_add_u32 s59, s59, s65
    s_lshl_b32 s59, s59, 11
    s_add_u32 s79, s59, 6291456
    s_mul_i32 s59, s60, 44
    s_add_u32 s59, s59, s65
    s_lshl_b32 s59, s59, 11
    s_add_u32 s86, s59, 14712832
    s_mul_i32 s59, s61, 28
    s_add_u32 s59, s59, s62
    s_lshl_b32 s59, s59, 11
    s_add_u32 s80, s59, 6291456
    s_mul_i32 s59, s61, 44
    s_add_u32 s59, s59, s62
    s_lshl_b32 s59, s59, 11
    s_add_u32 s87, s59, 14712832
    s_mul_i32 s59, s61, 28
    s_add_u32 s59, s59, s63
    s_lshl_b32 s59, s59, 11
    s_add_u32 s81, s59, 6291456
    s_mul_i32 s59, s61, 44
    s_add_u32 s59, s59, s63
    s_lshl_b32 s59, s59, 11
    s_add_u32 s88, s59, 14712832
    s_mul_i32 s59, s61, 28
    s_add_u32 s59, s59, s64
    s_lshl_b32 s59, s59, 11
    s_add_u32 s82, s59, 6291456
    s_mul_i32 s59, s61, 44
    s_add_u32 s59, s59, s64
    s_lshl_b32 s59, s59, 11
    s_add_u32 s89, s59, 14712832
    s_lshl_b32 s59, s52, 2
    s_lshr_b32 s71, s53, 3
    s_add_u32 s59, s59, s71
    s_lshl_b32 s71, s59, 17
    s_lshl_b32 s92, s57, 11
    s_add_u32 s71, s71, s92
    s_add_u32 s71, s71, 2097152
    s_and_b32 s58, s53, 0
    s_lshl_b32 s58, s58, 14
    ds_write_b32 v13, v15 offset:128
    s_mov_b32 s36, 29360128
    s_add_u32 s37, s2, 1280
    s_waitcnt vmcnt(0)
L_g2b:
    ds_read_b128 v[16:19], v6 offset:0
    ds_read_b128 v[32:35], v6 offset:4096
    ds_read_b128 v[20:23], v7 offset:0
    ds_read_b128 v[36:39], v7 offset:4096
    ds_read_b128 v[24:27], v8 offset:0
    ds_read_b128 v[40:43], v8 offset:4096
    ds_read_b128 v[28:31], v9 offset:0
    ds_read_b128 v[44:47], v9 offset:4096
    s_mov_b32 s91, 65536
L_sc1:
    ds_read_b128 v[224:227], v14 offset:208
    s_waitcnt lgkmcnt(0)
    v_and_b32 v224, v224, v225
    v_and_b32 v226, v226, v227
    v_and_b32 v224, v224, v226
    s_sub_u32 s91, s91, 1
    v_readfirstlane_b32 s3, v224
    s_cbranch_scc1 L_sc1d
    s_cmp_lg_u32 s3, 0
    s_cbranch_scc1 L_sc1d
    s_sleep 2
    s_branch L_sc1
L_sc1d:
    s_mov_b32 s91, 65536
L_sc2:
    ds_read_b128 v[224:227], v14 offset:160
    s_waitcnt lgkmcnt(0)
    v_and_b32 v224, v224, v225
    v_and_b32 v226, v226, v227
    v_and_b32 v224, v224, v226
    s_sub_u32 s91, s91, 1
    v_readfirstlane_b32 s3, v224
    s_cbranch_scc1 L_sc2d
    s_cmp_lg_u32 s3, 0
    s_cbranch_scc1 L_sc2d
    s_sleep 2
    s_branch L_sc2
L_sc2d:
    s_add_u32 m0, s92, 32768
    s_add_u32 s59, s58, 32768
    s_and_b32 s59, s59, 0x1ffff
    s_add_u32 s59, s59, s71
    buffer_load_dwordx4 v1, s[28:31], s59 offen sc1 lds
    buffer_load_dwordx4 v1, s[28:31], s59 offen offset:1024 sc1 lds
    s_add_u32 m0, s92, 40960
    s_add_u32 s59, s58, 40960
    s_and_b32 s59, s59, 0x1ffff
    s_add_u32 s59, s59, s71
    buffer_load_dwordx4 v1, s[28:31], s59 offen sc1 lds
    buffer_load_dwordx4 v1, s[28:31], s59 offen offset:1024 sc1 lds
    s_add_u32 m0, s92, 49152
    s_add_u32 s59, s58, 49152
    s_and_b32 s59, s59, 0x1ffff
    s_add_u32 s59, s59, s71
    buffer_load_dwordx4 v1, s[28:31], s59 offen sc1 lds
    buffer_load_dwordx4 v1, s[28:31], s59 offen offset:1024 sc1 lds
    s_add_u32 m0, s92, 57344
    s_add_u32 s59, s58, 57344
    s_and_b32 s59, s59, 0x1ffff
    s_add_u32 s59, s59, s71
    buffer_load_dwordx4 v1, s[28:31], s59 offen sc1 lds
    buffer_load_dwordx4 v1, s[28:31], s59 offen offset:1024 sc1 lds
    s_add_u32 s3, s93, 1
    s_and_b32 s3, s3, 7
    s_lshl_b32 s3, s3, 7
    s_mov_b32 m0, s72
    s_add_u32 s59, s3, s74
    buffer_load_dwordx4 v2, s[32:35], s59 offen offset:0 lds
    buffer_load_dwordx4 v3, s[32:35], s59 offen offset:1024 lds
    buffer_load_dwordx4 v4, s[32:35], s59 offen offset:2048 lds
    buffer_load_dwordx4 v5, s[32:35], s59 offen offset:3072 lds
    s_add_u32 s3, s93, 1
    s_and_b32 s3, s3, 7
    s_lshl_b32 s3, s3, 7
    s_mov_b32 m0, s73
    s_add_u32 s59, s3, s75
    buffer_load_dwordx4 v2, s[32:35], s59 offen offset:0 lds
    buffer_load_dwordx4 v3, s[32:35], s59 offen offset:1024 lds
    buffer_load_dwordx4 v4, s[32:35], s59 offen offset:2048 lds
    buffer_load_dwordx4 v5, s[32:35], s59 offen offset:3072 lds
    s_mov_b32 s50, 0x10001
    s_mov_b32 s51, 1
    s_mov_b64 exec, s[50:51]
    v_mov_b32 v252, 0
    buffer_atomic_add v252, v10, s[28:31], s90 offen sc0 sc1
    s_mov_b64 exec, -1
    s_cmp_eq_u32 s36, 29360128
    s_cbranch_scc1 L_nog1
    v_pk_mul_f32 v[144:145], v[112:113], v[112:113]
    v_pk_mul_f32 v[146:147], v[114:115], v[114:115]
    v_pk_mul_f32 v[148:149], v[116:117], v[116:117]
    v_pk_mul_f32 v[150:151], v[118:119], v[118:119]
    v_pk_mul_f32 v[152:153], v[120:121], v[120:121]
    v_pk_mul_f32 v[154:155], v[122:123], v[122:123]
    v_pk_mul_f32 v[156:157], v[124:125], v[124:125]
    v_pk_mul_f32 v[158:159], v[126:127], v[126:127]
    v_pk_fma_f32 v[144:145], v[144:145], v[182:183], v[180:181]
    v_pk_fma_f32 v[146:147], v[146:147], v[182:183], v[180:181]
    v_pk_fma_f32 v[148:149], v[148:149], v[182:183], v[180:181]
    v_pk_fma_f32 v[150:151], v[150:151], v[182:183], v[180:181]
    v_pk_fma_f32 v[152:153], v[152:153], v[182:183], v[180:181]
    v_pk_fma_f32 v[154:155], v[154:155], v[182:183], v[180:181]
    v_pk_fma_f32 v[156:157], v[156:157], v[182:183], v[180:181]
    v_pk_fma_f32 v[158:159], v[158:159], v[182:183], v[180:181]
    v_pk_mul_f32 v[144:145], v[144:145], v[112:113]
    v_pk_mul_f32 v[146:147], v[146:147], v[114:115]
    v_pk_mul_f32 v[148:149], v[148:149], v[116:117]
    v_pk_mul_f32 v[150:151], v[150:151], v[118:119]
    v_pk_mul_f32 v[152:153], v[152:153], v[120:121]
    v_pk_mul_f32 v[154:155], v[154:155], v[122:123]
    v_pk_mul_f32 v[156:157], v[156:157], v[124:125]
    v_pk_mul_f32 v[158:159], v[158:159], v[126:127]
    v_exp_f32 v144, v144
    v_exp_f32 v145, v145
    v_exp_f32 v146, v146
    v_exp_f32 v147, v147
    v_exp_f32 v148, v148
    v_exp_f32 v149, v149
    v_exp_f32 v150, v150
    v_exp_f32 v151, v151
    v_exp_f32 v152, v152
    v_exp_f32 v153, v153
    v_exp_f32 v154, v154
    v_exp_f32 v155, v155
    v_exp_f32 v156, v156
    v_exp_f32 v157, v157
    v_exp_f32 v158, v158
    v_exp_f32 v159, v159
    v_pk_add_f32 v[144:145], v[144:145], s[0:1]
    v_pk_add_f32 v[146:147], v[146:147], s[0:1]
    v_pk_add_f32 v[148:149], v[148:149], s[0:1]
    v_pk_add_f32 v[150:151], v[150:151], s[0:1]
    v_pk_add_f32 v[152:153], v[152:153], s[0:1]
    v_pk_add_f32 v[154:155], v[154:155], s[0:1]
    v_pk_add_f32 v[156:157], v[156:157], s[0:1]
    v_pk_add_f32 v[158:159], v[158:159], s[0:1]
    v_rcp_f32 v144, v144
    v_rcp_f32 v145, v145
    v_rcp_f32 v146, v146
    v_rcp_f32 v147, v147
    v_rcp_f32 v148, v148
    v_rcp_f32 v149, v149
    v_rcp_f32 v150, v150
    v_rcp_f32 v151, v151
    v_rcp_f32 v152, v152
    v_rcp_f32 v153, v153
    v_rcp_f32 v154, v154
    v_rcp_f32 v155, v155
    v_rcp_f32 v156, v156
    v_rcp_f32 v157, v157
    v_rcp_f32 v158, v158
    v_rcp_f32 v159, v159
    v_pk_mul_f32 v[112:113], v[112:113], v[144:145]
    v_pk_mul_f32 v[114:115], v[114:115], v[146:147]
    v_pk_mul_f32 v[116:117], v[116:117], v[148:149]
    v_pk_mul_f32 v[118:119], v[118:119], v[150:151]
    v_pk_mul_f32 v[120:121], v[120:121], v[152:153]
    v_pk_mul_f32 v[122:123], v[122:123], v[154:155]
    v_pk_mul_f32 v[124:125], v[124:125], v[156:157]
    v_pk_mul_f32 v[126:127], v[126:127], v[158:159]
    v_cvt_pk_bf16_f32 v200, v112, v113
    v_cvt_pk_bf16_f32 v201, v114, v115
    v_cvt_pk_bf16_f32 v202, v116, v117
    v_cvt_pk_bf16_f32 v203, v118, v119
    v_cvt_pk_bf16_f32 v204, v120, v121
    v_cvt_pk_bf16_f32 v205, v122, v123
    v_cvt_pk_bf16_f32 v206, v124, v125
    v_cvt_pk_bf16_f32 v207, v126, v127
L_nog1:
    buffer_store_dwordx4 v[192:195], v1, s[28:31], s36 offen offset:0 sc1
    buffer_store_dwordx4 v[196:199], v1, s[28:31], s36 offen offset:1024 sc1
    buffer_store_dwordx4 v[200:203], v1, s[28:31], s36 offen offset:2048 sc1
    buffer_store_dwordx4 v[204:207], v1, s[28:31], s36 offen offset:3072 sc1
    s_waitcnt vmcnt(4)
    ds_write_b32 v13, v15
    s_mov_b64 exec, s[50:51]
    s_mov_b32 s91, 65536
    v_cmp_gt_u32 vcc, 16, v252
    s_sub_u32 s91, s91, 1
    s_cbranch_scc1 L_pzd
    s_and_b64 exec, exec, vcc
    s_cbranch_scc0 L_pzd
    v_mov_b32 v252, 0
    buffer_atomic_add v252, v10, s[28:31], s90 offen sc0 sc1
    s_sleep 6
L_pz:
    v_mov_b32 v253, 0
    buffer_atomic_add v253, v10, s[28:31], s90 offen sc0 sc1
    s_sleep 5
    s_waitcnt vmcnt(1)
    v_cmp_gt_u32 vcc, 16, v252
    s_sub_u32 s91, s91, 1
    s_cbranch_scc1 L_pzd
    s_and_b64 exec, exec, vcc
    s_cbranch_scc0 L_pzd
    v_mov_b32 v252, 0
    buffer_atomic_add v252, v10, s[28:31], s90 offen sc0 sc1
    s_sleep 5
    s_waitcnt vmcnt(1)
    v_cmp_gt_u32 vcc, 16, v253
    s_sub_u32 s91, s91, 1
    s_cbranch_scc1 L_pzd
    s_and_b64 exec, exec, vcc
    s_cbranch_scc0 L_pzd
    s_branch L_pz
L_pzd:
    s_mov_b64 exec, -1
    s_add_u32 s59, s93, 0
    s_and_b32 s59, s59, 7
    s_lshl_b32 s59, s59, 12
    s_add_u32 s44, s59, s66
    s_add_u32 s45, s59, s67
    s_add_u32 s46, s59, s68
    s_add_u32 s47, s59, s69
    buffer_load_dwordx4 v[48:51], v1, s[28:31], s44 offen offset:0 sc1
    buffer_load_dwordx4 v[64:67], v1, s[28:31], s44 offen offset:1024 sc1
    buffer_load_dwordx4 v[80:83], v1, s[28:31], s44 offen offset:2048 sc1
    buffer_load_dwordx4 v[96:99], v1, s[28:31], s44 offen offset:3072 sc1
    buffer_load_dwordx4 v[52:55], v1, s[28:31], s45 offen offset:0 sc1
    buffer_load_dwordx4 v[68:71], v1, s[28:31], s45 offen offset:1024 sc1
    buffer_load_dwordx4 v[84:87], v1, s[28:31], s45 offen offset:2048 sc1
    buffer_load_dwordx4 v[100:103], v1, s[28:31], s45 offen offset:3072 sc1
    v_mov_b32 v10, 0
    s_setprio 0
    buffer_load_dwordx4 v[56:59], v1, s[28:31], s46 offen offset:0 sc1
    buffer_load_dwordx4 v[72:75], v1, s[28:31], s46 offen offset:1024 sc1
    buffer_load_dwordx4 v[88:91], v1, s[28:31], s46 offen offset:2048 sc1
    buffer_load_dwordx4 v[104:107], v1, s[28:31], s46 offen offset:3072 sc1
    buffer_load_dwordx4 v[60:63], v1, s[28:31], s47 offen offset:0 sc1
    buffer_load_dwordx4 v[76:79], v1, s[28:31], s47 offen offset:1024 sc1
    buffer_load_dwordx4 v[92:95], v1, s[28:31], s47 offen offset:2048 sc1
    buffer_load_dwordx4 v[108:111], v1, s[28:31], s47 offen offset:3072 sc1
    s_add_u32 s59, s93, 1
    s_and_b32 s59, s59, 7
    s_lshl_b32 s59, s59, 12
    s_add_u32 s44, s59, s66
    s_add_u32 s45, s59, s67
    s_add_u32 s46, s59, s68
    s_add_u32 s47, s59, s69
    s_waitcnt vmcnt(15)
    v_mfma_f32_32x32x16_bf16 v[112:127], v[48:51], v[16:19], 0
    v_mfma_f32_32x32x16_bf16 v[176:191], v[48:51], v[32:35], 0
    buffer_load_dwordx4 v[48:51], v1, s[28:31], s44 offen offset:0 sc1
    s_add_u32 m0, s92, 65536
    s_add_u32 s59, s58, 65536
    s_and_b32 s59, s59, 0x1ffff
    s_add_u32 s59, s59, s71
    buffer_load_dwordx4 v1, s[28:31], s59 offen sc1 lds
    buffer_load_dwordx4 v1, s[28:31], s59 offen offset:1024 sc1 lds
    s_waitcnt vmcnt(20)
    ds_read_b128 v[224:227], v6 offset:0
    ds_read_b128 v[228:231], v7 offset:0
    ds_read_b128 v[232:235], v8 offset:0
    ds_read_b128 v[236:239], v9 offset:0
    s_waitcnt vmcnt(17)
    v_mfma_f32_32x32x16_bf16 v[112:127], v[64:67], v[20:23], v[112:127]
    v_mfma_f32_32x32x16_bf16 v[176:191], v[64:67], v[36:39], v[176:191]
    buffer_load_dwordx4 v[64:67], v1, s[28:31], s44 offen offset:1024 sc1
    s_add_u32 m0, s92, 73728
    s_add_u32 s59, s58, 73728
    s_and_b32 s59, s59, 0x1ffff
    s_add_u32 s59, s59, s71
    buffer_load_dwordx4 v1, s[28:31], s59 offen sc1 lds
    buffer_load_dwordx4 v1, s[28:31], s59 offen offset:1024 sc1 lds
    s_waitcnt lgkmcnt(0)
    s_waitcnt vmcnt(19)
    v_mfma_f32_32x32x16_bf16 v[112:127], v[80:83], v[24:27], v[112:127]
    v_mfma_f32_32x32x16_bf16 v[176:191], v[80:83], v[40:43], v[176:191]
    buffer_load_dwordx4 v[80:83], v1, s[28:31], s44 offen offset:2048 sc1
    s_add_u32 s3, s93, 2
    s_and_b32 s3, s3, 7
    s_lshl_b32 s3, s3, 7
    s_mov_b32 m0, s72
    s_add_u32 s59, s3, s74
    buffer_load_dwordx4 v2, s[32:35], s59 offen offset:0 lds
    s_waitcnt vmcnt(20)
    v_mfma_f32_32x32x16_bf16 v[112:127], v[96:99], v[28:31], v[112:127]
    v_mfma_f32_32x32x16_bf16 v[176:191], v[96:99], v[44:47], v[176:191]
    buffer_load_dwordx4 v[96:99], v1, s[28:31], s44 offen offset:3072 sc1
    buffer_load_dwordx4 v3, s[32:35], s59 offen offset:1024 lds
    s_waitcnt vmcnt(21)
    v_mfma_f32_32x32x16_bf16 v[128:143], v[52:55], v[16:19], 0
    v_mfma_f32_32x32x16_bf16 v[192:207], v[52:55], v[32:35], 0
    buffer_load_dwordx4 v[52:55], v1, s[28:31], s45 offen offset:0 sc1
    buffer_load_dwordx4 v4, s[32:35], s59 offen offset:2048 lds
    s_waitcnt vmcnt(22)
    v_mfma_f32_32x32x16_bf16 v[128:143], v[68:71], v[20:23], v[128:143]
    v_mfma_f32_32x32x16_bf16 v[192:207], v[68:71], v[36:39], v[192:207]
    buffer_load_dwordx4 v[68:71], v1, s[28:31], s45 offen offset:1024 sc1
    buffer_load_dwordx4 v5, s[32:35], s59 offen offset:3072 lds
    s_waitcnt vmcnt(23)
    v_mfma_f32_32x32x16_bf16 v[128:143], v[84:87], v[24:27], v[128:143]
    v_mfma_f32_32x32x16_bf16 v[192:207], v[84:87], v[40:43], v[192:207]
    buffer_load_dwordx4 v[84:87], v1, s[28:31], s45 offen offset:2048 sc1
    s_add_u32 m0, s92, 81920
    s_add_u32 s59, s58, 81920
    s_and_b32 s59, s59, 0x1ffff
    s_add_u32 s59, s59, s71
    buffer_load_dwordx4 v1, s[28:31], s59 offen sc1 lds
    buffer_load_dwordx4 v1, s[28:31], s59 offen offset:1024 sc1 lds
    s_waitcnt vmcnt(33)
    ds_read_b128 v[240:243], v6 offset:4096
    ds_read_b128 v[244:247], v7 offset:4096
    ds_read_b128 v[248:251], v8 offset:4096
    ds_read_b128 v[252:255], v9 offset:4096
    s_waitcnt vmcnt(25)
    v_mfma_f32_32x32x16_bf16 v[128:143], v[100:103], v[28:31], v[128:143]
    v_mfma_f32_32x32x16_bf16 v[192:207], v[100:103], v[44:47], v[192:207]
    buffer_load_dwordx4 v[100:103], v1, s[28:31], s45 offen offset:3072 sc1
    s_add_u32 m0, s92, 90112
    s_add_u32 s59, s58, 90112
    s_and_b32 s59, s59, 0x1ffff
    s_add_u32 s59, s59, s71
    buffer_load_dwordx4 v1, s[28:31], s59 offen sc1 lds
    buffer_load_dwordx4 v1, s[28:31], s59 offen offset:1024 sc1 lds
    s_waitcnt lgkmcnt(0)
    s_waitcnt vmcnt(27)
    v_mfma_f32_32x32x16_bf16 v[144:159], v[56:59], v[16:19], 0
    v_mfma_f32_32x32x16_bf16 v[208:223], v[56:59], v[32:35], 0
    buffer_load_dwordx4 v[56:59], v1, s[28:31], s46 offen offset:0 sc1
    s_add_u32 s3, s93, 2
    s_and_b32 s3, s3, 7
    s_lshl_b32 s3, s3, 7
    s_mov_b32 m0, s73
    s_add_u32 s59, s3, s75
    buffer_load_dwordx4 v2, s[32:35], s59 offen offset:0 lds
    s_waitcnt vmcnt(28)
    v_mfma_f32_32x32x16_bf16 v[144:159], v[72:75], v[20:23], v[144:159]
    v_mfma_f32_32x32x16_bf16 v[208:223], v[72:75], v[36:39], v[208:223]
    buffer_load_dwordx4 v[72:75], v1, s[28:31], s46 offen offset:1024 sc1
    buffer_load_dwordx4 v3, s[32:35], s59 offen offset:1024 lds
    s_waitcnt vmcnt(29)
    v_mfma_f32_32x32x16_bf16 v[144:159], v[88:91], v[24:27], v[144:159]
    v_mfma_f32_32x32x16_bf16 v[208:223], v[88:91], v[40:43], v[208:223]
    buffer_load_dwordx4 v[88:91], v1, s[28:31], s46 offen offset:2048 sc1
    buffer_load_dwordx4 v4, s[32:35], s59 offen offset:2048 lds
    s_waitcnt vmcnt(30)
    v_mfma_f32_32x32x16_bf16 v[144:159], v[104:107], v[28:31], v[144:159]
    v_mfma_f32_32x32x16_bf16 v[208:223], v[104:107], v[44:47], v[208:223]
    buffer_load_dwordx4 v[104:107], v1, s[28:31], s46 offen offset:3072 sc1
    buffer_load_dwordx4 v5, s[32:35], s59 offen offset:3072 lds
    s_waitcnt vmcnt(31)
    v_mfma_f32_32x32x16_bf16 v[160:175], v[60:63], v[16:19], 0
    buffer_load_dwordx4 v[60:63], v1, s[28:31], s47 offen offset:0 sc1
    s_waitcnt vmcnt(31)
    v_mfma_f32_32x32x16_bf16 v[160:175], v[76:79], v[20:23], v[160:175]
    buffer_load_dwordx4 v[76:79], v1, s[28:31], s47 offen offset:1024 sc1
    s_waitcnt vmcnt(31)
    v_mfma_f32_32x32x16_bf16 v[160:175], v[92:95], v[24:27], v[160:175]
    buffer_load_dwordx4 v[92:95], v1, s[28:31], s47 offen offset:2048 sc1
    s_waitcnt vmcnt(31)
    v_mfma_f32_32x32x16_bf16 v[160:175], v[108:111], v[28:31], v[160:175]
    buffer_load_dwordx4 v[108:111], v1, s[28:31], s47 offen offset:3072 sc1
    s_add_u32 s59, s93, 2
    s_and_b32 s59, s59, 7
    s_lshl_b32 s59, s59, 12
    s_add_u32 s44, s59, s66
    s_add_u32 s45, s59, s67
    s_add_u32 s46, s59, s68
    s_add_u32 s47, s59, s69
    s_waitcnt vmcnt(31)
    v_mfma_f32_32x32x16_bf16 v[112:127], v[48:51], v[224:227], v[112:127]
    v_mfma_f32_32x32x16_bf16 v[176:191], v[48:51], v[240:243], v[176:191]
    buffer_load_dwordx4 v[48:51], v1, s[28:31], s44 offen offset:0 sc1
    s_add_u32 m0, s92, 98304
    s_add_u32 s59, s58, 98304
    s_and_b32 s59, s59, 0x1ffff
    s_add_u32 s59, s59, s71
    buffer_load_dwordx4 v1, s[28:31], s59 offen sc1 lds
    buffer_load_dwordx4 v1, s[28:31], s59 offen offset:1024 sc1 lds
    s_waitcnt vmcnt(21)
    ds_read_b128 v[16:19], v6 offset:0
    ds_read_b128 v[20:23], v7 offset:0
    ds_read_b128 v[24:27], v8 offset:0
    ds_read_b128 v[28:31], v9 offset:0
    s_waitcnt vmcnt(31)
    v_mfma_f32_32x32x16_bf16 v[112:127], v[64:67], v[228:231], v[112:127]
    v_mfma_f32_32x32x16_bf16 v[176:191], v[64:67], v[244:247], v[176:191]
    buffer_load_dwordx4 v[64:67], v1, s[28:31], s44 offen offset:1024 sc1
    s_waitcnt lgkmcnt(0)
    s_waitcnt vmcnt(29)
    v_mfma_f32_32x32x16_bf16 v[112:127], v[80:83], v[232:235], v[112:127]
    v_mfma_f32_32x32x16_bf16 v[176:191], v[80:83], v[248:251], v[176:191]
    buffer_load_dwordx4 v[80:83], v1, s[28:31], s44 offen offset:2048 sc1
    s_add_u32 s3, s93, 3
    s_and_b32 s3, s3, 7
    s_lshl_b32 s3, s3, 7
    s_mov_b32 m0, s72
    s_add_u32 s59, s3, s74
    buffer_load_dwordx4 v2, s[32:35], s59 offen offset:0 lds
    s_waitcnt vmcnt(29)
    v_mfma_f32_32x32x16_bf16 v[112:127], v[96:99], v[236:239], v[112:127]
    v_mfma_f32_32x32x16_bf16 v[176:191], v[96:99], v[252:255], v[176:191]
    buffer_load_dwordx4 v[96:99], v1, s[28:31], s44 offen offset:3072 sc1
    buffer_load_dwordx4 v3, s[32:35], s59 offen offset:1024 lds
    s_waitcnt vmcnt(29)
    v_mfma_f32_32x32x16_bf16 v[128:143], v[52:55], v[224:227], v[128:143]
    v_mfma_f32_32x32x16_bf16 v[192:207], v[52:55], v[240:243], v[192:207]
    buffer_load_dwordx4 v[52:55], v1, s[28:31], s45 offen offset:0 sc1
    buffer_load_dwordx4 v4, s[32:35], s59 offen offset:2048 lds
    s_waitcnt vmcnt(29)
    v_mfma_f32_32x32x16_bf16 v[128:143], v[68:71], v[228:231], v[128:143]
    v_mfma_f32_32x32x16_bf16 v[192:207], v[68:71], v[244:247], v[192:207]
    buffer_load_dwordx4 v[68:71], v1, s[28:31], s45 offen offset:1024 sc1
    buffer_load_dwordx4 v5, s[32:35], s59 offen offset:3072 lds
    s_waitcnt vmcnt(29)
    v_mfma_f32_32x32x16_bf16 v[128:143], v[84:87], v[232:235], v[128:143]
    v_mfma_f32_32x32x16_bf16 v[192:207], v[84:87], v[248:251], v[192:207]
    buffer_load_dwordx4 v[84:87], v1, s[28:31], s45 offen offset:2048 sc1
    s_add_u32 m0, s92, 106496
    s_add_u32 s59, s58, 106496
    s_and_b32 s59, s59, 0x1ffff
    s_add_u32 s59, s59, s71
    buffer_load_dwordx4 v1, s[28:31], s59 offen sc1 lds
    buffer_load_dwordx4 v1, s[28:31], s59 offen offset:1024 sc1 lds
    s_waitcnt vmcnt(19)
    ds_read_b128 v[32:35], v6 offset:4096
    ds_read_b128 v[36:39], v7 offset:4096
    ds_read_b128 v[40:43], v8 offset:4096
    ds_read_b128 v[44:47], v9 offset:4096
    ds_write_b32 v13, v15 offset:16
    s_waitcnt vmcnt(29)
    v_mfma_f32_32x32x16_bf16 v[128:143], v[100:103], v[236:239], v[128:143]
    v_mfma_f32_32x32x16_bf16 v[192:207], v[100:103], v[252:255], v[192:207]
    buffer_load_dwordx4 v[100:103], v1, s[28:31], s45 offen offset:3072 sc1
    s_waitcnt lgkmcnt(0)
    s_waitcnt vmcnt(27)
    v_mfma_f32_32x32x16_bf16 v[144:159], v[56:59], v[224:227], v[144:159]
    v_mfma_f32_32x32x16_bf16 v[208:223], v[56:59], v[240:243], v[208:223]
    buffer_load_dwordx4 v[56:59], v1, s[28:31], s46 offen offset:0 sc1
    s_add_u32 s3, s93, 3
    s_and_b32 s3, s3, 7
    s_lshl_b32 s3, s3, 7
    s_mov_b32 m0, s73
    s_add_u32 s59, s3, s75
    buffer_load_dwordx4 v2, s[32:35], s59 offen offset:0 lds
    s_waitcnt vmcnt(27)
    v_mfma_f32_32x32x16_bf16 v[144:159], v[72:75], v[228:231], v[144:159]
    v_mfma_f32_32x32x16_bf16 v[208:223], v[72:75], v[244:247], v[208:223]
    buffer_load_dwordx4 v[72:75], v1, s[28:31], s46 offen offset:1024 sc1
    buffer_load_dwordx4 v3, s[32:35], s59 offen offset:1024 lds
    s_waitcnt vmcnt(27)
    v_mfma_f32_32x32x16_bf16 v[144:159], v[88:91], v[232:235], v[144:159]
    v_mfma_f32_32x32x16_bf16 v[208:223], v[88:91], v[248:251], v[208:223]
    buffer_load_dwordx4 v[88:91], v1, s[28:31], s46 offen offset:2048 sc1
    buffer_load_dwordx4 v4, s[32:35], s59 offen offset:2048 lds
    s_waitcnt vmcnt(27)
    v_mfma_f32_32x32x16_bf16 v[144:159], v[104:107], v[236:239], v[144:159]
    v_mfma_f32_32x32x16_bf16 v[208:223], v[104:107], v[252:255], v[208:223]
    buffer_load_dwordx4 v[104:107], v1, s[28:31], s46 offen offset:3072 sc1
    buffer_load_dwordx4 v5, s[32:35], s59 offen offset:3072 lds
    s_waitcnt vmcnt(27)
    v_mfma_f32_32x32x16_bf16 v[160:175], v[60:63], v[224:227], v[160:175]
    buffer_load_dwordx4 v[60:63], v1, s[28:31], s47 offen offset:0 sc1
    s_waitcnt vmcnt(27)
    v_mfma_f32_32x32x16_bf16 v[160:175], v[76:79], v[228:231], v[160:175]
    buffer_load_dwordx4 v[76:79], v1, s[28:31], s47 offen offset:1024 sc1
    s_waitcnt vmcnt(27)
    v_mfma_f32_32x32x16_bf16 v[160:175], v[92:95], v[232:235], v[160:175]
    buffer_load_dwordx4 v[92:95], v1, s[28:31], s47 offen offset:2048 sc1
    s_waitcnt vmcnt(27)
    v_mfma_f32_32x32x16_bf16 v[160:175], v[108:111], v[236:239], v[160:175]
    buffer_load_dwordx4 v[108:111], v1, s[28:31], s47 offen offset:3072 sc1
    s_add_u32 s59, s93, 3
    s_and_b32 s59, s59, 7
    s_lshl_b32 s59, s59, 12
    s_add_u32 s44, s59, s66
    s_add_u32 s45, s59, s67
    s_add_u32 s46, s59, s68
    s_add_u32 s47, s59, s69
    s_waitcnt vmcnt(27)
    v_mfma_f32_32x32x16_bf16 v[112:127], v[48:51], v[16:19], v[112:127]
    v_mfma_f32_32x32x16_bf16 v[176:191], v[48:51], v[32:35], v[176:191]
    buffer_load_dwordx4 v[48:51], v1, s[28:31], s44 offen offset:0 sc1
    s_add_u32 m0, s92, 114688
    s_add_u32 s59, s58, 114688
    s_and_b32 s59, s59, 0x1ffff
    s_add_u32 s59, s59, s71
    buffer_load_dwordx4 v1, s[28:31], s59 offen sc1 lds
    buffer_load_dwordx4 v1, s[28:31], s59 offen offset:1024 sc1 lds
    s_waitcnt vmcnt(19)
    ds_read_b128 v[224:227], v6 offset:0
    ds_read_b128 v[228:231], v7 offset:0
    ds_read_b128 v[232:235], v8 offset:0
    ds_read_b128 v[236:239], v9 offset:0
    s_waitcnt vmcnt(27)
    v_mfma_f32_32x32x16_bf16 v[112:127], v[64:67], v[20:23], v[112:127]
    v_mfma_f32_32x32x16_bf16 v[176:191], v[64:67], v[36:39], v[176:191]
    buffer_load_dwordx4 v[64:67], v1, s[28:31], s44 offen offset:1024 sc1
    s_waitcnt lgkmcnt(0)
    s_waitcnt vmcnt(27)
    v_mfma_f32_32x32x16_bf16 v[112:127], v[80:83], v[24:27], v[112:127]
    v_mfma_f32_32x32x16_bf16 v[176:191], v[80:83], v[40:43], v[176:191]
    buffer_load_dwordx4 v[80:83], v1, s[28:31], s44 offen offset:2048 sc1
    s_add_u32 s3, s93, 4
    s_and_b32 s3, s3, 7
    s_lshl_b32 s3, s3, 7
    s_mov_b32 m0, s72
    s_add_u32 s59, s3, s74
    buffer_load_dwordx4 v2, s[32:35], s59 offen offset:0 lds
    s_waitcnt vmcnt(27)
    v_mfma_f32_32x32x16_bf16 v[112:127], v[96:99], v[28:31], v[112:127]
    v_mfma_f32_32x32x16_bf16 v[176:191], v[96:99], v[44:47], v[176:191]
    buffer_load_dwordx4 v[96:99], v1, s[28:31], s44 offen offset:3072 sc1
    buffer_load_dwordx4 v3, s[32:35], s59 offen offset:1024 lds
    s_waitcnt vmcnt(27)
    v_mfma_f32_32x32x16_bf16 v[128:143], v[52:55], v[16:19], v[128:143]
    v_mfma_f32_32x32x16_bf16 v[192:207], v[52:55], v[32:35], v[192:207]
    buffer_load_dwordx4 v[52:55], v1, s[28:31], s45 offen offset:0 sc1
    buffer_load_dwordx4 v4, s[32:35], s59 offen offset:2048 lds
    s_waitcnt vmcnt(27)
    v_mfma_f32_32x32x16_bf16 v[128:143], v[68:71], v[20:23], v[128:143]
    v_mfma_f32_32x32x16_bf16 v[192:207], v[68:71], v[36:39], v[192:207]
    buffer_load_dwordx4 v[68:71], v1, s[28:31], s45 offen offset:1024 sc1
    buffer_load_dwordx4 v5, s[32:35], s59 offen offset:3072 lds
    s_waitcnt vmcnt(27)
    v_mfma_f32_32x32x16_bf16 v[128:143], v[84:87], v[24:27], v[128:143]
    v_mfma_f32_32x32x16_bf16 v[192:207], v[84:87], v[40:43], v[192:207]
    buffer_load_dwordx4 v[84:87], v1, s[28:31], s45 offen offset:2048 sc1
    s_add_u32 m0, s92, 122880
    s_add_u32 s59, s58, 122880
    s_and_b32 s59, s59, 0x1ffff
    s_add_u32 s59, s59, s71
    buffer_load_dwordx4 v1, s[28:31], s59 offen sc1 lds
    buffer_load_dwordx4 v1, s[28:31], s59 offen offset:1024 sc1 lds
    s_waitcnt vmcnt(19)
    ds_read_b128 v[240:243], v6 offset:4096
    ds_read_b128 v[244:247], v7 offset:4096
    ds_read_b128 v[248:251], v8 offset:4096
    ds_read_b128 v[252:255], v9 offset:4096
    s_waitcnt vmcnt(27)
    v_mfma_f32_32x32x16_bf16 v[128:143], v[100:103], v[28:31], v[128:143]
    v_mfma_f32_32x32x16_bf16 v[192:207], v[100:103], v[44:47], v[192:207]
    buffer_load_dwordx4 v[100:103], v1, s[28:31], s45 offen offset:3072 sc1
    s_waitcnt lgkmcnt(0)
    s_waitcnt vmcnt(27)
    v_mfma_f32_32x32x16_bf16 v[144:159], v[56:59], v[16:19], v[144:159]
    v_mfma_f32_32x32x16_bf16 v[208:223], v[56:59], v[32:35], v[208:223]
    buffer_load_dwordx4 v[56:59], v1, s[28:31], s46 offen offset:0 sc1
    s_add_u32 s3, s93, 4
    s_and_b32 s3, s3, 7
    s_lshl_b32 s3, s3, 7
    s_mov_b32 m0, s73
    s_add_u32 s59, s3, s75
    buffer_load_dwordx4 v2, s[32:35], s59 offen offset:0 lds
    s_waitcnt vmcnt(27)
    v_mfma_f32_32x32x16_bf16 v[144:159], v[72:75], v[20:23], v[144:159]
    v_mfma_f32_32x32x16_bf16 v[208:223], v[72:75], v[36:39], v[208:223]
    buffer_load_dwordx4 v[72:75], v1, s[28:31], s46 offen offset:1024 sc1
    buffer_load_dwordx4 v3, s[32:35], s59 offen offset:1024 lds
    s_waitcnt vmcnt(27)
    v_mfma_f32_32x32x16_bf16 v[144:159], v[88:91], v[24:27], v[144:159]
    v_mfma_f32_32x32x16_bf16 v[208:223], v[88:91], v[40:43], v[208:223]
    buffer_load_dwordx4 v[88:91], v1, s[28:31], s46 offen offset:2048 sc1
    buffer_load_dwordx4 v4, s[32:35], s59 offen offset:2048 lds
    s_waitcnt vmcnt(27)
    v_mfma_f32_32x32x16_bf16 v[144:159], v[104:107], v[28:31], v[144:159]
    v_mfma_f32_32x32x16_bf16 v[208:223], v[104:107], v[44:47], v[208:223]
    buffer_load_dwordx4 v[104:107], v1, s[28:31], s46 offen offset:3072 sc1
    buffer_load_dwordx4 v5, s[32:35], s59 offen offset:3072 lds
    s_waitcnt vmcnt(27)
    v_mfma_f32_32x32x16_bf16 v[160:175], v[60:63], v[16:19], v[160:175]
    buffer_load_dwordx4 v[60:63], v1, s[28:31], s47 offen offset:0 sc1
    s_waitcnt vmcnt(27)
    v_mfma_f32_32x32x16_bf16 v[160:175], v[76:79], v[20:23], v[160:175]
    buffer_load_dwordx4 v[76:79], v1, s[28:31], s47 offen offset:1024 sc1
    s_mul_i32 s37, s37, 256
    s_add_u32 s37, s37, 23592960
    s_mov_b64 exec, 3
    buffer_atomic_add v15, v14, s[28:31], s37 offen sc1
    s_mov_b64 exec, -1
    s_waitcnt vmcnt(28)
    v_mfma_f32_32x32x16_bf16 v[160:175], v[92:95], v[24:27], v[160:175]
    buffer_load_dwordx4 v[92:95], v1, s[28:31], s47 offen offset:2048 sc1
    s_waitcnt vmcnt(28)
    v_mfma_f32_32x32x16_bf16 v[160:175], v[108:111], v[28:31], v[160:175]
    buffer_load_dwordx4 v[108:111], v1, s[28:31], s47 offen offset:3072 sc1
    s_add_u32 s59, s93, 4
    s_and_b32 s59, s59, 7
    s_lshl_b32 s59, s59, 12
    s_add_u32 s44, s59, s66
    s_add_u32 s45, s59, s67
    s_add_u32 s46, s59, s68
    s_add_u32 s47, s59, s69
    s_waitcnt vmcnt(28)
    v_mfma_f32_32x32x16_bf16 v[112:127], v[48:51], v[224:227], v[112:127]
    v_mfma_f32_32x32x16_bf16 v[176:191], v[48:51], v[240:243], v[176:191]
    buffer_load_dwordx4 v[48:51], v1, s[28:31], s44 offen offset:0 sc1
    s_waitcnt vmcnt(18)
    ds_read_b128 v[16:19], v6 offset:0
    ds_read_b128 v[20:23], v7 offset:0
    ds_read_b128 v[24:27], v8 offset:0
    ds_read_b128 v[28:31], v9 offset:0
    s_waitcnt vmcnt(26)
    v_mfma_f32_32x32x16_bf16 v[112:127], v[64:67], v[228:231], v[112:127]
    v_mfma_f32_32x32x16_bf16 v[176:191], v[64:67], v[244:247], v[176:191]
    buffer_load_dwordx4 v[64:67], v1, s[28:31], s44 offen offset:1024 sc1
    s_waitcnt lgkmcnt(0)
    s_waitcnt vmcnt(26)
    v_mfma_f32_32x32x16_bf16 v[112:127], v[80:83], v[232:235], v[112:127]
    v_mfma_f32_32x32x16_bf16 v[176:191], v[80:83], v[248:251], v[176:191]
    buffer_load_dwordx4 v[80:83], v1, s[28:31], s44 offen offset:2048 sc1
    s_add_u32 s3, s93, 5
    s_and_b32 s3, s3, 7
    s_lshl_b32 s3, s3, 7
    s_mov_b32 m0, s72
    s_add_u32 s59, s3, s74
    buffer_load_dwordx4 v2, s[32:35], s59 offen offset:0 lds
    s_waitcnt vmcnt(26)
    v_mfma_f32_32x32x16_bf16 v[112:127], v[96:99], v[236:239], v[112:127]
    v_mfma_f32_32x32x16_bf16 v[176:191], v[96:99], v[252:255], v[176:191]
    buffer_load_dwordx4 v[96:99], v1, s[28:31], s44 offen offset:3072 sc1
    buffer_load_dwordx4 v3, s[32:35], s59 offen offset:1024 lds
    s_waitcnt vmcnt(26)
    v_mfma_f32_32x32x16_bf16 v[128:143], v[52:55], v[224:227], v[128:143]
    v_mfma_f32_32x32x16_bf16 v[192:207], v[52:55], v[240:243], v[192:207]
    buffer_load_dwordx4 v[52:55], v1, s[28:31], s45 offen offset:0 sc1
    buffer_load_dwordx4 v4, s[32:35], s59 offen offset:2048 lds
    s_waitcnt vmcnt(26)
    v_mfma_f32_32x32x16_bf16 v[128:143], v[68:71], v[228:231], v[128:143]
    v_mfma_f32_32x32x16_bf16 v[192:207], v[68:71], v[244:247], v[192:207]
    buffer_load_dwordx4 v[68:71], v1, s[28:31], s45 offen offset:1024 sc1
    buffer_load_dwordx4 v5, s[32:35], s59 offen offset:3072 lds
    s_waitcnt vmcnt(26)
    v_mfma_f32_32x32x16_bf16 v[128:143], v[84:87], v[232:235], v[128:143]
    v_mfma_f32_32x32x16_bf16 v[192:207], v[84:87], v[248:251], v[192:207]
    buffer_load_dwordx4 v[84:87], v1, s[28:31], s45 offen offset:2048 sc1
    s_waitcnt vmcnt(16)
    ds_read_b128 v[32:35], v6 offset:4096
    ds_read_b128 v[36:39], v7 offset:4096
    ds_read_b128 v[40:43], v8 offset:4096
    ds_read_b128 v[44:47], v9 offset:4096
    ds_write_b32 v13, v15 offset:32
    s_waitcnt vmcnt(24)
    v_mfma_f32_32x32x16_bf16 v[128:143], v[100:103], v[236:239], v[128:143]
    v_mfma_f32_32x32x16_bf16 v[192:207], v[100:103], v[252:255], v[192:207]
    buffer_load_dwordx4 v[100:103], v1, s[28:31], s45 offen offset:3072 sc1
    s_waitcnt lgkmcnt(0)
    s_waitcnt vmcnt(24)
    v_mfma_f32_32x32x16_bf16 v[144:159], v[56:59], v[224:227], v[144:159]
    v_mfma_f32_32x32x16_bf16 v[208:223], v[56:59], v[240:243], v[208:223]
    buffer_load_dwordx4 v[56:59], v1, s[28:31], s46 offen offset:0 sc1
    s_add_u32 s3, s93, 5
    s_and_b32 s3, s3, 7
    s_lshl_b32 s3, s3, 7
    s_mov_b32 m0, s73
    s_add_u32 s59, s3, s75
    buffer_load_dwordx4 v2, s[32:35], s59 offen offset:0 lds
    s_waitcnt vmcnt(24)
    v_mfma_f32_32x32x16_bf16 v[144:159], v[72:75], v[228:231], v[144:159]
    v_mfma_f32_32x32x16_bf16 v[208:223], v[72:75], v[244:247], v[208:223]
    buffer_load_dwordx4 v[72:75], v1, s[28:31], s46 offen offset:1024 sc1
    buffer_load_dwordx4 v3, s[32:35], s59 offen offset:1024 lds
    s_waitcnt vmcnt(24)
    v_mfma_f32_32x32x16_bf16 v[144:159], v[88:91], v[232:235], v[144:159]
    v_mfma_f32_32x32x16_bf16 v[208:223], v[88:91], v[248:251], v[208:223]
    buffer_load_dwordx4 v[88:91], v1, s[28:31], s46 offen offset:2048 sc1
    buffer_load_dwordx4 v4, s[32:35], s59 offen offset:2048 lds
    s_waitcnt vmcnt(24)
    v_mfma_f32_32x32x16_bf16 v[144:159], v[104:107], v[236:239], v[144:159]
    v_mfma_f32_32x32x16_bf16 v[208:223], v[104:107], v[252:255], v[208:223]
    buffer_load_dwordx4 v[104:107], v1, s[28:31], s46 offen offset:3072 sc1
    buffer_load_dwordx4 v5, s[32:35], s59 offen offset:3072 lds
    s_waitcnt vmcnt(24)
    v_mfma_f32_32x32x16_bf16 v[160:175], v[60:63], v[224:227], v[160:175]
    buffer_load_dwordx4 v[60:63], v1, s[28:31], s47 offen offset:0 sc1
    s_waitcnt vmcnt(24)
    v_mfma_f32_32x32x16_bf16 v[160:175], v[76:79], v[228:231], v[160:175]
    buffer_load_dwordx4 v[76:79], v1, s[28:31], s47 offen offset:1024 sc1
    s_waitcnt vmcnt(23)
    v_mfma_f32_32x32x16_bf16 v[160:175], v[92:95], v[232:235], v[160:175]
    buffer_load_dwordx4 v[92:95], v1, s[28:31], s47 offen offset:2048 sc1
    s_waitcnt vmcnt(23)
    v_mfma_f32_32x32x16_bf16 v[160:175], v[108:111], v[236:239], v[160:175]
    buffer_load_dwordx4 v[108:111], v1, s[28:31], s47 offen offset:3072 sc1
    s_add_u32 s59, s93, 5
    s_and_b32 s59, s59, 7
    s_lshl_b32 s59, s59, 12
    s_add_u32 s44, s59, s66
    s_add_u32 s45, s59, s67
    s_add_u32 s46, s59, s68
    s_add_u32 s47, s59, s69
    s_waitcnt vmcnt(23)
    v_mfma_f32_32x32x16_bf16 v[112:127], v[48:51], v[16:19], v[112:127]
    v_mfma_f32_32x32x16_bf16 v[176:191], v[48:51], v[32:35], v[176:191]
    buffer_load_dwordx4 v[48:51], v1, s[28:31], s44 offen offset:0 sc1
    s_waitcnt vmcnt(15)
    ds_read_b128 v[224:227], v6 offset:0
    ds_read_b128 v[228:231], v7 offset:0
    ds_read_b128 v[232:235], v8 offset:0
    ds_read_b128 v[236:239], v9 offset:0
    s_waitcnt vmcnt(23)
    v_mfma_f32_32x32x16_bf16 v[112:127], v[64:67], v[20:23], v[112:127]
    v_mfma_f32_32x32x16_bf16 v[176:191], v[64:67], v[36:39], v[176:191]
    buffer_load_dwordx4 v[64:67], v1, s[28:31], s44 offen offset:1024 sc1
    s_waitcnt lgkmcnt(0)
    s_waitcnt vmcnt(23)
    v_mfma_f32_32x32x16_bf16 v[112:127], v[80:83], v[24:27], v[112:127]
    v_mfma_f32_32x32x16_bf16 v[176:191], v[80:83], v[40:43], v[176:191]
    buffer_load_dwordx4 v[80:83], v1, s[28:31], s44 offen offset:2048 sc1
    s_add_u32 s3, s93, 6
    s_and_b32 s3, s3, 7
    s_lshl_b32 s3, s3, 7
    s_mov_b32 m0, s72
    s_add_u32 s59, s3, s74
    buffer_load_dwordx4 v2, s[32:35], s59 offen offset:0 lds
    s_waitcnt vmcnt(23)
    v_mfma_f32_32x32x16_bf16 v[112:127], v[96:99], v[28:31], v[112:127]
    v_mfma_f32_32x32x16_bf16 v[176:191], v[96:99], v[44:47], v[176:191]
    buffer_load_dwordx4 v[96:99], v1, s[28:31], s44 offen offset:3072 sc1
    buffer_load_dwordx4 v3, s[32:35], s59 offen offset:1024 lds
    s_waitcnt vmcnt(23)
    v_mfma_f32_32x32x16_bf16 v[128:143], v[52:55], v[16:19], v[128:143]
    v_mfma_f32_32x32x16_bf16 v[192:207], v[52:55], v[32:35], v[192:207]
    buffer_load_dwordx4 v[52:55], v1, s[28:31], s45 offen offset:0 sc1
    buffer_load_dwordx4 v4, s[32:35], s59 offen offset:2048 lds
    s_waitcnt vmcnt(23)
    v_mfma_f32_32x32x16_bf16 v[128:143], v[68:71], v[20:23], v[128:143]
    v_mfma_f32_32x32x16_bf16 v[192:207], v[68:71], v[36:39], v[192:207]
    buffer_load_dwordx4 v[68:71], v1, s[28:31], s45 offen offset:1024 sc1
    buffer_load_dwordx4 v5, s[32:35], s59 offen offset:3072 lds
    s_waitcnt vmcnt(23)
    v_mfma_f32_32x32x16_bf16 v[128:143], v[84:87], v[24:27], v[128:143]
    v_mfma_f32_32x32x16_bf16 v[192:207], v[84:87], v[40:43], v[192:207]
    buffer_load_dwordx4 v[84:87], v1, s[28:31], s45 offen offset:2048 sc1
    s_waitcnt vmcnt(15)
    ds_read_b128 v[240:243], v6 offset:4096
    ds_read_b128 v[244:247], v7 offset:4096
    ds_read_b128 v[248:251], v8 offset:4096
    ds_read_b128 v[252:255], v9 offset:4096
    s_waitcnt vmcnt(23)
    v_mfma_f32_32x32x16_bf16 v[128:143], v[100:103], v[28:31], v[128:143]
    v_mfma_f32_32x32x16_bf16 v[192:207], v[100:103], v[44:47], v[192:207]
    buffer_load_dwordx4 v[100:103], v1, s[28:31], s45 offen offset:3072 sc1
    s_waitcnt lgkmcnt(0)
    s_waitcnt vmcnt(23)
    v_mfma_f32_32x32x16_bf16 v[144:159], v[56:59], v[16:19], v[144:159]
    v_mfma_f32_32x32x16_bf16 v[208:223], v[56:59], v[32:35], v[208:223]
    buffer_load_dwordx4 v[56:59], v1, s[28:31], s46 offen offset:0 sc1
    s_add_u32 s3, s93, 6
    s_and_b32 s3, s3, 7
    s_lshl_b32 s3, s3, 7
    s_mov_b32 m0, s73
    s_add_u32 s59, s3, s75
    buffer_load_dwordx4 v2, s[32:35], s59 offen offset:0 lds
    s_waitcnt vmcnt(23)
    v_mfma_f32_32x32x16_bf16 v[144:159], v[72:75], v[20:23], v[144:159]
    v_mfma_f32_32x32x16_bf16 v[208:223], v[72:75], v[36:39], v[208:223]
    buffer_load_dwordx4 v[72:75], v1, s[28:31], s46 offen offset:1024 sc1
    buffer_load_dwordx4 v3, s[32:35], s59 offen offset:1024 lds
    s_waitcnt vmcnt(23)
    v_mfma_f32_32x32x16_bf16 v[144:159], v[88:91], v[24:27], v[144:159]
    v_mfma_f32_32x32x16_bf16 v[208:223], v[88:91], v[40:43], v[208:223]
    buffer_load_dwordx4 v[88:91], v1, s[28:31], s46 offen offset:2048 sc1
    buffer_load_dwordx4 v4, s[32:35], s59 offen offset:2048 lds
    s_waitcnt vmcnt(23)
    v_mfma_f32_32x32x16_bf16 v[144:159], v[104:107], v[28:31], v[144:159]
    v_mfma_f32_32x32x16_bf16 v[208:223], v[104:107], v[44:47], v[208:223]
    buffer_load_dwordx4 v[104:107], v1, s[28:31], s46 offen offset:3072 sc1
    buffer_load_dwordx4 v5, s[32:35], s59 offen offset:3072 lds
    s_waitcnt vmcnt(23)
    v_mfma_f32_32x32x16_bf16 v[160:175], v[60:63], v[16:19], v[160:175]
    buffer_load_dwordx4 v[60:63], v1, s[28:31], s47 offen offset:0 sc1
    s_waitcnt vmcnt(23)
    v_mfma_f32_32x32x16_bf16 v[160:175], v[76:79], v[20:23], v[160:175]
    buffer_load_dwordx4 v[76:79], v1, s[28:31], s47 offen offset:1024 sc1
    s_waitcnt vmcnt(23)
    v_mfma_f32_32x32x16_bf16 v[160:175], v[92:95], v[24:27], v[160:175]
    buffer_load_dwordx4 v[92:95], v1, s[28:31], s47 offen offset:2048 sc1
    s_waitcnt vmcnt(23)
    v_mfma_f32_32x32x16_bf16 v[160:175], v[108:111], v[28:31], v[160:175]
    buffer_load_dwordx4 v[108:111], v1, s[28:31], s47 offen offset:3072 sc1
    s_add_u32 s59, s93, 6
    s_and_b32 s59, s59, 7
    s_lshl_b32 s59, s59, 12
    s_add_u32 s44, s59, s66
    s_add_u32 s45, s59, s67
    s_add_u32 s46, s59, s68
    s_add_u32 s47, s59, s69
    s_waitcnt vmcnt(23)
    v_mfma_f32_32x32x16_bf16 v[112:127], v[48:51], v[224:227], v[112:127]
    v_mfma_f32_32x32x16_bf16 v[176:191], v[48:51], v[240:243], v[176:191]
    buffer_load_dwordx4 v[48:51], v1, s[28:31], s44 offen offset:0 sc1
    s_mov_b32 s51, 0x07ff0001
    s_mov_b64 exec, s[50:51]
    buffer_atomic_add v10, v12, s[28:31], s90 offen sc0 sc1
    s_mov_b64 exec, -1
    s_waitcnt vmcnt(16)
    ds_read_b128 v[16:19], v6 offset:0
    ds_read_b128 v[20:23], v7 offset:0
    ds_read_b128 v[24:27], v8 offset:0
    ds_read_b128 v[28:31], v9 offset:0
    s_waitcnt vmcnt(24)
    v_mfma_f32_32x32x16_bf16 v[112:127], v[64:67], v[228:231], v[112:127]
    v_mfma_f32_32x32x16_bf16 v[176:191], v[64:67], v[244:247], v[176:191]
    buffer_load_dwordx4 v[64:67], v1, s[28:31], s44 offen offset:1024 sc1
    s_waitcnt lgkmcnt(0)
    s_waitcnt vmcnt(24)
    v_mfma_f32_32x32x16_bf16 v[112:127], v[80:83], v[232:235], v[112:127]
    v_mfma_f32_32x32x16_bf16 v[176:191], v[80:83], v[248:251], v[176:191]
    buffer_load_dwordx4 v[80:83], v1, s[28:31], s44 offen offset:2048 sc1
    s_add_u32 s3, s93, 7
    s_and_b32 s3, s3, 7
    s_lshl_b32 s3, s3, 7
    s_mov_b32 m0, s72
    s_add_u32 s59, s3, s74
    buffer_load_dwordx4 v2, s[32:35], s59 offen offset:0 lds
    s_waitcnt vmcnt(24)
    v_mfma_f32_32x32x16_bf16 v[112:127], v[96:99], v[236:239], v[112:127]
    v_mfma_f32_32x32x16_bf16 v[176:191], v[96:99], v[252:255], v[176:191]
    buffer_load_dwordx4 v[96:99], v1, s[28:31], s44 offen offset:3072 sc1
    buffer_load_dwordx4 v3, s[32:35], s59 offen offset:1024 lds
    s_waitcnt vmcnt(24)
    v_mfma_f32_32x32x16_bf16 v[128:143], v[52:55], v[224:227], v[128:143]
    v_mfma_f32_32x32x16_bf16 v[192:207], v[52:55], v[240:243], v[192:207]
    buffer_load_dwordx4 v[52:55], v1, s[28:31], s45 offen offset:0 sc1
    buffer_load_dwordx4 v4, s[32:35], s59 offen offset:2048 lds
    s_waitcnt vmcnt(24)
    v_mfma_f32_32x32x16_bf16 v[128:143], v[68:71], v[228:231], v[128:143]
    v_mfma_f32_32x32x16_bf16 v[192:207], v[68:71], v[244:247], v[192:207]
    buffer_load_dwordx4 v[68:71], v1, s[28:31], s45 offen offset:1024 sc1
    buffer_load_dwordx4 v5, s[32:35], s59 offen offset:3072 lds
    s_waitcnt vmcnt(24)
    v_mfma_f32_32x32x16_bf16 v[128:143], v[84:87], v[232:235], v[128:143]
    v_mfma_f32_32x32x16_bf16 v[192:207], v[84:87], v[248:251], v[192:207]
    buffer_load_dwordx4 v[84:87], v1, s[28:31], s45 offen offset:2048 sc1
    s_waitcnt vmcnt(16)
    ds_read_b128 v[32:35], v6 offset:4096
    ds_read_b128 v[36:39], v7 offset:4096
    ds_read_b128 v[40:43], v8 offset:4096
    ds_read_b128 v[44:47], v9 offset:4096
    s_waitcnt vmcnt(24)
    v_mfma_f32_32x32x16_bf16 v[128:143], v[100:103], v[236:239], v[128:143]
    v_mfma_f32_32x32x16_bf16 v[192:207], v[100:103], v[252:255], v[192:207]
    buffer_load_dwordx4 v[100:103], v1, s[28:31], s45 offen offset:3072 sc1
    s_waitcnt lgkmcnt(0)
    s_waitcnt vmcnt(24)
    v_mfma_f32_32x32x16_bf16 v[144:159], v[56:59], v[224:227], v[144:159]
    v_mfma_f32_32x32x16_bf16 v[208:223], v[56:59], v[240:243], v[208:223]
    buffer_load_dwordx4 v[56:59], v1, s[28:31], s46 offen offset:0 sc1
    s_add_u32 s3, s93, 7
    s_and_b32 s3, s3, 7
    s_lshl_b32 s3, s3, 7
    s_mov_b32 m0, s73
    s_add_u32 s59, s3, s75
    buffer_load_dwordx4 v2, s[32:35], s59 offen offset:0 lds
    s_waitcnt vmcnt(24)
    v_mfma_f32_32x32x16_bf16 v[144:159], v[72:75], v[228:231], v[144:159]
    v_mfma_f32_32x32x16_bf16 v[208:223], v[72:75], v[244:247], v[208:223]
    buffer_load_dwordx4 v[72:75], v1, s[28:31], s46 offen offset:1024 sc1
    buffer_load_dwordx4 v3, s[32:35], s59 offen offset:1024 lds
    s_waitcnt vmcnt(24)
    v_mfma_f32_32x32x16_bf16 v[144:159], v[88:91], v[232:235], v[144:159]
    v_mfma_f32_32x32x16_bf16 v[208:223], v[88:91], v[248:251], v[208:223]
    buffer_load_dwordx4 v[88:91], v1, s[28:31], s46 offen offset:2048 sc1
    buffer_load_dwordx4 v4, s[32:35], s59 offen offset:2048 lds
    s_waitcnt vmcnt(24)
    v_mfma_f32_32x32x16_bf16 v[144:159], v[104:107], v[236:239], v[144:159]
    v_mfma_f32_32x32x16_bf16 v[208:223], v[104:107], v[252:255], v[208:223]
    buffer_load_dwordx4 v[104:107], v1, s[28:31], s46 offen offset:3072 sc1
    buffer_load_dwordx4 v5, s[32:35], s59 offen offset:3072 lds
    s_waitcnt vmcnt(24)
    v_mfma_f32_32x32x16_bf16 v[160:175], v[60:63], v[224:227], v[160:175]
    buffer_load_dwordx4 v[60:63], v1, s[28:31], s47 offen offset:0 sc1
    s_waitcnt vmcnt(24)
    v_mfma_f32_32x32x16_bf16 v[160:175], v[76:79], v[228:231], v[160:175]
    buffer_load_dwordx4 v[76:79], v1, s[28:31], s47 offen offset:1024 sc1
    s_waitcnt vmcnt(21)
    s_setprio 2
    s_mov_b64 exec, s[50:51]
    v_cmp_gt_u32 vcc, 8, v10
    s_nop 1
    s_cmp_eq_u64 vcc, 0
    s_cbranch_scc1 L_pyd
    s_mov_b32 s91, 65536
    s_mov_b64 exec, vcc
    v_mov_b32 v10, 0
    buffer_atomic_add v10, v12, s[28:31], s90 offen sc0 sc1
L_py:
    s_waitcnt vmcnt(0)
    v_cmp_gt_u32 vcc, 8, v10
    s_sub_u32 s91, s91, 1
    s_cbranch_scc1 L_pyd
    s_cmp_eq_u64 vcc, 0
    s_cbranch_scc1 L_pyd
    s_sleep 8
    s_mov_b64 exec, vcc
    v_mov_b32 v10, 0
    buffer_atomic_add v10, v12, s[28:31], s90 offen sc0 sc1
    s_branch L_py
L_pyd:
    s_mov_b64 exec, -1
    s_setprio 0
    s_waitcnt vmcnt(24)
    v_mfma_f32_32x32x16_bf16 v[160:175], v[92:95], v[232:235], v[160:175]
    buffer_load_dwordx4 v[92:95], v1, s[28:31], s47 offen offset:2048 sc1
    s_waitcnt vmcnt(24)
    v_mfma_f32_32x32x16_bf16 v[160:175], v[108:111], v[236:239], v[160:175]
    buffer_load_dwordx4 v[108:111], v1, s[28:31], s47 offen offset:3072 sc1
    s_add_u32 s59, s93, 7
    s_and_b32 s59, s59, 7
    s_lshl_b32 s59, s59, 12
    s_add_u32 s44, s59, s66
    s_add_u32 s45, s59, s67
    s_add_u32 s46, s59, s68
    s_add_u32 s47, s59, s69
    s_lshl_b32 s66, s39, 1
    s_lshr_b32 s59, s57, 1
    s_add_u32 s66, s66, s59
    s_mul_i32 s66, s66, 90112
    s_and_b32 s59, s57, 1
    s_lshl_b32 s59, s59, 14
    s_add_u32 s66, s66, s59
    s_add_u32 s66, s66, 20971520
    s_waitcnt vmcnt(24)
    v_mfma_f32_32x32x16_bf16 v[112:127], v[48:51], v[16:19], v[112:127]
    v_mfma_f32_32x32x16_bf16 v[176:191], v[48:51], v[32:35], v[176:191]
    buffer_load_dwordx4 v[48:51], v1, s[28:31], s44 offen offset:0 sc1
    s_waitcnt vmcnt(15)
    ds_read_b128 v[224:227], v6 offset:0
    ds_read_b128 v[228:231], v7 offset:0
    ds_read_b128 v[232:235], v8 offset:0
    ds_read_b128 v[236:239], v9 offset:0
    s_waitcnt vmcnt(23)
    v_mfma_f32_32x32x16_bf16 v[112:127], v[64:67], v[20:23], v[112:127]
    v_mfma_f32_32x32x16_bf16 v[176:191], v[64:67], v[36:39], v[176:191]
    buffer_load_dwordx4 v[64:67], v1, s[28:31], s44 offen offset:1024 sc1
    s_waitcnt lgkmcnt(0)
    s_waitcnt vmcnt(23)
    v_mfma_f32_32x32x16_bf16 v[112:127], v[80:83], v[24:27], v[112:127]
    v_mfma_f32_32x32x16_bf16 v[176:191], v[80:83], v[40:43], v[176:191]
    buffer_load_dwordx4 v[80:83], v1, s[28:31], s44 offen offset:2048 sc1
    s_mov_b32 m0, s72
    s_nop 0
    buffer_load_dwordx4 v1, s[28:31], s66 offen offset:0 sc1 lds
    s_waitcnt vmcnt(23)
    v_mfma_f32_32x32x16_bf16 v[112:127], v[96:99], v[28:31], v[112:127]
    v_mfma_f32_32x32x16_bf16 v[176:191], v[96:99], v[44:47], v[176:191]
    buffer_load_dwordx4 v[96:99], v1, s[28:31], s44 offen offset:3072 sc1
    buffer_load_dwordx4 v1, s[28:31], s66 offen offset:1024 sc1 lds
    s_waitcnt vmcnt(23)
    v_mfma_f32_32x32x16_bf16 v[128:143], v[52:55], v[16:19], v[128:143]
    v_mfma_f32_32x32x16_bf16 v[192:207], v[52:55], v[32:35], v[192:207]
    buffer_load_dwordx4 v[52:55], v1, s[28:31], s45 offen offset:0 sc1
    buffer_load_dwordx4 v1, s[28:31], s66 offen offset:2048 sc1 lds
    s_waitcnt vmcnt(23)
    v_mfma_f32_32x32x16_bf16 v[128:143], v[68:71], v[20:23], v[128:143]
    v_mfma_f32_32x32x16_bf16 v[192:207], v[68:71], v[36:39], v[192:207]
    buffer_load_dwordx4 v[68:71], v1, s[28:31], s45 offen offset:1024 sc1
    buffer_load_dwordx4 v1, s[28:31], s66 offen offset:3072 sc1 lds
    s_add_u32 s66, s66, 4096
    s_waitcnt vmcnt(23)
    v_mfma_f32_32x32x16_bf16 v[128:143], v[84:87], v[24:27], v[128:143]
    v_mfma_f32_32x32x16_bf16 v[192:207], v[84:87], v[40:43], v[192:207]
    buffer_load_dwordx4 v[84:87], v1, s[28:31], s45 offen offset:2048 sc1
    s_waitcnt vmcnt(15)
    ds_read_b128 v[240:243], v6 offset:4096
    ds_read_b128 v[244:247], v7 offset:4096
    ds_read_b128 v[248:251], v8 offset:4096
    ds_read_b128 v[252:255], v9 offset:4096
    s_waitcnt vmcnt(23)
    v_mfma_f32_32x32x16_bf16 v[128:143], v[100:103], v[28:31], v[128:143]
    v_mfma_f32_32x32x16_bf16 v[192:207], v[100:103], v[44:47], v[192:207]
    buffer_load_dwordx4 v[100:103], v1, s[28:31], s45 offen offset:3072 sc1
    s_waitcnt lgkmcnt(0)
    s_waitcnt vmcnt(23)
    v_mfma_f32_32x32x16_bf16 v[144:159], v[56:59], v[16:19], v[144:159]
    v_mfma_f32_32x32x16_bf16 v[208:223], v[56:59], v[32:35], v[208:223]
    buffer_load_dwordx4 v[56:59], v1, s[28:31], s46 offen offset:0 sc1
    s_mov_b32 m0, s73
    s_nop 0
    buffer_load_dwordx4 v1, s[28:31], s66 offen offset:0 sc1 lds
    s_waitcnt vmcnt(23)
    v_mfma_f32_32x32x16_bf16 v[144:159], v[72:75], v[20:23], v[144:159]
    v_mfma_f32_32x32x16_bf16 v[208:223], v[72:75], v[36:39], v[208:223]
    buffer_load_dwordx4 v[72:75], v1, s[28:31], s46 offen offset:1024 sc1
    buffer_load_dwordx4 v1, s[28:31], s66 offen offset:1024 sc1 lds
    s_waitcnt vmcnt(23)
    v_mfma_f32_32x32x16_bf16 v[144:159], v[88:91], v[24:27], v[144:159]
    v_mfma_f32_32x32x16_bf16 v[208:223], v[88:91], v[40:43], v[208:223]
    buffer_load_dwordx4 v[88:91], v1, s[28:31], s46 offen offset:2048 sc1
    buffer_load_dwordx4 v1, s[28:31], s66 offen offset:2048 sc1 lds
    s_waitcnt vmcnt(23)
    v_mfma_f32_32x32x16_bf16 v[144:159], v[104:107], v[28:31], v[144:159]
    v_mfma_f32_32x32x16_bf16 v[208:223], v[104:107], v[44:47], v[208:223]
    buffer_load_dwordx4 v[104:107], v1, s[28:31], s46 offen offset:3072 sc1
    buffer_load_dwordx4 v1, s[28:31], s66 offen offset:3072 sc1 lds
    s_add_u32 s66, s66, 4096
    s_waitcnt vmcnt(23)
    v_mfma_f32_32x32x16_bf16 v[160:175], v[60:63], v[16:19], v[160:175]
    buffer_load_dwordx4 v[60:63], v1, s[28:31], s47 offen offset:0 sc1
    s_waitcnt vmcnt(23)
    v_mfma_f32_32x32x16_bf16 v[160:175], v[76:79], v[20:23], v[160:175]
    buffer_load_dwordx4 v[76:79], v1, s[28:31], s47 offen offset:1024 sc1
    s_setprio 2
    v_and_b32 v2, 31, v0
    v_lshlrev_b32 v4, 2, v2
    v_lshlrev_b32 v2, 1, v2
    v_add_u32 v3, 0x10000, v1
    v_add_u32 v5, -16, v13
    s_setprio 0
    s_lshl_b32 s59, s60, 6
    buffer_load_ushort v6, v2, s[40:43], s59 offen
    s_lshl_b32 s74, s60, 7
    s_add_u32 s74, s74, 23068672
    buffer_load_dword v8, v4, s[28:31], s74 offen sc1
    s_lshl_b32 s59, s61, 6
    buffer_load_ushort v7, v2, s[40:43], s59 offen
    s_lshl_b32 s75, s61, 7
    s_add_u32 s75, s75, 23068672
    buffer_load_dword v9, v4, s[28:31], s75 offen sc1
    s_waitcnt vmcnt(27)
    v_mfma_f32_32x32x16_bf16 v[160:175], v[92:95], v[24:27], v[160:175]
    buffer_load_dwordx4 v[92:95], v1, s[28:31], s47 offen offset:2048 sc1
    s_waitcnt vmcnt(27)
    v_mfma_f32_32x32x16_bf16 v[160:175], v[108:111], v[28:31], v[160:175]
    buffer_load_dwordx4 v[108:111], v1, s[28:31], s47 offen offset:3072 sc1
    s_cmp_lg_u32 s57, 0
    s_cbranch_scc1 L_w1
    s_waitcnt vmcnt(27)
    v_mfma_f32_32x32x16_bf16 v[112:127], v[48:51], v[224:227], v[112:127]
    v_mfma_f32_32x32x16_bf16 v[176:191], v[48:51], v[240:243], v[176:191]
    buffer_load_dwordx4 v[32:35], v1, s[28:31], s76 offen offset:0 sc1
    buffer_load_dwordx4 v[16:19], v1, s[28:31], s48 offen offset:0 sc1
    s_waitcnt vmcnt(28)
    v_mfma_f32_32x32x16_bf16 v[112:127], v[64:67], v[228:231], v[112:127]
    v_mfma_f32_32x32x16_bf16 v[176:191], v[64:67], v[244:247], v[176:191]
    buffer_load_dwordx4 v[36:39], v1, s[28:31], s76 offen offset:1024 sc1
    buffer_load_dwordx4 v[20:23], v1, s[28:31], s49 offen offset:0 sc1
    s_waitcnt vmcnt(29)
    v_mfma_f32_32x32x16_bf16 v[112:127], v[80:83], v[232:235], v[112:127]
    v_mfma_f32_32x32x16_bf16 v[176:191], v[80:83], v[248:251], v[176:191]
    buffer_load_dwordx4 v[40:43], v1, s[28:31], s77 offen offset:0 sc1
    buffer_load_dwordx4 v[24:27], v1, s[28:31], s48 offen offset:1024 sc1
    s_waitcnt vmcnt(29)
    v_mfma_f32_32x32x16_bf16 v[112:127], v[96:99], v[236:239], v[112:127]
    v_mfma_f32_32x32x16_bf16 v[176:191], v[96:99], v[252:255], v[176:191]
    buffer_load_dwordx4 v[44:47], v1, s[28:31], s77 offen offset:1024 sc1
    buffer_load_dwordx4 v[28:31], v1, s[28:31], s49 offen offset:1024 sc1
    s_waitcnt vmcnt(29)
    v_mfma_f32_32x32x16_bf16 v[128:143], v[52:55], v[224:227], v[128:143]
    v_mfma_f32_32x32x16_bf16 v[192:207], v[52:55], v[240:243], v[192:207]
    s_setprio 2
    s_mov_b32 s91, 65536
L_pa0:
    ds_read_b128 v[52:55], v14 offset:0
    s_waitcnt lgkmcnt(0)
    v_and_b32 v52, v52, v53
    v_and_b32 v54, v54, v55
    v_and_b32 v52, v52, v54
    s_sub_u32 s91, s91, 1
    v_readfirstlane_b32 s3, v52
    s_cbranch_scc1 L_pa0d
    s_cmp_lg_u32 s3, 0
    s_cbranch_scc1 L_pa0d
    s_sleep 2
    s_branch L_pa0
L_pa0d:
    s_setprio 0
    buffer_load_dwordx4 v[48:51], v1, s[28:31], s48 offen offset:2048 sc1
    buffer_load_dwordx4 v[64:67], v1, s[28:31], s49 offen offset:2048 sc1
    s_waitcnt vmcnt(29)
    v_mfma_f32_32x32x16_bf16 v[128:143], v[68:71], v[228:231], v[128:143]
    v_mfma_f32_32x32x16_bf16 v[192:207], v[68:71], v[244:247], v[192:207]
    buffer_load_dwordx4 v[80:83], v1, s[28:31], s48 offen offset:3072 sc1
    buffer_load_dwordx4 v[96:99], v1, s[28:31], s49 offen offset:3072 sc1
    s_add_u32 s48, s48, 4096
    s_add_u32 s49, s49, 4096
    ds_write_b128 v1, v[176:179] offset:51200
    ds_write_b128 v1, v[180:183] offset:52224
    ds_write_b128 v1, v[184:187] offset:57344
    s_waitcnt vmcnt(29)
    v_mfma_f32_32x32x16_bf16 v[128:143], v[84:87], v[232:235], v[128:143]
    v_mfma_f32_32x32x16_bf16 v[192:207], v[84:87], v[248:251], v[192:207]
    buffer_load_dwordx4 v[52:55], v1, s[28:31], s48 offen offset:0 sc1
    buffer_load_dwordx4 v[68:71], v1, s[28:31], s49 offen offset:0 sc1
    ds_write_b128 v1, v[188:191] offset:58368
    s_waitcnt vmcnt(30)
    v_mfma_f32_32x32x16_bf16 v[128:143], v[100:103], v[236:239], v[128:143]
    v_mfma_f32_32x32x16_bf16 v[192:207], v[100:103], v[252:255], v[192:207]
    buffer_load_dwordx4 v[84:87], v1, s[28:31], s48 offen offset:1024 sc1
    buffer_load_dwordx4 v[100:103], v1, s[28:31], s49 offen offset:1024 sc1
    s_waitcnt vmcnt(31)
    v_mfma_f32_32x32x16_bf16 v[144:159], v[56:59], v[224:227], v[144:159]
    v_mfma_f32_32x32x16_bf16 v[208:223], v[56:59], v[240:243], v[208:223]
    buffer_load_dwordx4 v[56:59], v1, s[28:31], s48 offen offset:2048 sc1
    s_waitcnt vmcnt(30)
    v_mfma_f32_32x32x16_bf16 v[144:159], v[72:75], v[228:231], v[144:159]
    v_mfma_f32_32x32x16_bf16 v[208:223], v[72:75], v[244:247], v[208:223]
    buffer_load_dwordx4 v[72:75], v1, s[28:31], s49 offen offset:2048 sc1
    s_nop 3
    ds_write_b128 v1, v[192:195] offset:63488
    ds_write_b128 v1, v[196:199] offset:64512
    ds_write_b128 v3, v[200:203] offset:4096
    s_waitcnt vmcnt(29)
    v_mfma_f32_32x32x16_bf16 v[144:159], v[88:91], v[232:235], v[144:159]
    v_mfma_f32_32x32x16_bf16 v[208:223], v[88:91], v[248:251], v[208:223]
    buffer_load_dwordx4 v[88:91], v1, s[28:31], s48 offen offset:3072 sc1
    ds_write_b128 v3, v[204:207] offset:5120
    s_waitcnt vmcnt(28)
    v_mfma_f32_32x32x16_bf16 v[144:159], v[104:107], v[236:239], v[144:159]
    v_mfma_f32_32x32x16_bf16 v[208:223], v[104:107], v[252:255], v[208:223]
    buffer_load_dwordx4 v[104:107], v1, s[28:31], s49 offen offset:3072 sc1
    s_add_u32 s48, s48, 4096
    s_add_u32 s49, s49, 4096
    s_waitcnt vmcnt(27)
    v_mfma_f32_32x32x16_bf16 v[160:175], v[60:63], v[224:227], v[160:175]
    buffer_load_dwordx4 v[60:63], v1, s[28:31], s48 offen offset:0 sc1
    s_waitcnt vmcnt(27)
    v_mfma_f32_32x32x16_bf16 v[160:175], v[76:79], v[228:231], v[160:175]
    buffer_load_dwordx4 v[76:79], v1, s[28:31], s49 offen offset:0 sc1
    s_nop 5
    ds_write_b128 v1, v[144:147] offset:26624
    ds_write_b128 v1, v[148:151] offset:27648
    ds_write_b128 v1, v[152:155] offset:32768
    s_waitcnt vmcnt(23)
    v_mfma_f32_32x32x16_bf16 v[160:175], v[92:95], v[232:235], v[160:175]
    buffer_load_dwordx4 v[92:95], v1, s[28:31], s48 offen offset:1024 sc1
    ds_write_b128 v1, v[156:159] offset:33792
    ds_write_b128 v3, v[208:211] offset:10240
    ds_write_b128 v3, v[212:215] offset:11264
    s_waitcnt vmcnt(23)
    v_mfma_f32_32x32x16_bf16 v[160:175], v[108:111], v[236:239], v[160:175]
    buffer_load_dwordx4 v[108:111], v1, s[28:31], s49 offen offset:1024 sc1
    ds_write_b128 v3, v[216:219] offset:16384
    ds_write_b128 v3, v[220:223] offset:17408
    s_setprio 2
    s_nop 7
    s_nop 1
    ds_write_b128 v1, v[160:163] offset:38912
    ds_write_b128 v1, v[164:167] offset:39936
    ds_write_b128 v1, v[168:171] offset:45056
    ds_write_b128 v1, v[172:175] offset:46080
    s_waitcnt lgkmcnt(0)
    ds_write_b32 v5, v15
    buffer_load_dwordx4 v[224:227], v1, s[28:31], s48 offen offset:2048 sc1
    buffer_load_dwordx4 v[228:231], v1, s[28:31], s49 offen offset:2048 sc1
    buffer_load_dwordx4 v[232:235], v1, s[28:31], s48 offen offset:3072 sc1
    buffer_load_dwordx4 v[236:239], v1, s[28:31], s49 offen offset:3072 sc1
    s_add_u32 s48, s48, 4096
    s_add_u32 s49, s49, 4096
    buffer_load_dwordx4 v[240:243], v1, s[28:31], s48 offen offset:0 sc1
    buffer_load_dwordx4 v[244:247], v1, s[28:31], s49 offen offset:0 sc1
    buffer_load_dwordx4 v[248:251], v1, s[28:31], s48 offen offset:1024 sc1
    buffer_load_dwordx4 v[252:255], v1, s[28:31], s49 offen offset:1024 sc1
    s_waitcnt vmcnt(25)
    s_mov_b32 s91, 65536
L_gp0:
    v_or_b32 v192, v8, v9
    v_cmp_gt_i32 vcc, 0, v192
    s_sub_u32 s91, s91, 1
    s_cbranch_scc1 L_gp0d
    s_cmp_eq_u64 vcc, 0
    s_cbranch_scc1 L_gp0d
    buffer_load_dword v8, v4, s[28:31], s74 offen sc1
    buffer_load_dword v9, v4, s[28:31], s75 offen sc1
    s_waitcnt vmcnt(0)
    s_branch L_gp0
L_gp0d:
    v_sub_f32 v200, 1.0, v8
    v_lshlrev_b32 v6, 16, v6
    v_mov_b32 v201, v200
    v_mul_f32 v202, v6, v200
    v_mov_b32 v203, v202
    v_sub_f32 v204, 1.0, v9
    v_lshlrev_b32 v7, 16, v7
    v_mov_b32 v205, v204
    v_mul_f32 v206, v7, v204
    v_mov_b32 v207, v206
    s_mov_b32 s91, 65536
L_pb0:
    ds_read_b128 v[6:9], v14 offset:16
    s_waitcnt lgkmcnt(0)
    v_and_b32 v6, v6, v7
    v_and_b32 v8, v8, v9
    v_and_b32 v6, v6, v8
    s_sub_u32 s91, s91, 1
    v_readfirstlane_b32 s3, v6
    s_cbranch_scc1 L_pb0d
    s_cmp_lg_u32 s3, 0
    s_cbranch_scc1 L_pb0d
    s_sleep 2
    s_branch L_pb0
L_pb0d:
    ds_read_b128 v[144:147], v1 offset:2048
    ds_read_b128 v[148:151], v1 offset:3072
    ds_read_b128 v[152:155], v1 offset:4096
    ds_read_b128 v[156:159], v1 offset:5120
    ds_read_b128 v[160:163], v1 offset:6144
    ds_read_b128 v[164:167], v1 offset:7168
    ds_read_b128 v[168:171], v1 offset:8192
    ds_read_b128 v[172:175], v1 offset:9216
    ds_read_b128 v[176:179], v1 offset:10240
    ds_read_b128 v[180:183], v1 offset:11264
    ds_read_b128 v[184:187], v1 offset:12288
    ds_read_b128 v[188:191], v1 offset:13312
    v_lshlrev_b32 v192, 16, v32
    v_and_b32 v193, 0xffff0000, v32
    v_lshlrev_b32 v194, 16, v33
    v_and_b32 v195, 0xffff0000, v33
    v_lshlrev_b32 v196, 16, v34
    v_and_b32 v197, 0xffff0000, v34
    v_lshlrev_b32 v198, 16, v35
    v_and_b32 v199, 0xffff0000, v35
    s_waitcnt lgkmcnt(6)
    v_pk_add_f32 v[112:113], v[112:113], v[144:145]
    v_pk_add_f32 v[114:115], v[114:115], v[146:147]
    v_pk_add_f32 v[116:117], v[116:117], v[148:149]
    v_pk_add_f32 v[118:119], v[118:119], v[150:151]
    v_pk_add_f32 v[112:113], v[112:113], v[152:153]
    v_pk_add_f32 v[114:115], v[114:115], v[154:155]
    v_pk_add_f32 v[116:117], v[116:117], v[156:157]
    v_pk_add_f32 v[118:119], v[118:119], v[158:159]
    v_pk_add_f32 v[112:113], v[112:113], v[160:161]
    v_pk_add_f32 v[114:115], v[114:115], v[162:163]
    v_pk_add_f32 v[116:117], v[116:117], v[164:165]
    v_pk_add_f32 v[118:119], v[118:119], v[166:167]
    v_pk_fma_f32 v[112:113], v[112:113], v[200:201], v[202:203]
    v_pk_fma_f32 v[114:115], v[114:115], v[200:201], v[202:203]
    v_pk_fma_f32 v[116:117], v[116:117], v[200:201], v[202:203]
    v_pk_fma_f32 v[118:119], v[118:119], v[200:201], v[202:203]
    v_pk_mul_f32 v[112:113], v[112:113], v[192:193]
    v_pk_mul_f32 v[114:115], v[114:115], v[194:195]
    v_pk_mul_f32 v[116:117], v[116:117], v[196:197]
    v_pk_mul_f32 v[118:119], v[118:119], v[198:199]
    v_cvt_pk_bf16_f32 v32, v112, v113
    v_cvt_pk_bf16_f32 v33, v114, v115
    v_cvt_pk_bf16_f32 v34, v116, v117
    v_cvt_pk_bf16_f32 v35, v118, v119
    buffer_store_dwordx4 v[32:35], v1, s[28:31], s83 offen offset:0 sc1
    ds_read_b128 v[144:147], v1 offset:14336
    ds_read_b128 v[148:151], v1 offset:15360
    ds_read_b128 v[152:155], v1 offset:16384
    ds_read_b128 v[156:159], v1 offset:17408
    ds_read_b128 v[160:163], v1 offset:18432
    ds_read_b128 v[164:167], v1 offset:19456
    v_lshlrev_b32 v192, 16, v36
    v_and_b32 v193, 0xffff0000, v36
    v_lshlrev_b32 v194, 16, v37
    v_and_b32 v195, 0xffff0000, v37
    v_lshlrev_b32 v196, 16, v38
    v_and_b32 v197, 0xffff0000, v38
    v_lshlrev_b32 v198, 16, v39
    v_and_b32 v199, 0xffff0000, v39
    s_waitcnt lgkmcnt(6)
    v_pk_add_f32 v[120:121], v[120:121], v[168:169]
    v_pk_add_f32 v[122:123], v[122:123], v[170:171]
    v_pk_add_f32 v[124:125], v[124:125], v[172:173]
    v_pk_add_f32 v[126:127], v[126:127], v[174:175]
    v_pk_add_f32 v[120:121], v[120:121], v[176:177]
    v_pk_add_f32 v[122:123], v[122:123], v[178:179]
    v_pk_add_f32 v[124:125], v[124:125], v[180:181]
    v_pk_add_f32 v[126:127], v[126:127], v[182:183]
    v_pk_add_f32 v[120:121], v[120:121], v[184:185]
    v_pk_add_f32 v[122:123], v[122:123], v[186:187]
    v_pk_add_f32 v[124:125], v[124:125], v[188:189]
    v_pk_add_f32 v[126:127], v[126:127], v[190:191]
    v_pk_fma_f32 v[120:121], v[120:121], v[200:201], v[202:203]
    v_pk_fma_f32 v[122:123], v[122:123], v[200:201], v[202:203]
    v_pk_fma_f32 v[124:125], v[124:125], v[200:201], v[202:203]
    v_pk_fma_f32 v[126:127], v[126:127], v[200:201], v[202:203]
    v_pk_mul_f32 v[120:121], v[120:121], v[192:193]
    v_pk_mul_f32 v[122:123], v[122:123], v[194:195]
    v_pk_mul_f32 v[124:125], v[124:125], v[196:197]
    v_pk_mul_f32 v[126:127], v[126:127], v[198:199]
    v_cvt_pk_bf16_f32 v36, v120, v121
    v_cvt_pk_bf16_f32 v37, v122, v123
    v_cvt_pk_bf16_f32 v38, v124, v125
    v_cvt_pk_bf16_f32 v39, v126, v127
    buffer_store_dwordx4 v[36:39], v1, s[28:31], s83 offen offset:1024 sc1
    ds_read_b128 v[168:171], v1 offset:20480
    ds_read_b128 v[172:175], v1 offset:21504
    ds_read_b128 v[176:179], v1 offset:22528
    ds_read_b128 v[180:183], v1 offset:23552
    ds_read_b128 v[184:187], v1 offset:24576
    ds_read_b128 v[188:191], v1 offset:25600
    v_lshlrev_b32 v192, 16, v40
    v_and_b32 v193, 0xffff0000, v40
    v_lshlrev_b32 v194, 16, v41
    v_and_b32 v195, 0xffff0000, v41
    v_lshlrev_b32 v196, 16, v42
    v_and_b32 v197, 0xffff0000, v42
    v_lshlrev_b32 v198, 16, v43
    v_and_b32 v199, 0xffff0000, v43
    s_waitcnt lgkmcnt(6)
    v_pk_add_f32 v[128:129], v[128:129], v[144:145]
    v_pk_add_f32 v[130:131], v[130:131], v[146:147]
    v_pk_add_f32 v[132:133], v[132:133], v[148:149]
    v_pk_add_f32 v[134:135], v[134:135], v[150:151]
    v_pk_add_f32 v[128:129], v[128:129], v[152:153]
    v_pk_add_f32 v[130:131], v[130:131], v[154:155]
    v_pk_add_f32 v[132:133], v[132:133], v[156:157]
    v_pk_add_f32 v[134:135], v[134:135], v[158:159]
    v_pk_add_f32 v[128:129], v[128:129], v[160:161]
    v_pk_add_f32 v[130:131], v[130:131], v[162:163]
    v_pk_add_f32 v[132:133], v[132:133], v[164:165]
    v_pk_add_f32 v[134:135], v[134:135], v[166:167]
    v_pk_fma_f32 v[128:129], v[128:129], v[200:201], v[202:203]
    v_pk_fma_f32 v[130:131], v[130:131], v[200:201], v[202:203]
    v_pk_fma_f32 v[132:133], v[132:133], v[200:201], v[202:203]
    v_pk_fma_f32 v[134:135], v[134:135], v[200:201], v[202:203]
    v_pk_mul_f32 v[128:129], v[128:129], v[192:193]
    v_pk_mul_f32 v[130:131], v[130:131], v[194:195]
    v_pk_mul_f32 v[132:133], v[132:133], v[196:197]
    v_pk_mul_f32 v[134:135], v[134:135], v[198:199]
    v_cvt_pk_bf16_f32 v40, v128, v129
    v_cvt_pk_bf16_f32 v41, v130, v131
    v_cvt_pk_bf16_f32 v42, v132, v133
    v_cvt_pk_bf16_f32 v43, v134, v135
    buffer_store_dwordx4 v[40:43], v1, s[28:31], s84 offen offset:0 sc1
    v_lshlrev_b32 v192, 16, v44
    v_and_b32 v193, 0xffff0000, v44
    v_lshlrev_b32 v194, 16, v45
    v_and_b32 v195, 0xffff0000, v45
    v_lshlrev_b32 v196, 16, v46
    v_and_b32 v197, 0xffff0000, v46
    v_lshlrev_b32 v198, 16, v47
    v_and_b32 v199, 0xffff0000, v47
    s_waitcnt lgkmcnt(0)
    ds_write_b32 v13, v15 offset:80
    v_pk_add_f32 v[136:137], v[136:137], v[168:169]
    v_pk_add_f32 v[138:139], v[138:139], v[170:171]
    v_pk_add_f32 v[140:141], v[140:141], v[172:173]
    v_pk_add_f32 v[142:143], v[142:143], v[174:175]
    v_pk_add_f32 v[136:137], v[136:137], v[176:177]
    v_pk_add_f32 v[138:139], v[138:139], v[178:179]
    v_pk_add_f32 v[140:141], v[140:141], v[180:181]
    v_pk_add_f32 v[142:143], v[142:143], v[182:183]
    v_pk_add_f32 v[136:137], v[136:137], v[184:185]
    v_pk_add_f32 v[138:139], v[138:139], v[186:187]
    v_pk_add_f32 v[140:141], v[140:141], v[188:189]
    v_pk_add_f32 v[142:143], v[142:143], v[190:191]
    v_pk_fma_f32 v[136:137], v[136:137], v[200:201], v[202:203]
    v_pk_fma_f32 v[138:139], v[138:139], v[200:201], v[202:203]
    v_pk_fma_f32 v[140:141], v[140:141], v[200:201], v[202:203]
    v_pk_fma_f32 v[142:143], v[142:143], v[200:201], v[202:203]
    v_pk_mul_f32 v[136:137], v[136:137], v[192:193]
    v_pk_mul_f32 v[138:139], v[138:139], v[194:195]
    v_pk_mul_f32 v[140:141], v[140:141], v[196:197]
    v_pk_mul_f32 v[142:143], v[142:143], v[198:199]
    v_cvt_pk_bf16_f32 v44, v136, v137
    v_cvt_pk_bf16_f32 v45, v138, v139
    v_cvt_pk_bf16_f32 v46, v140, v141
    v_cvt_pk_bf16_f32 v47, v142, v143
    buffer_store_dwordx4 v[44:47], v1, s[28:31], s84 offen offset:1024 sc1
    s_branch L_fin
L_w1:
    s_cmp_lg_u32 s57, 1
    s_cbranch_scc1 L_w2
    s_waitcnt vmcnt(27)
    v_mfma_f32_32x32x16_bf16 v[112:127], v[48:51], v[224:227], v[112:127]
    v_mfma_f32_32x32x16_bf16 v[176:191], v[48:51], v[240:243], v[176:191]
    buffer_load_dwordx4 v[32:35], v1, s[28:31], s78 offen offset:0 sc1
    buffer_load_dwordx4 v[16:19], v1, s[28:31], s48 offen offset:0 sc1
    s_waitcnt vmcnt(28)
    v_mfma_f32_32x32x16_bf16 v[112:127], v[64:67], v[228:231], v[112:127]
    v_mfma_f32_32x32x16_bf16 v[176:191], v[64:67], v[244:247], v[176:191]
    buffer_load_dwordx4 v[36:39], v1, s[28:31], s78 offen offset:1024 sc1
    buffer_load_dwordx4 v[20:23], v1, s[28:31], s49 offen offset:0 sc1
    s_waitcnt vmcnt(29)
    v_mfma_f32_32x32x16_bf16 v[112:127], v[80:83], v[232:235], v[112:127]
    v_mfma_f32_32x32x16_bf16 v[176:191], v[80:83], v[248:251], v[176:191]
    buffer_load_dwordx4 v[40:43], v1, s[28:31], s79 offen offset:0 sc1
    buffer_load_dwordx4 v[24:27], v1, s[28:31], s48 offen offset:1024 sc1
    s_waitcnt vmcnt(29)
    v_mfma_f32_32x32x16_bf16 v[112:127], v[96:99], v[236:239], v[112:127]
    v_mfma_f32_32x32x16_bf16 v[176:191], v[96:99], v[252:255], v[176:191]
    buffer_load_dwordx4 v[44:47], v1, s[28:31], s79 offen offset:1024 sc1
    buffer_load_dwordx4 v[28:31], v1, s[28:31], s49 offen offset:1024 sc1
    s_waitcnt vmcnt(29)
    v_mfma_f32_32x32x16_bf16 v[128:143], v[52:55], v[224:227], v[128:143]
    v_mfma_f32_32x32x16_bf16 v[192:207], v[52:55], v[240:243], v[192:207]
    s_setprio 2
    s_mov_b32 s91, 65536
L_pa1:
    ds_read_b128 v[52:55], v14 offset:0
    s_waitcnt lgkmcnt(0)
    v_and_b32 v52, v52, v53
    v_and_b32 v54, v54, v55
    v_and_b32 v52, v52, v54
    s_sub_u32 s91, s91, 1
    v_readfirstlane_b32 s3, v52
    s_cbranch_scc1 L_pa1d
    s_cmp_lg_u32 s3, 0
    s_cbranch_scc1 L_pa1d
    s_sleep 2
    s_branch L_pa1
L_pa1d:
    s_setprio 0
    buffer_load_dwordx4 v[48:51], v1, s[28:31], s48 offen offset:2048 sc1
    buffer_load_dwordx4 v[64:67], v1, s[28:31], s49 offen offset:2048 sc1
    s_waitcnt vmcnt(29)
    v_mfma_f32_32x32x16_bf16 v[128:143], v[68:71], v[228:231], v[128:143]
    v_mfma_f32_32x32x16_bf16 v[192:207], v[68:71], v[244:247], v[192:207]
    buffer_load_dwordx4 v[80:83], v1, s[28:31], s48 offen offset:3072 sc1
    buffer_load_dwordx4 v[96:99], v1, s[28:31], s49 offen offset:3072 sc1
    s_add_u32 s48, s48, 4096
    s_add_u32 s49, s49, 4096
    ds_write_b128 v1, v[112:115] offset:2048
    ds_write_b128 v1, v[116:119] offset:3072
    ds_write_b128 v1, v[120:123] offset:8192
    s_waitcnt vmcnt(29)
    v_mfma_f32_32x32x16_bf16 v[128:143], v[84:87], v[232:235], v[128:143]
    v_mfma_f32_32x32x16_bf16 v[192:207], v[84:87], v[248:251], v[192:207]
    buffer_load_dwordx4 v[52:55], v1, s[28:31], s48 offen offset:0 sc1
    buffer_load_dwordx4 v[68:71], v1, s[28:31], s49 offen offset:0 sc1
    ds_write_b128 v1, v[124:127] offset:9216
    ds_write_b128 v1, v[176:179] offset:53248
    ds_write_b128 v1, v[180:183] offset:54272
    s_waitcnt vmcnt(30)
    v_mfma_f32_32x32x16_bf16 v[128:143], v[100:103], v[236:239], v[128:143]
    v_mfma_f32_32x32x16_bf16 v[192:207], v[100:103], v[252:255], v[192:207]
    buffer_load_dwordx4 v[84:87], v1, s[28:31], s48 offen offset:1024 sc1
    buffer_load_dwordx4 v[100:103], v1, s[28:31], s49 offen offset:1024 sc1
    ds_write_b128 v1, v[184:187] offset:59392
    ds_write_b128 v1, v[188:191] offset:60416
    s_waitcnt vmcnt(31)
    v_mfma_f32_32x32x16_bf16 v[144:159], v[56:59], v[224:227], v[144:159]
    v_mfma_f32_32x32x16_bf16 v[208:223], v[56:59], v[240:243], v[208:223]
    buffer_load_dwordx4 v[56:59], v1, s[28:31], s48 offen offset:2048 sc1
    s_waitcnt vmcnt(30)
    v_mfma_f32_32x32x16_bf16 v[144:159], v[72:75], v[228:231], v[144:159]
    v_mfma_f32_32x32x16_bf16 v[208:223], v[72:75], v[244:247], v[208:223]
    buffer_load_dwordx4 v[72:75], v1, s[28:31], s49 offen offset:2048 sc1
    s_nop 3
    ds_write_b128 v1, v[128:131] offset:14336
    ds_write_b128 v1, v[132:135] offset:15360
    ds_write_b128 v1, v[136:139] offset:20480
    s_waitcnt vmcnt(29)
    v_mfma_f32_32x32x16_bf16 v[144:159], v[88:91], v[232:235], v[144:159]
    v_mfma_f32_32x32x16_bf16 v[208:223], v[88:91], v[248:251], v[208:223]
    buffer_load_dwordx4 v[88:91], v1, s[28:31], s48 offen offset:3072 sc1
    ds_write_b128 v1, v[140:143] offset:21504
    ds_write_b128 v3, v[192:195] offset:0
    ds_write_b128 v3, v[196:199] offset:1024
    s_waitcnt vmcnt(28)
    v_mfma_f32_32x32x16_bf16 v[144:159], v[104:107], v[236:239], v[144:159]
    v_mfma_f32_32x32x16_bf16 v[208:223], v[104:107], v[252:255], v[208:223]
    buffer_load_dwordx4 v[104:107], v1, s[28:31], s49 offen offset:3072 sc1
    s_add_u32 s48, s48, 4096
    s_add_u32 s49, s49, 4096
    ds_write_b128 v3, v[200:203] offset:6144
    ds_write_b128 v3, v[204:207] offset:7168
    s_waitcnt vmcnt(27)
    v_mfma_f32_32x32x16_bf16 v[160:175], v[60:63], v[224:227], v[160:175]
    buffer_load_dwordx4 v[60:63], v1, s[28:31], s48 offen offset:0 sc1
    s_waitcnt vmcnt(27)
    v_mfma_f32_32x32x16_bf16 v[160:175], v[76:79], v[228:231], v[160:175]
    buffer_load_dwordx4 v[76:79], v1, s[28:31], s49 offen offset:0 sc1
    s_nop 5
    ds_write_b128 v3, v[208:211] offset:12288
    ds_write_b128 v3, v[212:215] offset:13312
    ds_write_b128 v3, v[216:219] offset:18432
    s_waitcnt vmcnt(23)
    v_mfma_f32_32x32x16_bf16 v[160:175], v[92:95], v[232:235], v[160:175]
    buffer_load_dwordx4 v[92:95], v1, s[28:31], s48 offen offset:1024 sc1
    ds_write_b128 v3, v[220:223] offset:19456
    s_waitcnt vmcnt(23)
    v_mfma_f32_32x32x16_bf16 v[160:175], v[108:111], v[236:239], v[160:175]
    buffer_load_dwordx4 v[108:111], v1, s[28:31], s49 offen offset:1024 sc1
    s_setprio 2
    s_nop 7
    s_nop 1
    s_waitcnt lgkmcnt(0)
    ds_write_b32 v5, v15
    buffer_load_dwordx4 v[224:227], v1, s[28:31], s48 offen offset:2048 sc1
    buffer_load_dwordx4 v[228:231], v1, s[28:31], s49 offen offset:2048 sc1
    buffer_load_dwordx4 v[232:235], v1, s[28:31], s48 offen offset:3072 sc1
    buffer_load_dwordx4 v[236:239], v1, s[28:31], s49 offen offset:3072 sc1
    s_add_u32 s48, s48, 4096
    s_add_u32 s49, s49, 4096
    buffer_load_dwordx4 v[240:243], v1, s[28:31], s48 offen offset:0 sc1
    buffer_load_dwordx4 v[244:247], v1, s[28:31], s49 offen offset:0 sc1
    buffer_load_dwordx4 v[248:251], v1, s[28:31], s48 offen offset:1024 sc1
    buffer_load_dwordx4 v[252:255], v1, s[28:31], s49 offen offset:1024 sc1
    s_waitcnt vmcnt(25)
    s_mov_b32 s91, 65536
L_gp1:
    v_or_b32 v192, v8, v9
    v_cmp_gt_i32 vcc, 0, v192
    s_sub_u32 s91, s91, 1
    s_cbranch_scc1 L_gp1d
    s_cmp_eq_u64 vcc, 0
    s_cbranch_scc1 L_gp1d
    buffer_load_dword v8, v4, s[28:31], s74 offen sc1
    buffer_load_dword v9, v4, s[28:31], s75 offen sc1
    s_waitcnt vmcnt(0)
    s_branch L_gp1
L_gp1d:
    v_sub_f32 v200, 1.0, v8
    v_lshlrev_b32 v6, 16, v6
    v_mov_b32 v201, v200
    v_mul_f32 v202, v6, v200
    v_mov_b32 v203, v202
    v_sub_f32 v204, 1.0, v9
    v_lshlrev_b32 v7, 16, v7
    v_mov_b32 v205, v204
    v_mul_f32 v206, v7, v204
    v_mov_b32 v207, v206
    s_mov_b32 s91, 65536
L_pb1:
    ds_read_b128 v[6:9], v14 offset:16
    s_waitcnt lgkmcnt(0)
    v_and_b32 v6, v6, v7
    v_and_b32 v8, v8, v9
    v_and_b32 v6, v6, v8
    s_sub_u32 s91, s91, 1
    v_readfirstlane_b32 s3, v6
    s_cbranch_scc1 L_pb1d
    s_cmp_lg_u32 s3, 0
    s_cbranch_scc1 L_pb1d
    s_sleep 2
    s_branch L_pb1
L_pb1d:
    ds_read_b128 v[112:115], v1 offset:26624
    ds_read_b128 v[116:119], v1 offset:27648
    ds_read_b128 v[120:123], v1 offset:28672
    ds_read_b128 v[124:127], v1 offset:29696
    ds_read_b128 v[128:131], v1 offset:30720
    ds_read_b128 v[132:135], v1 offset:31744
    ds_read_b128 v[136:139], v1 offset:32768
    ds_read_b128 v[140:143], v1 offset:33792
    ds_read_b128 v[176:179], v1 offset:34816
    ds_read_b128 v[180:183], v1 offset:35840
    ds_read_b128 v[184:187], v1 offset:36864
    ds_read_b128 v[188:191], v1 offset:37888
    v_lshlrev_b32 v192, 16, v32
    v_and_b32 v193, 0xffff0000, v32
    v_lshlrev_b32 v194, 16, v33
    v_and_b32 v195, 0xffff0000, v33
    v_lshlrev_b32 v196, 16, v34
    v_and_b32 v197, 0xffff0000, v34
    v_lshlrev_b32 v198, 16, v35
    v_and_b32 v199, 0xffff0000, v35
    s_waitcnt lgkmcnt(6)
    v_pk_add_f32 v[144:145], v[144:145], v[112:113]
    v_pk_add_f32 v[146:147], v[146:147], v[114:115]
    v_pk_add_f32 v[148:149], v[148:149], v[116:117]
    v_pk_add_f32 v[150:151], v[150:151], v[118:119]
    v_pk_add_f32 v[144:145], v[144:145], v[120:121]
    v_pk_add_f32 v[146:147], v[146:147], v[122:123]
    v_pk_add_f32 v[148:149], v[148:149], v[124:125]
    v_pk_add_f32 v[150:151], v[150:151], v[126:127]
    v_pk_add_f32 v[144:145], v[144:145], v[128:129]
    v_pk_add_f32 v[146:147], v[146:147], v[130:131]
    v_pk_add_f32 v[148:149], v[148:149], v[132:133]
    v_pk_add_f32 v[150:151], v[150:151], v[134:135]
    v_pk_fma_f32 v[144:145], v[144:145], v[200:201], v[202:203]
    v_pk_fma_f32 v[146:147], v[146:147], v[200:201], v[202:203]
    v_pk_fma_f32 v[148:149], v[148:149], v[200:201], v[202:203]
    v_pk_fma_f32 v[150:151], v[150:151], v[200:201], v[202:203]
    v_pk_mul_f32 v[144:145], v[144:145], v[192:193]
    v_pk_mul_f32 v[146:147], v[146:147], v[194:195]
    v_pk_mul_f32 v[148:149], v[148:149], v[196:197]
    v_pk_mul_f32 v[150:151], v[150:151], v[198:199]
    v_cvt_pk_bf16_f32 v32, v144, v145
    v_cvt_pk_bf16_f32 v33, v146, v147
    v_cvt_pk_bf16_f32 v34, v148, v149
    v_cvt_pk_bf16_f32 v35, v150, v151
    buffer_store_dwordx4 v[32:35], v1, s[28:31], s85 offen offset:0 sc1
    ds_read_b128 v[112:115], v1 offset:38912
    ds_read_b128 v[116:119], v1 offset:39936
    ds_read_b128 v[120:123], v1 offset:40960
    ds_read_b128 v[124:127], v1 offset:41984
    ds_read_b128 v[128:131], v1 offset:43008
    ds_read_b128 v[132:135], v1 offset:44032
    v_lshlrev_b32 v192, 16, v36
    v_and_b32 v193, 0xffff0000, v36
    v_lshlrev_b32 v194, 16, v37
    v_and_b32 v195, 0xffff0000, v37
    v_lshlrev_b32 v196, 16, v38
    v_and_b32 v197, 0xffff0000, v38
    v_lshlrev_b32 v198, 16, v39
    v_and_b32 v199, 0xffff0000, v39
    s_waitcnt lgkmcnt(6)
    v_pk_add_f32 v[152:153], v[152:153], v[136:137]
    v_pk_add_f32 v[154:155], v[154:155], v[138:139]
    v_pk_add_f32 v[156:157], v[156:157], v[140:141]
    v_pk_add_f32 v[158:159], v[158:159], v[142:143]
    v_pk_add_f32 v[152:153], v[152:153], v[176:177]
    v_pk_add_f32 v[154:155], v[154:155], v[178:179]
    v_pk_add_f32 v[156:157], v[156:157], v[180:181]
    v_pk_add_f32 v[158:159], v[158:159], v[182:183]
    v_pk_add_f32 v[152:153], v[152:153], v[184:185]
    v_pk_add_f32 v[154:155], v[154:155], v[186:187]
    v_pk_add_f32 v[156:157], v[156:157], v[188:189]
    v_pk_add_f32 v[158:159], v[158:159], v[190:191]
    v_pk_fma_f32 v[152:153], v[152:153], v[200:201], v[202:203]
    v_pk_fma_f32 v[154:155], v[154:155], v[200:201], v[202:203]
    v_pk_fma_f32 v[156:157], v[156:157], v[200:201], v[202:203]
    v_pk_fma_f32 v[158:159], v[158:159], v[200:201], v[202:203]
    v_pk_mul_f32 v[152:153], v[152:153], v[192:193]
    v_pk_mul_f32 v[154:155], v[154:155], v[194:195]
    v_pk_mul_f32 v[156:157], v[156:157], v[196:197]
    v_pk_mul_f32 v[158:159], v[158:159], v[198:199]
    v_cvt_pk_bf16_f32 v36, v152, v153
    v_cvt_pk_bf16_f32 v37, v154, v155
    v_cvt_pk_bf16_f32 v38, v156, v157
    v_cvt_pk_bf16_f32 v39, v158, v159
    buffer_store_dwordx4 v[36:39], v1, s[28:31], s85 offen offset:1024 sc1
    ds_read_b128 v[136:139], v1 offset:45056
    ds_read_b128 v[140:143], v1 offset:46080
    ds_read_b128 v[176:179], v1 offset:47104
    ds_read_b128 v[180:183], v1 offset:48128
    ds_read_b128 v[184:187], v1 offset:49152
    ds_read_b128 v[188:191], v1 offset:50176
    v_lshlrev_b32 v192, 16, v40
    v_and_b32 v193, 0xffff0000, v40
    v_lshlrev_b32 v194, 16, v41
    v_and_b32 v195, 0xffff0000, v41
    v_lshlrev_b32 v196, 16, v42
    v_and_b32 v197, 0xffff0000, v42
    v_lshlrev_b32 v198, 16, v43
    v_and_b32 v199, 0xffff0000, v43
    s_waitcnt lgkmcnt(6)
    v_pk_add_f32 v[160:161], v[160:161], v[112:113]
    v_pk_add_f32 v[162:163], v[162:163], v[114:115]
    v_pk_add_f32 v[164:165], v[164:165], v[116:117]
    v_pk_add_f32 v[166:167], v[166:167], v[118:119]
    v_pk_add_f32 v[160:161], v[160:161], v[120:121]
    v_pk_add_f32 v[162:163], v[162:163], v[122:123]
    v_pk_add_f32 v[164:165], v[164:165], v[124:125]
    v_pk_add_f32 v[166:167], v[166:167], v[126:127]
    v_pk_add_f32 v[160:161], v[160:161], v[128:129]
    v_pk_add_f32 v[162:163], v[162:163], v[130:131]
    v_pk_add_f32 v[164:165], v[164:165], v[132:133]
    v_pk_add_f32 v[166:167], v[166:167], v[134:135]
    v_pk_fma_f32 v[160:161], v[160:161], v[200:201], v[202:203]
    v_pk_fma_f32 v[162:163], v[162:163], v[200:201], v[202:203]
    v_pk_fma_f32 v[164:165], v[164:165], v[200:201], v[202:203]
    v_pk_fma_f32 v[166:167], v[166:167], v[200:201], v[202:203]
    v_pk_mul_f32 v[160:161], v[160:161], v[192:193]
    v_pk_mul_f32 v[162:163], v[162:163], v[194:195]
    v_pk_mul_f32 v[164:165], v[164:165], v[196:197]
    v_pk_mul_f32 v[166:167], v[166:167], v[198:199]
    v_cvt_pk_bf16_f32 v40, v160, v161
    v_cvt_pk_bf16_f32 v41, v162, v163
    v_cvt_pk_bf16_f32 v42, v164, v165
    v_cvt_pk_bf16_f32 v43, v166, v167
    buffer_store_dwordx4 v[40:43], v1, s[28:31], s86 offen offset:0 sc1
    v_lshlrev_b32 v192, 16, v44
    v_and_b32 v193, 0xffff0000, v44
    v_lshlrev_b32 v194, 16, v45
    v_and_b32 v195, 0xffff0000, v45
    v_lshlrev_b32 v196, 16, v46
    v_and_b32 v197, 0xffff0000, v46
    v_lshlrev_b32 v198, 16, v47
    v_and_b32 v199, 0xffff0000, v47
    s_waitcnt lgkmcnt(0)
    ds_write_b32 v13, v15 offset:80
    v_pk_add_f32 v[168:169], v[168:169], v[136:137]
    v_pk_add_f32 v[170:171], v[170:171], v[138:139]
    v_pk_add_f32 v[172:173], v[172:173], v[140:141]
    v_pk_add_f32 v[174:175], v[174:175], v[142:143]
    v_pk_add_f32 v[168:169], v[168:169], v[176:177]
    v_pk_add_f32 v[170:171], v[170:171], v[178:179]
    v_pk_add_f32 v[172:173], v[172:173], v[180:181]
    v_pk_add_f32 v[174:175], v[174:175], v[182:183]
    v_pk_add_f32 v[168:169], v[168:169], v[184:185]
    v_pk_add_f32 v[170:171], v[170:171], v[186:187]
    v_pk_add_f32 v[172:173], v[172:173], v[188:189]
    v_pk_add_f32 v[174:175], v[174:175], v[190:191]
    v_pk_fma_f32 v[168:169], v[168:169], v[200:201], v[202:203]
    v_pk_fma_f32 v[170:171], v[170:171], v[200:201], v[202:203]
    v_pk_fma_f32 v[172:173], v[172:173], v[200:201], v[202:203]
    v_pk_fma_f32 v[174:175], v[174:175], v[200:201], v[202:203]
    v_pk_mul_f32 v[168:169], v[168:169], v[192:193]
    v_pk_mul_f32 v[170:171], v[170:171], v[194:195]
    v_pk_mul_f32 v[172:173], v[172:173], v[196:197]
    v_pk_mul_f32 v[174:175], v[174:175], v[198:199]
    v_cvt_pk_bf16_f32 v44, v168, v169
    v_cvt_pk_bf16_f32 v45, v170, v171
    v_cvt_pk_bf16_f32 v46, v172, v173
    v_cvt_pk_bf16_f32 v47, v174, v175
    buffer_store_dwordx4 v[44:47], v1, s[28:31], s86 offen offset:1024 sc1
    s_branch L_fin
L_w2:
    s_cmp_lg_u32 s57, 2
    s_cbranch_scc1 L_w3
    s_waitcnt vmcnt(27)
    v_mfma_f32_32x32x16_bf16 v[112:127], v[48:51], v[224:227], v[112:127]
    v_mfma_f32_32x32x16_bf16 v[176:191], v[48:51], v[240:243], v[176:191]
    buffer_load_dwordx4 v[32:35], v1, s[28:31], s80 offen offset:0 sc1
    buffer_load_dwordx4 v[16:19], v1, s[28:31], s48 offen offset:0 sc1
    s_waitcnt vmcnt(28)
    v_mfma_f32_32x32x16_bf16 v[112:127], v[64:67], v[228:231], v[112:127]
    v_mfma_f32_32x32x16_bf16 v[176:191], v[64:67], v[244:247], v[176:191]
    buffer_load_dwordx4 v[36:39], v1, s[28:31], s80 offen offset:1024 sc1
    buffer_load_dwordx4 v[20:23], v1, s[28:31], s49 offen offset:0 sc1
    s_waitcnt vmcnt(29)
    v_mfma_f32_32x32x16_bf16 v[112:127], v[80:83], v[232:235], v[112:127]
    v_mfma_f32_32x32x16_bf16 v[176:191], v[80:83], v[248:251], v[176:191]
    buffer_load_dwordx4 v[40:43], v1, s[28:31], s81 offen offset:0 sc1
    buffer_load_dwordx4 v[24:27], v1, s[28:31], s48 offen offset:1024 sc1
    s_waitcnt vmcnt(29)
    v_mfma_f32_32x32x16_bf16 v[112:127], v[96:99], v[236:239], v[112:127]
    v_mfma_f32_32x32x16_bf16 v[176:191], v[96:99], v[252:255], v[176:191]
    buffer_load_dwordx4 v[28:31], v1, s[28:31], s49 offen offset:1024 sc1
    s_waitcnt vmcnt(28)
    v_mfma_f32_32x32x16_bf16 v[128:143], v[52:55], v[224:227], v[128:143]
    v_mfma_f32_32x32x16_bf16 v[192:207], v[52:55], v[240:243], v[192:207]
    s_setprio 2
    s_mov_b32 s91, 65536
L_pa2:
    ds_read_b128 v[52:55], v14 offset:0
    s_waitcnt lgkmcnt(0)
    v_and_b32 v52, v52, v53
    v_and_b32 v54, v54, v55
    v_and_b32 v52, v52, v54
    s_sub_u32 s91, s91, 1
    v_readfirstlane_b32 s3, v52
    s_cbranch_scc1 L_pa2d
    s_cmp_lg_u32 s3, 0
    s_cbranch_scc1 L_pa2d
    s_sleep 2
    s_branch L_pa2
L_pa2d:
    s_setprio 0
    buffer_load_dwordx4 v[48:51], v1, s[28:31], s48 offen offset:2048 sc1
    buffer_load_dwordx4 v[64:67], v1, s[28:31], s49 offen offset:2048 sc1
    s_waitcnt vmcnt(28)
    v_mfma_f32_32x32x16_bf16 v[128:143], v[68:71], v[228:231], v[128:143]
    v_mfma_f32_32x32x16_bf16 v[192:207], v[68:71], v[244:247], v[192:207]
    buffer_load_dwordx4 v[80:83], v1, s[28:31], s48 offen offset:3072 sc1
    buffer_load_dwordx4 v[96:99], v1, s[28:31], s49 offen offset:3072 sc1
    s_add_u32 s48, s48, 4096
    s_add_u32 s49, s49, 4096
    ds_write_b128 v1, v[112:115] offset:4096
    ds_write_b128 v1, v[116:119] offset:5120
    ds_write_b128 v1, v[120:123] offset:10240
    s_waitcnt vmcnt(28)
    v_mfma_f32_32x32x16_bf16 v[128:143], v[84:87], v[232:235], v[128:143]
    v_mfma_f32_32x32x16_bf16 v[192:207], v[84:87], v[248:251], v[192:207]
    buffer_load_dwordx4 v[52:55], v1, s[28:31], s48 offen offset:0 sc1
    buffer_load_dwordx4 v[68:71], v1, s[28:31], s49 offen offset:0 sc1
    ds_write_b128 v1, v[124:127] offset:11264
    s_waitcnt vmcnt(29)
    v_mfma_f32_32x32x16_bf16 v[128:143], v[100:103], v[236:239], v[128:143]
    v_mfma_f32_32x32x16_bf16 v[192:207], v[100:103], v[252:255], v[192:207]
    buffer_load_dwordx4 v[84:87], v1, s[28:31], s48 offen offset:1024 sc1
    buffer_load_dwordx4 v[100:103], v1, s[28:31], s49 offen offset:1024 sc1
    s_waitcnt vmcnt(30)
    v_mfma_f32_32x32x16_bf16 v[144:159], v[56:59], v[224:227], v[144:159]
    v_mfma_f32_32x32x16_bf16 v[208:223], v[56:59], v[240:243], v[208:223]
    buffer_load_dwordx4 v[56:59], v1, s[28:31], s48 offen offset:2048 sc1
    s_waitcnt vmcnt(29)
    v_mfma_f32_32x32x16_bf16 v[144:159], v[72:75], v[228:231], v[144:159]
    v_mfma_f32_32x32x16_bf16 v[208:223], v[72:75], v[244:247], v[208:223]
    buffer_load_dwordx4 v[72:75], v1, s[28:31], s49 offen offset:2048 sc1
    s_nop 3
    ds_write_b128 v1, v[128:131] offset:16384
    ds_write_b128 v1, v[132:135] offset:17408
    ds_write_b128 v1, v[136:139] offset:22528
    s_waitcnt vmcnt(28)
    v_mfma_f32_32x32x16_bf16 v[144:159], v[88:91], v[232:235], v[144:159]
    v_mfma_f32_32x32x16_bf16 v[208:223], v[88:91], v[248:251], v[208:223]
    buffer_load_dwordx4 v[88:91], v1, s[28:31], s48 offen offset:3072 sc1
    ds_write_b128 v1, v[140:143] offset:23552
    ds_write_b128 v3, v[200:203] offset:8192
    ds_write_b128 v3, v[204:207] offset:9216
    s_waitcnt vmcnt(27)
    v_mfma_f32_32x32x16_bf16 v[144:159], v[104:107], v[236:239], v[144:159]
    v_mfma_f32_32x32x16_bf16 v[208:223], v[104:107], v[252:255], v[208:223]
    buffer_load_dwordx4 v[104:107], v1, s[28:31], s49 offen offset:3072 sc1
    s_add_u32 s48, s48, 4096
    s_add_u32 s49, s49, 4096
    s_waitcnt vmcnt(26)
    v_mfma_f32_32x32x16_bf16 v[160:175], v[60:63], v[224:227], v[160:175]
    buffer_load_dwordx4 v[60:63], v1, s[28:31], s48 offen offset:0 sc1
    s_waitcnt vmcnt(26)
    v_mfma_f32_32x32x16_bf16 v[160:175], v[76:79], v[228:231], v[160:175]
    buffer_load_dwordx4 v[76:79], v1, s[28:31], s49 offen offset:0 sc1
    s_nop 5
    ds_write_b128 v1, v[144:147] offset:28672
    ds_write_b128 v1, v[148:151] offset:29696
    ds_write_b128 v1, v[152:155] offset:34816
    s_waitcnt vmcnt(22)
    v_mfma_f32_32x32x16_bf16 v[160:175], v[92:95], v[232:235], v[160:175]
    buffer_load_dwordx4 v[92:95], v1, s[28:31], s48 offen offset:1024 sc1
    ds_write_b128 v1, v[156:159] offset:35840
    ds_write_b128 v3, v[208:211] offset:14336
    ds_write_b128 v3, v[212:215] offset:15360
    s_waitcnt vmcnt(22)
    v_mfma_f32_32x32x16_bf16 v[160:175], v[108:111], v[236:239], v[160:175]
    buffer_load_dwordx4 v[108:111], v1, s[28:31], s49 offen offset:1024 sc1
    ds_write_b128 v3, v[216:219] offset:20480
    ds_write_b128 v3, v[220:223] offset:21504
    s_setprio 2
    s_nop 7
    s_nop 1
    ds_write_b128 v1, v[160:163] offset:40960
    ds_write_b128 v1, v[164:167] offset:41984
    ds_write_b128 v1, v[168:171] offset:47104
    ds_write_b128 v1, v[172:175] offset:48128
    s_waitcnt lgkmcnt(0)
    ds_write_b32 v5, v15
    buffer_load_dwordx4 v[224:227], v1, s[28:31], s48 offen offset:2048 sc1
    buffer_load_dwordx4 v[228:231], v1, s[28:31], s49 offen offset:2048 sc1
    buffer_load_dwordx4 v[232:235], v1, s[28:31], s48 offen offset:3072 sc1
    buffer_load_dwordx4 v[236:239], v1, s[28:31], s49 offen offset:3072 sc1
    s_add_u32 s48, s48, 4096
    s_add_u32 s49, s49, 4096
    buffer_load_dwordx4 v[240:243], v1, s[28:31], s48 offen offset:0 sc1
    buffer_load_dwordx4 v[244:247], v1, s[28:31], s49 offen offset:0 sc1
    buffer_load_dwordx4 v[248:251], v1, s[28:31], s48 offen offset:1024 sc1
    buffer_load_dwordx4 v[252:255], v1, s[28:31], s49 offen offset:1024 sc1
    s_waitcnt vmcnt(26)
    s_mov_b32 s91, 65536
L_gp2:
    v_or_b32 v160, v8, v9
    v_cmp_gt_i32 vcc, 0, v160
    s_sub_u32 s91, s91, 1
    s_cbranch_scc1 L_gp2d
    s_cmp_eq_u64 vcc, 0
    s_cbranch_scc1 L_gp2d
    buffer_load_dword v8, v4, s[28:31], s74 offen sc1
    buffer_load_dword v9, v4, s[28:31], s75 offen sc1
    s_waitcnt vmcnt(0)
    s_branch L_gp2
L_gp2d:
    v_sub_f32 v168, 1.0, v8
    v_lshlrev_b32 v6, 16, v6
    v_mov_b32 v169, v168
    v_mul_f32 v170, v6, v168
    v_mov_b32 v171, v170
    v_sub_f32 v172, 1.0, v9
    v_lshlrev_b32 v7, 16, v7
    v_mov_b32 v173, v172
    v_mul_f32 v174, v7, v172
    v_mov_b32 v175, v174
    s_mov_b32 s91, 65536
L_pb2:
    ds_read_b128 v[6:9], v14 offset:16
    s_waitcnt lgkmcnt(0)
    v_and_b32 v6, v6, v7
    v_and_b32 v8, v8, v9
    v_and_b32 v6, v6, v8
    s_sub_u32 s91, s91, 1
    v_readfirstlane_b32 s3, v6
    s_cbranch_scc1 L_pb2d
    s_cmp_lg_u32 s3, 0
    s_cbranch_scc1 L_pb2d
    s_sleep 2
    s_branch L_pb2
L_pb2d:
    ds_read_b128 v[112:115], v1 offset:51200
    ds_read_b128 v[116:119], v1 offset:52224
    ds_read_b128 v[120:123], v1 offset:53248
    ds_read_b128 v[124:127], v1 offset:54272
    ds_read_b128 v[128:131], v1 offset:55296
    ds_read_b128 v[132:135], v1 offset:56320
    ds_read_b128 v[136:139], v1 offset:57344
    ds_read_b128 v[140:143], v1 offset:58368
    ds_read_b128 v[144:147], v1 offset:59392
    ds_read_b128 v[148:151], v1 offset:60416
    ds_read_b128 v[152:155], v1 offset:61440
    ds_read_b128 v[156:159], v1 offset:62464
    v_lshlrev_b32 v160, 16, v32
    v_and_b32 v161, 0xffff0000, v32
    v_lshlrev_b32 v162, 16, v33
    v_and_b32 v163, 0xffff0000, v33
    v_lshlrev_b32 v164, 16, v34
    v_and_b32 v165, 0xffff0000, v34
    v_lshlrev_b32 v166, 16, v35
    v_and_b32 v167, 0xffff0000, v35
    s_waitcnt lgkmcnt(6)
    v_pk_add_f32 v[176:177], v[176:177], v[112:113]
    v_pk_add_f32 v[178:179], v[178:179], v[114:115]
    v_pk_add_f32 v[180:181], v[180:181], v[116:117]
    v_pk_add_f32 v[182:183], v[182:183], v[118:119]
    v_pk_add_f32 v[176:177], v[176:177], v[120:121]
    v_pk_add_f32 v[178:179], v[178:179], v[122:123]
    v_pk_add_f32 v[180:181], v[180:181], v[124:125]
    v_pk_add_f32 v[182:183], v[182:183], v[126:127]
    v_pk_add_f32 v[176:177], v[176:177], v[128:129]
    v_pk_add_f32 v[178:179], v[178:179], v[130:131]
    v_pk_add_f32 v[180:181], v[180:181], v[132:133]
    v_pk_add_f32 v[182:183], v[182:183], v[134:135]
    v_pk_fma_f32 v[176:177], v[176:177], v[172:173], v[174:175]
    v_pk_fma_f32 v[178:179], v[178:179], v[172:173], v[174:175]
    v_pk_fma_f32 v[180:181], v[180:181], v[172:173], v[174:175]
    v_pk_fma_f32 v[182:183], v[182:183], v[172:173], v[174:175]
    v_pk_mul_f32 v[176:177], v[176:177], v[160:161]
    v_pk_mul_f32 v[178:179], v[178:179], v[162:163]
    v_pk_mul_f32 v[180:181], v[180:181], v[164:165]
    v_pk_mul_f32 v[182:183], v[182:183], v[166:167]
    v_cvt_pk_bf16_f32 v32, v176, v177
    v_cvt_pk_bf16_f32 v33, v178, v179
    v_cvt_pk_bf16_f32 v34, v180, v181
    v_cvt_pk_bf16_f32 v35, v182, v183
    buffer_store_dwordx4 v[32:35], v1, s[28:31], s87 offen offset:0 sc1
    ds_read_b128 v[112:115], v1 offset:63488
    ds_read_b128 v[116:119], v1 offset:64512
    ds_read_b128 v[120:123], v3 offset:0
    ds_read_b128 v[124:127], v3 offset:1024
    ds_read_b128 v[128:131], v3 offset:2048
    ds_read_b128 v[132:135], v3 offset:3072
    v_lshlrev_b32 v160, 16, v36
    v_and_b32 v161, 0xffff0000, v36
    v_lshlrev_b32 v162, 16, v37
    v_and_b32 v163, 0xffff0000, v37
    v_lshlrev_b32 v164, 16, v38
    v_and_b32 v165, 0xffff0000, v38
    v_lshlrev_b32 v166, 16, v39
    v_and_b32 v167, 0xffff0000, v39
    s_waitcnt lgkmcnt(6)
    v_pk_add_f32 v[184:185], v[184:185], v[136:137]
    v_pk_add_f32 v[186:187], v[186:187], v[138:139]
    v_pk_add_f32 v[188:189], v[188:189], v[140:141]
    v_pk_add_f32 v[190:191], v[190:191], v[142:143]
    v_pk_add_f32 v[184:185], v[184:185], v[144:145]
    v_pk_add_f32 v[186:187], v[186:187], v[146:147]
    v_pk_add_f32 v[188:189], v[188:189], v[148:149]
    v_pk_add_f32 v[190:191], v[190:191], v[150:151]
    v_pk_add_f32 v[184:185], v[184:185], v[152:153]
    v_pk_add_f32 v[186:187], v[186:187], v[154:155]
    v_pk_add_f32 v[188:189], v[188:189], v[156:157]
    v_pk_add_f32 v[190:191], v[190:191], v[158:159]
    v_pk_fma_f32 v[184:185], v[184:185], v[172:173], v[174:175]
    v_pk_fma_f32 v[186:187], v[186:187], v[172:173], v[174:175]
    v_pk_fma_f32 v[188:189], v[188:189], v[172:173], v[174:175]
    v_pk_fma_f32 v[190:191], v[190:191], v[172:173], v[174:175]
    v_pk_mul_f32 v[184:185], v[184:185], v[160:161]
    v_pk_mul_f32 v[186:187], v[186:187], v[162:163]
    v_pk_mul_f32 v[188:189], v[188:189], v[164:165]
    v_pk_mul_f32 v[190:191], v[190:191], v[166:167]
    v_cvt_pk_bf16_f32 v36, v184, v185
    v_cvt_pk_bf16_f32 v37, v186, v187
    v_cvt_pk_bf16_f32 v38, v188, v189
    v_cvt_pk_bf16_f32 v39, v190, v191
    buffer_store_dwordx4 v[36:39], v1, s[28:31], s87 offen offset:1024 sc1
    v_lshlrev_b32 v160, 16, v40
    v_and_b32 v161, 0xffff0000, v40
    v_lshlrev_b32 v162, 16, v41
    v_and_b32 v163, 0xffff0000, v41
    v_lshlrev_b32 v164, 16, v42
    v_and_b32 v165, 0xffff0000, v42
    v_lshlrev_b32 v166, 16, v43
    v_and_b32 v167, 0xffff0000, v43
    s_waitcnt lgkmcnt(0)
    ds_write_b32 v13, v15 offset:80
    v_pk_add_f32 v[192:193], v[192:193], v[112:113]
    v_pk_add_f32 v[194:195], v[194:195], v[114:115]
    v_pk_add_f32 v[196:197], v[196:197], v[116:117]
    v_pk_add_f32 v[198:199], v[198:199], v[118:119]
    v_pk_add_f32 v[192:193], v[192:193], v[120:121]
    v_pk_add_f32 v[194:195], v[194:195], v[122:123]
    v_pk_add_f32 v[196:197], v[196:197], v[124:125]
    v_pk_add_f32 v[198:199], v[198:199], v[126:127]
    v_pk_add_f32 v[192:193], v[192:193], v[128:129]
    v_pk_add_f32 v[194:195], v[194:195], v[130:131]
    v_pk_add_f32 v[196:197], v[196:197], v[132:133]
    v_pk_add_f32 v[198:199], v[198:199], v[134:135]
    v_pk_fma_f32 v[192:193], v[192:193], v[172:173], v[174:175]
    v_pk_fma_f32 v[194:195], v[194:195], v[172:173], v[174:175]
    v_pk_fma_f32 v[196:197], v[196:197], v[172:173], v[174:175]
    v_pk_fma_f32 v[198:199], v[198:199], v[172:173], v[174:175]
    v_pk_mul_f32 v[192:193], v[192:193], v[160:161]
    v_pk_mul_f32 v[194:195], v[194:195], v[162:163]
    v_pk_mul_f32 v[196:197], v[196:197], v[164:165]
    v_pk_mul_f32 v[198:199], v[198:199], v[166:167]
    v_cvt_pk_bf16_f32 v40, v192, v193
    v_cvt_pk_bf16_f32 v41, v194, v195
    v_cvt_pk_bf16_f32 v42, v196, v197
    v_cvt_pk_bf16_f32 v43, v198, v199
    buffer_store_dwordx4 v[40:43], v1, s[28:31], s88 offen offset:0 sc1
    s_branch L_fin
L_w3:
    s_waitcnt vmcnt(27)
    v_mfma_f32_32x32x16_bf16 v[112:127], v[48:51], v[224:227], v[112:127]
    v_mfma_f32_32x32x16_bf16 v[176:191], v[48:51], v[240:243], v[176:191]
    buffer_load_dwordx4 v[32:35], v1, s[28:31], s81 offen offset:1024 sc1
    buffer_load_dwordx4 v[16:19], v1, s[28:31], s48 offen offset:0 sc1
    s_waitcnt vmcnt(28)
    v_mfma_f32_32x32x16_bf16 v[112:127], v[64:67], v[228:231], v[112:127]
    v_mfma_f32_32x32x16_bf16 v[176:191], v[64:67], v[244:247], v[176:191]
    buffer_load_dwordx4 v[36:39], v1, s[28:31], s82 offen offset:0 sc1
    buffer_load_dwordx4 v[20:23], v1, s[28:31], s49 offen offset:0 sc1
    s_waitcnt vmcnt(29)
    v_mfma_f32_32x32x16_bf16 v[112:127], v[80:83], v[232:235], v[112:127]
    v_mfma_f32_32x32x16_bf16 v[176:191], v[80:83], v[248:251], v[176:191]
    buffer_load_dwordx4 v[40:43], v1, s[28:31], s82 offen offset:1024 sc1
    buffer_load_dwordx4 v[24:27], v1, s[28:31], s48 offen offset:1024 sc1
    s_waitcnt vmcnt(29)
    v_mfma_f32_32x32x16_bf16 v[112:127], v[96:99], v[236:239], v[112:127]
    v_mfma_f32_32x32x16_bf16 v[176:191], v[96:99], v[252:255], v[176:191]
    buffer_load_dwordx4 v[28:31], v1, s[28:31], s49 offen offset:1024 sc1
    s_waitcnt vmcnt(28)
    v_mfma_f32_32x32x16_bf16 v[128:143], v[52:55], v[224:227], v[128:143]
    v_mfma_f32_32x32x16_bf16 v[192:207], v[52:55], v[240:243], v[192:207]
    s_setprio 2
    s_mov_b32 s91, 65536
L_pa3:
    ds_read_b128 v[52:55], v14 offset:0
    s_waitcnt lgkmcnt(0)
    v_and_b32 v52, v52, v53
    v_and_b32 v54, v54, v55
    v_and_b32 v52, v52, v54
    s_sub_u32 s91, s91, 1
    v_readfirstlane_b32 s3, v52
    s_cbranch_scc1 L_pa3d
    s_cmp_lg_u32 s3, 0
    s_cbranch_scc1 L_pa3d
    s_sleep 2
    s_branch L_pa3
L_pa3d:
    s_setprio 0
    buffer_load_dwordx4 v[48:51], v1, s[28:31], s48 offen offset:2048 sc1
    buffer_load_dwordx4 v[64:67], v1, s[28:31], s49 offen offset:2048 sc1
    s_waitcnt vmcnt(28)
    v_mfma_f32_32x32x16_bf16 v[128:143], v[68:71], v[228:231], v[128:143]
    v_mfma_f32_32x32x16_bf16 v[192:207], v[68:71], v[244:247], v[192:207]
    buffer_load_dwordx4 v[80:83], v1, s[28:31], s48 offen offset:3072 sc1
    buffer_load_dwordx4 v[96:99], v1, s[28:31], s49 offen offset:3072 sc1
    s_add_u32 s48, s48, 4096
    s_add_u32 s49, s49, 4096
    ds_write_b128 v1, v[112:115] offset:6144
    ds_write_b128 v1, v[116:119] offset:7168
    ds_write_b128 v1, v[120:123] offset:12288
    s_waitcnt vmcnt(28)
    v_mfma_f32_32x32x16_bf16 v[128:143], v[84:87], v[232:235], v[128:143]
    v_mfma_f32_32x32x16_bf16 v[192:207], v[84:87], v[248:251], v[192:207]
    buffer_load_dwordx4 v[52:55], v1, s[28:31], s48 offen offset:0 sc1
    buffer_load_dwordx4 v[68:71], v1, s[28:31], s49 offen offset:0 sc1
    ds_write_b128 v1, v[124:127] offset:13312
    ds_write_b128 v1, v[176:179] offset:55296
    ds_write_b128 v1, v[180:183] offset:56320
    s_waitcnt vmcnt(29)
    v_mfma_f32_32x32x16_bf16 v[128:143], v[100:103], v[236:239], v[128:143]
    v_mfma_f32_32x32x16_bf16 v[192:207], v[100:103], v[252:255], v[192:207]
    buffer_load_dwordx4 v[84:87], v1, s[28:31], s48 offen offset:1024 sc1
    buffer_load_dwordx4 v[100:103], v1, s[28:31], s49 offen offset:1024 sc1
    ds_write_b128 v1, v[184:187] offset:61440
    ds_write_b128 v1, v[188:191] offset:62464
    s_waitcnt vmcnt(30)
    v_mfma_f32_32x32x16_bf16 v[144:159], v[56:59], v[224:227], v[144:159]
    v_mfma_f32_32x32x16_bf16 v[208:223], v[56:59], v[240:243], v[208:223]
    buffer_load_dwordx4 v[56:59], v1, s[28:31], s48 offen offset:2048 sc1
    s_waitcnt vmcnt(29)
    v_mfma_f32_32x32x16_bf16 v[144:159], v[72:75], v[228:231], v[144:159]
    v_mfma_f32_32x32x16_bf16 v[208:223], v[72:75], v[244:247], v[208:223]
    buffer_load_dwordx4 v[72:75], v1, s[28:31], s49 offen offset:2048 sc1
    s_nop 3
    ds_write_b128 v1, v[128:131] offset:18432
    ds_write_b128 v1, v[132:135] offset:19456
    ds_write_b128 v1, v[136:139] offset:24576
    s_waitcnt vmcnt(28)
    v_mfma_f32_32x32x16_bf16 v[144:159], v[88:91], v[232:235], v[144:159]
    v_mfma_f32_32x32x16_bf16 v[208:223], v[88:91], v[248:251], v[208:223]
    buffer_load_dwordx4 v[88:91], v1, s[28:31], s48 offen offset:3072 sc1
    ds_write_b128 v1, v[140:143] offset:25600
    ds_write_b128 v3, v[192:195] offset:2048
    ds_write_b128 v3, v[196:199] offset:3072
    s_waitcnt vmcnt(27)
    v_mfma_f32_32x32x16_bf16 v[144:159], v[104:107], v[236:239], v[144:159]
    v_mfma_f32_32x32x16_bf16 v[208:223], v[104:107], v[252:255], v[208:223]
    buffer_load_dwordx4 v[104:107], v1, s[28:31], s49 offen offset:3072 sc1
    s_add_u32 s48, s48, 4096
    s_add_u32 s49, s49, 4096
    s_waitcnt vmcnt(26)
    v_mfma_f32_32x32x16_bf16 v[160:175], v[60:63], v[224:227], v[160:175]
    buffer_load_dwordx4 v[60:63], v1, s[28:31], s48 offen offset:0 sc1
    s_waitcnt vmcnt(26)
    v_mfma_f32_32x32x16_bf16 v[160:175], v[76:79], v[228:231], v[160:175]
    buffer_load_dwordx4 v[76:79], v1, s[28:31], s49 offen offset:0 sc1
    s_nop 5
    ds_write_b128 v1, v[144:147] offset:30720
    ds_write_b128 v1, v[148:151] offset:31744
    ds_write_b128 v1, v[152:155] offset:36864
    s_waitcnt vmcnt(22)
    v_mfma_f32_32x32x16_bf16 v[160:175], v[92:95], v[232:235], v[160:175]
    buffer_load_dwordx4 v[92:95], v1, s[28:31], s48 offen offset:1024 sc1
    ds_write_b128 v1, v[156:159] offset:37888
    s_waitcnt vmcnt(22)
    v_mfma_f32_32x32x16_bf16 v[160:175], v[108:111], v[236:239], v[160:175]
    buffer_load_dwordx4 v[108:111], v1, s[28:31], s49 offen offset:1024 sc1
    s_setprio 2
    s_nop 7
    s_nop 1
    ds_write_b128 v1, v[160:163] offset:43008
    ds_write_b128 v1, v[164:167] offset:44032
    ds_write_b128 v1, v[168:171] offset:49152
    ds_write_b128 v1, v[172:175] offset:50176
    s_waitcnt lgkmcnt(0)
    ds_write_b32 v5, v15
    buffer_load_dwordx4 v[224:227], v1, s[28:31], s48 offen offset:2048 sc1
    buffer_load_dwordx4 v[228:231], v1, s[28:31], s49 offen offset:2048 sc1
    buffer_load_dwordx4 v[232:235], v1, s[28:31], s48 offen offset:3072 sc1
    buffer_load_dwordx4 v[236:239], v1, s[28:31], s49 offen offset:3072 sc1
    s_add_u32 s48, s48, 4096
    s_add_u32 s49, s49, 4096
    buffer_load_dwordx4 v[240:243], v1, s[28:31], s48 offen offset:0 sc1
    buffer_load_dwordx4 v[244:247], v1, s[28:31], s49 offen offset:0 sc1
    buffer_load_dwordx4 v[248:251], v1, s[28:31], s48 offen offset:1024 sc1
    buffer_load_dwordx4 v[252:255], v1, s[28:31], s49 offen offset:1024 sc1
    s_waitcnt vmcnt(26)
    s_mov_b32 s91, 65536
L_gp3:
    v_or_b32 v160, v8, v9
    v_cmp_gt_i32 vcc, 0, v160
    s_sub_u32 s91, s91, 1
    s_cbranch_scc1 L_gp3d
    s_cmp_eq_u64 vcc, 0
    s_cbranch_scc1 L_gp3d
    buffer_load_dword v8, v4, s[28:31], s74 offen sc1
    buffer_load_dword v9, v4, s[28:31], s75 offen sc1
    s_waitcnt vmcnt(0)
    s_branch L_gp3
L_gp3d:
    v_sub_f32 v168, 1.0, v8
    v_lshlrev_b32 v6, 16, v6
    v_mov_b32 v169, v168
    v_mul_f32 v170, v6, v168
    v_mov_b32 v171, v170
    v_sub_f32 v172, 1.0, v9
    v_lshlrev_b32 v7, 16, v7
    v_mov_b32 v173, v172
    v_mul_f32 v174, v7, v172
    v_mov_b32 v175, v174
    s_mov_b32 s91, 65536
L_pb3:
    ds_read_b128 v[6:9], v14 offset:16
    s_waitcnt lgkmcnt(0)
    v_and_b32 v6, v6, v7
    v_and_b32 v8, v8, v9
    v_and_b32 v6, v6, v8
    s_sub_u32 s91, s91, 1
    v_readfirstlane_b32 s3, v6
    s_cbranch_scc1 L_pb3d
    s_cmp_lg_u32 s3, 0
    s_cbranch_scc1 L_pb3d
    s_sleep 2
    s_branch L_pb3
L_pb3d:
    ds_read_b128 v[112:115], v3 offset:4096
    ds_read_b128 v[116:119], v3 offset:5120
    ds_read_b128 v[120:123], v3 offset:6144
    ds_read_b128 v[124:127], v3 offset:7168
    ds_read_b128 v[128:131], v3 offset:8192
    ds_read_b128 v[132:135], v3 offset:9216
    ds_read_b128 v[136:139], v3 offset:10240
    ds_read_b128 v[140:143], v3 offset:11264
    ds_read_b128 v[144:147], v3 offset:12288
    ds_read_b128 v[148:151], v3 offset:13312
    ds_read_b128 v[152:155], v3 offset:14336
    ds_read_b128 v[156:159], v3 offset:15360
    v_lshlrev_b32 v160, 16, v32
    v_and_b32 v161, 0xffff0000, v32
    v_lshlrev_b32 v162, 16, v33
    v_and_b32 v163, 0xffff0000, v33
    v_lshlrev_b32 v164, 16, v34
    v_and_b32 v165, 0xffff0000, v34
    v_lshlrev_b32 v166, 16, v35
    v_and_b32 v167, 0xffff0000, v35
    s_waitcnt lgkmcnt(6)
    v_pk_add_f32 v[200:201], v[200:201], v[112:113]
    v_pk_add_f32 v[202:203], v[202:203], v[114:115]
    v_pk_add_f32 v[204:205], v[204:205], v[116:117]
    v_pk_add_f32 v[206:207], v[206:207], v[118:119]
    v_pk_add_f32 v[200:201], v[200:201], v[120:121]
    v_pk_add_f32 v[202:203], v[202:203], v[122:123]
    v_pk_add_f32 v[204:205], v[204:205], v[124:125]
    v_pk_add_f32 v[206:207], v[206:207], v[126:127]
    v_pk_add_f32 v[200:201], v[200:201], v[128:129]
    v_pk_add_f32 v[202:203], v[202:203], v[130:131]
    v_pk_add_f32 v[204:205], v[204:205], v[132:133]
    v_pk_add_f32 v[206:207], v[206:207], v[134:135]
    v_pk_fma_f32 v[200:201], v[200:201], v[172:173], v[174:175]
    v_pk_fma_f32 v[202:203], v[202:203], v[172:173], v[174:175]
    v_pk_fma_f32 v[204:205], v[204:205], v[172:173], v[174:175]
    v_pk_fma_f32 v[206:207], v[206:207], v[172:173], v[174:175]
    v_pk_mul_f32 v[200:201], v[200:201], v[160:161]
    v_pk_mul_f32 v[202:203], v[202:203], v[162:163]
    v_pk_mul_f32 v[204:205], v[204:205], v[164:165]
    v_pk_mul_f32 v[206:207], v[206:207], v[166:167]
    v_cvt_pk_bf16_f32 v32, v200, v201
    v_cvt_pk_bf16_f32 v33, v202, v203
    v_cvt_pk_bf16_f32 v34, v204, v205
    v_cvt_pk_bf16_f32 v35, v206, v207
    buffer_store_dwordx4 v[32:35], v1, s[28:31], s88 offen offset:1024 sc1
    ds_read_b128 v[112:115], v3 offset:16384
    ds_read_b128 v[116:119], v3 offset:17408
    ds_read_b128 v[120:123], v3 offset:18432
    ds_read_b128 v[124:127], v3 offset:19456
    ds_read_b128 v[128:131], v3 offset:20480
    ds_read_b128 v[132:135], v3 offset:21504
    v_lshlrev_b32 v160, 16, v36
    v_and_b32 v161, 0xffff0000, v36
    v_lshlrev_b32 v162, 16, v37
    v_and_b32 v163, 0xffff0000, v37
    v_lshlrev_b32 v164, 16, v38
    v_and_b32 v165, 0xffff0000, v38
    v_lshlrev_b32 v166, 16, v39
    v_and_b32 v167, 0xffff0000, v39
    s_waitcnt lgkmcnt(6)
    v_pk_add_f32 v[208:209], v[208:209], v[136:137]
    v_pk_add_f32 v[210:211], v[210:211], v[138:139]
    v_pk_add_f32 v[212:213], v[212:213], v[140:141]
    v_pk_add_f32 v[214:215], v[214:215], v[142:143]
    v_pk_add_f32 v[208:209], v[208:209], v[144:145]
    v_pk_add_f32 v[210:211], v[210:211], v[146:147]
    v_pk_add_f32 v[212:213], v[212:213], v[148:149]
    v_pk_add_f32 v[214:215], v[214:215], v[150:151]
    v_pk_add_f32 v[208:209], v[208:209], v[152:153]
    v_pk_add_f32 v[210:211], v[210:211], v[154:155]
    v_pk_add_f32 v[212:213], v[212:213], v[156:157]
    v_pk_add_f32 v[214:215], v[214:215], v[158:159]
    v_pk_fma_f32 v[208:209], v[208:209], v[172:173], v[174:175]
    v_pk_fma_f32 v[210:211], v[210:211], v[172:173], v[174:175]
    v_pk_fma_f32 v[212:213], v[212:213], v[172:173], v[174:175]
    v_pk_fma_f32 v[214:215], v[214:215], v[172:173], v[174:175]
    v_pk_mul_f32 v[208:209], v[208:209], v[160:161]
    v_pk_mul_f32 v[210:211], v[210:211], v[162:163]
    v_pk_mul_f32 v[212:213], v[212:213], v[164:165]
    v_pk_mul_f32 v[214:215], v[214:215], v[166:167]
    v_cvt_pk_bf16_f32 v36, v208, v209
    v_cvt_pk_bf16_f32 v37, v210, v211
    v_cvt_pk_bf16_f32 v38, v212, v213
    v_cvt_pk_bf16_f32 v39, v214, v215
    buffer_store_dwordx4 v[36:39], v1, s[28:31], s89 offen offset:0 sc1
    v_lshlrev_b32 v160, 16, v40
    v_and_b32 v161, 0xffff0000, v40
    v_lshlrev_b32 v162, 16, v41
    v_and_b32 v163, 0xffff0000, v41
    v_lshlrev_b32 v164, 16, v42
    v_and_b32 v165, 0xffff0000, v42
    v_lshlrev_b32 v166, 16, v43
    v_and_b32 v167, 0xffff0000, v43
    s_waitcnt lgkmcnt(0)
    ds_write_b32 v13, v15 offset:80
    v_pk_add_f32 v[216:217], v[216:217], v[112:113]
    v_pk_add_f32 v[218:219], v[218:219], v[114:115]
    v_pk_add_f32 v[220:221], v[220:221], v[116:117]
    v_pk_add_f32 v[222:223], v[222:223], v[118:119]
    v_pk_add_f32 v[216:217], v[216:217], v[120:121]
    v_pk_add_f32 v[218:219], v[218:219], v[122:123]
    v_pk_add_f32 v[220:221], v[220:221], v[124:125]
    v_pk_add_f32 v[222:223], v[222:223], v[126:127]
    v_pk_add_f32 v[216:217], v[216:217], v[128:129]
    v_pk_add_f32 v[218:219], v[218:219], v[130:131]
    v_pk_add_f32 v[220:221], v[220:221], v[132:133]
    v_pk_add_f32 v[222:223], v[222:223], v[134:135]
    v_pk_fma_f32 v[216:217], v[216:217], v[172:173], v[174:175]
    v_pk_fma_f32 v[218:219], v[218:219], v[172:173], v[174:175]
    v_pk_fma_f32 v[220:221], v[220:221], v[172:173], v[174:175]
    v_pk_fma_f32 v[222:223], v[222:223], v[172:173], v[174:175]
    v_pk_mul_f32 v[216:217], v[216:217], v[160:161]
    v_pk_mul_f32 v[218:219], v[218:219], v[162:163]
    v_pk_mul_f32 v[220:221], v[220:221], v[164:165]
    v_pk_mul_f32 v[222:223], v[222:223], v[166:167]
    v_cvt_pk_bf16_f32 v40, v216, v217
    v_cvt_pk_bf16_f32 v41, v218, v219
    v_cvt_pk_bf16_f32 v42, v220, v221
    v_cvt_pk_bf16_f32 v43, v222, v223
    buffer_store_dwordx4 v[40:43], v1, s[28:31], s89 offen offset:1024 sc1
L_fin:
    s_lshl_b32 s60, s38, 1
    s_lshr_b32 s59, s57, 1
    s_add_u32 s60, s60, s59
    s_xor_b32 s61, s60, 1
    s_lshl_b32 s62, s39, 1
    s_and_b32 s59, s57, 1
    s_add_u32 s62, s62, s59
    s_xor_b32 s63, s62, 1
    s_mul_i32 s72, s57, 14336
    s_mul_i32 s59, s60, 90112
    s_add_u32 s59, s59, s72
    s_add_u32 s64, s59, 14712832
    s_mul_i32 s59, s61, 90112
    s_add_u32 s59, s59, s72
    s_add_u32 s65, s59, 14712832
    s_lshl_b32 s59, s38, 2
    s_add_u32 s59, s59, s57
    s_lshl_b32 s59, s59, 1
    s_and_b32 s77, s39, 1
    s_add_u32 s59, s59, s77
    s_mul_i32 s59, s59, 256
    v_mov_b32 v2, s59
    s_lshl_b32 s77, s54, 3
    s_and_b32 s59, s55, 6
    s_add_u32 s77, s77, s59
    v_mul_u32_u24 v10, 256, v0
    v_mov_b32 v3, v13
    s_lshl_b32 s67, s57, 13
    s_xor_b32 s59, s57, 0
    s_mul_i32 s59, s59, 14336
    s_add_u32 s59, s59, 2048
    v_add_u32 v5, s59, v1
    s_xor_b32 s59, s57, 1
    s_mul_i32 s59, s59, 14336
    s_add_u32 s59, s59, 2048
    v_add_u32 v6, s59, v1
    s_xor_b32 s59, s57, 2
    s_mul_i32 s59, s59, 14336
    s_add_u32 s59, s59, 2048
    v_add_u32 v7, s59, v1
    s_xor_b32 s59, s57, 3
    s_mul_i32 s59, s59, 14336
    s_add_u32 s59, s59, 2048
    v_add_u32 v8, s59, v1
    s_xor_b32 s59, s57, 0
    s_mul_i32 s59, s59, 6144
    s_add_u32 s59, s59, 106496
    v_add_u32 v9, s59, v1
    v_and_b32 v12, 31, v0
    v_lshlrev_b32 v12, 10, v12
    v_lshrrev_b32 v13, 5, v0
    v_lshl_add_u32 v12, v13, 4, v12
    s_lshl_b32 s76, s60, 15
    s_lshl_b32 s59, s62, 6
    s_add_u32 s76, s76, s59
    s_mov_b32 s44, s22
    s_mov_b32 s45, s23
    s_mov_b32 s46, 2097152
    s_mov_b32 s47, 0x20000
    s_mov_b32 s91, 65536
L_prd:
    ds_read_b128 v[176:179], v14 offset:112
    s_waitcnt lgkmcnt(0)
    v_and_b32 v176, v176, v177
    v_and_b32 v178, v178, v179
    v_and_b32 v176, v176, v178
    s_sub_u32 s91, s91, 1
    v_readfirstlane_b32 s3, v176
    s_cbranch_scc1 L_prdd
    s_cmp_lg_u32 s3, 0
    s_cbranch_scc1 L_prdd
    s_sleep 2
    s_branch L_prd
L_prdd:
    s_waitcnt vmcnt(0)
    s_mul_i32 s77, s77, 256
    s_add_u32 s77, s77, 23592960
    s_mov_b64 exec, 3
    buffer_atomic_add v15, v10, s[28:31], s77 offen sc1
    s_mov_b64 exec, -1
    s_setprio 0
    s_add_u32 m0, s67, 59392
    s_nop 0
    buffer_load_dwordx4 v1, s[28:31], s66 offen offset:0 sc1 lds
    buffer_load_dwordx4 v1, s[28:31], s66 offen offset:1024 sc1 lds
    buffer_load_dwordx4 v1, s[28:31], s66 offen offset:2048 sc1 lds
    buffer_load_dwordx4 v1, s[28:31], s66 offen offset:3072 sc1 lds
    s_add_u32 s66, s66, 4096
    s_add_u32 m0, s67, 63488
    s_nop 0
    buffer_load_dwordx4 v1, s[28:31], s66 offen offset:0 sc1 lds
    buffer_load_dwordx4 v1, s[28:31], s66 offen offset:1024 sc1 lds
    buffer_load_dwordx4 v1, s[28:31], s66 offen offset:2048 sc1 lds
    buffer_load_dwordx4 v1, s[28:31], s66 offen offset:3072 sc1 lds
    s_add_u32 s66, s66, 4096
    s_setprio 2
    s_mov_b64 exec, 1
    v_mov_b32 v36, 0
    buffer_atomic_add v36, v2, s[28:31], s90 offen sc0 sc1
    s_waitcnt vmcnt(0)
    ds_write_b32 v3, v15 offset:96
    s_mov_b32 s91, 65536
    s_waitcnt vmcnt(0)
    v_cmp_gt_u32 vcc, 8, v36
    s_sub_u32 s91, s91, 1
    s_cbranch_scc1 L_pud
    s_and_b64 exec, exec, vcc
    s_cbranch_scc0 L_pud
    v_mov_b32 v36, 0
    buffer_atomic_add v36, v2, s[28:31], s90 offen sc0 sc1
    s_sleep 4
    v_mov_b32 v37, 0
    buffer_atomic_add v37, v2, s[28:31], s90 offen sc0 sc1
    s_sleep 4
L_pu:
    v_mov_b32 v38, 0
    buffer_atomic_add v38, v2, s[28:31], s90 offen sc0 sc1
    s_sleep 3
    s_waitcnt vmcnt(2)
    v_cmp_gt_u32 vcc, 8, v36
    s_sub_u32 s91, s91, 1
    s_cbranch_scc1 L_pud
    s_and_b64 exec, exec, vcc
    s_cbranch_scc0 L_pud
    v_mov_b32 v36, 0
    buffer_atomic_add v36, v2, s[28:31], s90 offen sc0 sc1
    s_sleep 3
    s_waitcnt vmcnt(2)
    v_cmp_gt_u32 vcc, 8, v37
    s_sub_u32 s91, s91, 1
    s_cbranch_scc1 L_pud
    s_and_b64 exec, exec, vcc
    s_cbranch_scc0 L_pud
    v_mov_b32 v37, 0
    buffer_atomic_add v37, v2, s[28:31], s90 offen sc0 sc1
    s_sleep 3
    s_waitcnt vmcnt(2)
    v_cmp_gt_u32 vcc, 8, v38
    s_sub_u32 s91, s91, 1
    s_cbranch_scc1 L_pud
    s_and_b64 exec, exec, vcc
    s_cbranch_scc0 L_pud
    s_branch L_pu
L_pud:
    s_mov_b64 exec, -1
    s_setprio 0
    buffer_load_dwordx4 v[176:179], v1, s[28:31], s64 offen offset:0 sc1
    buffer_load_dwordx4 v[180:183], v1, s[28:31], s65 offen offset:0 sc1
    buffer_load_dwordx4 v[184:187], v1, s[28:31], s64 offen offset:1024 sc1
    buffer_load_dwordx4 v[188:191], v1, s[28:31], s65 offen offset:1024 sc1
    buffer_load_dwordx4 v[192:195], v1, s[28:31], s64 offen offset:2048 sc1
    buffer_load_dwordx4 v[196:199], v1, s[28:31], s65 offen offset:2048 sc1
    buffer_load_dwordx4 v[200:203], v1, s[28:31], s64 offen offset:3072 sc1
    buffer_load_dwordx4 v[204:207], v1, s[28:31], s65 offen offset:3072 sc1
    s_add_u32 s64, s64, 4096
    s_add_u32 s65, s65, 4096
    buffer_load_dwordx4 v[208:211], v1, s[28:31], s64 offen offset:0 sc1
    buffer_load_dwordx4 v[212:215], v1, s[28:31], s65 offen offset:0 sc1
    buffer_load_dwordx4 v[216:219], v1, s[28:31], s64 offen offset:1024 sc1
    buffer_load_dwordx4 v[220:223], v1, s[28:31], s65 offen offset:1024 sc1
    s_waitcnt vmcnt(10)
    v_mfma_f32_32x32x16_bf16 v[128:143], v[20:23], v[176:179], 0
    v_mfma_f32_32x32x16_bf16 v[144:159], v[16:19], v[180:183], 0
    v_mfma_f32_32x32x16_bf16 v[160:175], v[20:23], v[180:183], 0
    v_mfma_f32_32x32x16_bf16 v[112:127], v[16:19], v[176:179], 0
    buffer_load_dwordx4 v[176:179], v1, s[28:31], s64 offen offset:2048 sc1
    buffer_load_dwordx4 v[180:183], v1, s[28:31], s65 offen offset:2048 sc1
    s_waitcnt vmcnt(10)
    v_mfma_f32_32x32x16_bf16 v[128:143], v[28:31], v[184:187], v[128:143]
    v_mfma_f32_32x32x16_bf16 v[144:159], v[24:27], v[188:191], v[144:159]
    v_mfma_f32_32x32x16_bf16 v[160:175], v[28:31], v[188:191], v[160:175]
    v_mfma_f32_32x32x16_bf16 v[112:127], v[24:27], v[184:187], v[112:127]
    buffer_load_dwordx4 v[184:187], v1, s[28:31], s64 offen offset:3072 sc1
    buffer_load_dwordx4 v[188:191], v1, s[28:31], s65 offen offset:3072 sc1
    s_add_u32 s64, s64, 4096
    s_add_u32 s65, s65, 4096
    s_waitcnt vmcnt(10)
    v_mfma_f32_32x32x16_bf16 v[128:143], v[64:67], v[192:195], v[128:143]
    v_mfma_f32_32x32x16_bf16 v[144:159], v[48:51], v[196:199], v[144:159]
    v_mfma_f32_32x32x16_bf16 v[160:175], v[64:67], v[196:199], v[160:175]
    v_mfma_f32_32x32x16_bf16 v[112:127], v[48:51], v[192:195], v[112:127]
    buffer_load_dwordx4 v[192:195], v1, s[28:31], s64 offen offset:0 sc1
    buffer_load_dwordx4 v[196:199], v1, s[28:31], s65 offen offset:0 sc1
    s_waitcnt vmcnt(10)
    v_mfma_f32_32x32x16_bf16 v[128:143], v[96:99], v[200:203], v[128:143]
    v_mfma_f32_32x32x16_bf16 v[144:159], v[80:83], v[204:207], v[144:159]
    v_mfma_f32_32x32x16_bf16 v[160:175], v[96:99], v[204:207], v[160:175]
    v_mfma_f32_32x32x16_bf16 v[112:127], v[80:83], v[200:203], v[112:127]
    buffer_load_dwordx4 v[200:203], v1, s[28:31], s64 offen offset:1024 sc1
    buffer_load_dwordx4 v[204:207], v1, s[28:31], s65 offen offset:1024 sc1
    s_waitcnt vmcnt(10)
    v_mfma_f32_32x32x16_bf16 v[128:143], v[68:71], v[208:211], v[128:143]
    v_mfma_f32_32x32x16_bf16 v[144:159], v[52:55], v[212:215], v[144:159]
    v_mfma_f32_32x32x16_bf16 v[160:175], v[68:71], v[212:215], v[160:175]
    v_mfma_f32_32x32x16_bf16 v[112:127], v[52:55], v[208:211], v[112:127]
    buffer_load_dwordx4 v[208:211], v1, s[28:31], s64 offen offset:2048 sc1
    buffer_load_dwordx4 v[212:215], v1, s[28:31], s65 offen offset:2048 sc1
    s_waitcnt vmcnt(10)
    v_mfma_f32_32x32x16_bf16 v[128:143], v[100:103], v[216:219], v[128:143]
    v_mfma_f32_32x32x16_bf16 v[144:159], v[84:87], v[220:223], v[144:159]
    v_mfma_f32_32x32x16_bf16 v[160:175], v[100:103], v[220:223], v[160:175]
    v_mfma_f32_32x32x16_bf16 v[112:127], v[84:87], v[216:219], v[112:127]
    buffer_load_dwordx4 v[216:219], v1, s[28:31], s64 offen offset:3072 sc1
    buffer_load_dwordx4 v[220:223], v1, s[28:31], s65 offen offset:3072 sc1
    s_add_u32 s64, s64, 4096
    s_add_u32 s65, s65, 4096
    s_waitcnt vmcnt(10)
    v_mfma_f32_32x32x16_bf16 v[128:143], v[72:75], v[176:179], v[128:143]
    v_mfma_f32_32x32x16_bf16 v[144:159], v[56:59], v[180:183], v[144:159]
    v_mfma_f32_32x32x16_bf16 v[160:175], v[72:75], v[180:183], v[160:175]
    v_mfma_f32_32x32x16_bf16 v[112:127], v[56:59], v[176:179], v[112:127]
    buffer_load_dwordx4 v[176:179], v1, s[28:31], s64 offen offset:0 sc1
    buffer_load_dwordx4 v[180:183], v1, s[28:31], s65 offen offset:0 sc1
    s_waitcnt vmcnt(10)
    v_mfma_f32_32x32x16_bf16 v[128:143], v[104:107], v[184:187], v[128:143]
    v_mfma_f32_32x32x16_bf16 v[144:159], v[88:91], v[188:191], v[144:159]
    v_mfma_f32_32x32x16_bf16 v[160:175], v[104:107], v[188:191], v[160:175]
    v_mfma_f32_32x32x16_bf16 v[112:127], v[88:91], v[184:187], v[112:127]
    buffer_load_dwordx4 v[184:187], v1, s[28:31], s64 offen offset:1024 sc1
    buffer_load_dwordx4 v[188:191], v1, s[28:31], s65 offen offset:1024 sc1
    s_waitcnt vmcnt(10)
    v_mfma_f32_32x32x16_bf16 v[128:143], v[76:79], v[192:195], v[128:143]
    v_mfma_f32_32x32x16_bf16 v[144:159], v[60:63], v[196:199], v[144:159]
    v_mfma_f32_32x32x16_bf16 v[160:175], v[76:79], v[196:199], v[160:175]
    v_mfma_f32_32x32x16_bf16 v[112:127], v[60:63], v[192:195], v[112:127]
    s_waitcnt vmcnt(8)
    v_mfma_f32_32x32x16_bf16 v[128:143], v[108:111], v[200:203], v[128:143]
    v_mfma_f32_32x32x16_bf16 v[144:159], v[92:95], v[204:207], v[144:159]
    v_mfma_f32_32x32x16_bf16 v[160:175], v[108:111], v[204:207], v[160:175]
    v_mfma_f32_32x32x16_bf16 v[112:127], v[92:95], v[200:203], v[112:127]
    s_waitcnt vmcnt(6)
    v_mfma_f32_32x32x16_bf16 v[128:143], v[228:231], v[208:211], v[128:143]
    v_mfma_f32_32x32x16_bf16 v[144:159], v[224:227], v[212:215], v[144:159]
    v_mfma_f32_32x32x16_bf16 v[160:175], v[228:231], v[212:215], v[160:175]
    v_mfma_f32_32x32x16_bf16 v[112:127], v[224:227], v[208:211], v[112:127]
    s_waitcnt vmcnt(4)
    v_mfma_f32_32x32x16_bf16 v[128:143], v[236:239], v[216:219], v[128:143]
    v_mfma_f32_32x32x16_bf16 v[144:159], v[232:235], v[220:223], v[144:159]
    v_mfma_f32_32x32x16_bf16 v[160:175], v[236:239], v[220:223], v[160:175]
    v_mfma_f32_32x32x16_bf16 v[112:127], v[232:235], v[216:219], v[112:127]
    s_waitcnt vmcnt(2)
    v_mfma_f32_32x32x16_bf16 v[128:143], v[244:247], v[176:179], v[128:143]
    v_mfma_f32_32x32x16_bf16 v[144:159], v[240:243], v[180:183], v[144:159]
    v_mfma_f32_32x32x16_bf16 v[160:175], v[244:247], v[180:183], v[160:175]
    v_mfma_f32_32x32x16_bf16 v[112:127], v[240:243], v[176:179], v[112:127]
    s_waitcnt vmcnt(0)
    v_mfma_f32_32x32x16_bf16 v[128:143], v[252:255], v[184:187], v[128:143]
    v_mfma_f32_32x32x16_bf16 v[144:159], v[248:251], v[188:191], v[144:159]
    v_mfma_f32_32x32x16_bf16 v[160:175], v[252:255], v[188:191], v[160:175]
    v_mfma_f32_32x32x16_bf16 v[112:127], v[248:251], v[184:187], v[112:127]
    s_nop 7
    s_nop 1
    ds_write_b128 v6, v[128:131] offset:2048
    ds_write_b128 v6, v[132:135] offset:3072
    ds_write_b128 v6, v[136:139] offset:8192
    ds_write_b128 v6, v[140:143] offset:9216
    ds_write_b128 v7, v[144:147] offset:4096
    ds_write_b128 v7, v[148:151] offset:5120
    ds_write_b128 v7, v[152:155] offset:10240
    ds_write_b128 v7, v[156:159] offset:11264
    ds_write_b128 v8, v[160:163] offset:6144
    ds_write_b128 v8, v[164:167] offset:7168
    ds_write_b128 v8, v[168:171] offset:12288
    ds_write_b128 v8, v[172:175] offset:13312
    ds_write_b128 v5, v[112:115] offset:0
    ds_write_b128 v5, v[116:119] offset:1024
    s_waitcnt lgkmcnt(0)
    s_barrier
    ds_read_b128 v[16:19], v5 offset:8192
    ds_read_b128 v[20:23], v5 offset:9216
    ds_read_b128 v[24:27], v5 offset:10240
    ds_read_b128 v[28:31], v5 offset:11264
    ds_read_b128 v[32:35], v5 offset:12288
    ds_read_b128 v[36:39], v5 offset:13312
    ds_read_b128 v[40:43], v9 offset:2048
    ds_read_b128 v[44:47], v9 offset:3072
    ds_read_b128 v[48:51], v9 offset:4096
    ds_read_b128 v[52:55], v9 offset:5120
    s_waitcnt lgkmcnt(8)
    v_pk_add_f32 v[120:121], v[120:121], v[16:17]
    v_pk_add_f32 v[122:123], v[122:123], v[18:19]
    v_pk_add_f32 v[124:125], v[124:125], v[20:21]
    v_pk_add_f32 v[126:127], v[126:127], v[22:23]
    s_waitcnt lgkmcnt(6)
    v_pk_add_f32 v[120:121], v[120:121], v[24:25]
    v_pk_add_f32 v[122:123], v[122:123], v[26:27]
    v_pk_add_f32 v[124:125], v[124:125], v[28:29]
    v_pk_add_f32 v[126:127], v[126:127], v[30:31]
    s_waitcnt lgkmcnt(4)
    v_pk_add_f32 v[120:121], v[120:121], v[32:33]
    v_pk_add_f32 v[122:123], v[122:123], v[34:35]
    v_pk_add_f32 v[124:125], v[124:125], v[36:37]
    v_pk_add_f32 v[126:127], v[126:127], v[38:39]
    s_waitcnt lgkmcnt(2)
    v_pk_add_f32 v[120:121], v[120:121], v[40:41]
    v_pk_add_f32 v[122:123], v[122:123], v[42:43]
    v_pk_add_f32 v[124:125], v[124:125], v[44:45]
    v_pk_add_f32 v[126:127], v[126:127], v[46:47]
    s_waitcnt lgkmcnt(0)
    v_pk_add_f32 v[120:121], v[120:121], v[48:49]
    v_pk_add_f32 v[122:123], v[122:123], v[50:51]
    v_pk_add_f32 v[124:125], v[124:125], v[52:53]
    v_pk_add_f32 v[126:127], v[126:127], v[54:55]
    v_cvt_pk_bf16_f32 v16, v120, v121
    v_cvt_pk_bf16_f32 v17, v122, v123
    v_cvt_pk_bf16_f32 v18, v124, v125
    v_cvt_pk_bf16_f32 v19, v126, v127
    s_nop 1
    v_permlane32_swap_b32 v16, v18
    v_permlane32_swap_b32 v17, v19
    buffer_store_dwordx4 v[16:19], v12, s[44:47], s76 offen offset:32
    s_endpgm
.p2align 6
L_g1:
    v_lshlrev_b32 v9, 4, v0
    s_waitcnt lgkmcnt(0)
    s_mov_b32 s28, s26
    s_mov_b32 s29, s27
    s_mov_b32 s30, 29360128
    s_mov_b32 s31, 0x20000
    s_mov_b32 s32, s24
    s_mov_b32 s33, s25
    s_mov_b32 s34, 256
    s_mov_b32 s35, 0x20000
    s_lshl_b32 s59, s55, 2
    s_add_u32 s59, s59, s57
    s_cmp_eq_u32 s59, 60
    s_cbranch_scc1 L_clear
L_noclr:
    v_bfe_u32 v1, v0, 1, 3
    v_lshrrev_b32 v115, 5, v0
    v_xor_b32 v1, v1, v115
    v_lshlrev_b32 v1, 4, v1
    v_and_b32 v115, 31, v0
    v_lshl_add_u32 v1, v115, 7, v1
    v_add_u32 v112, s60, v1
    v_xor_b32 v113, 32, v112
    v_xor_b32 v114, 64, v112
    v_xor_b32 v115, 96, v112
    v_lshrrev_b32 v1, 5, v0
    v_lshlrev_b32 v116, 11, v1
    v_bfe_u32 v1, v0, 2, 2
    v_lshl_add_u32 v116, v1, 7, v116
    v_bfe_u32 v1, v0, 3, 1
    v_lshl_add_u32 v116, v1, 6, v116
    v_bfe_u32 v1, v0, 4, 1
    v_lshl_add_u32 v116, v1, 5, v116
    v_and_b32 v1, 3, v0
    v_lshl_add_u32 v116, v1, 3, v116
    v_add_u32 v116, 16384, v116
    v_xor_b32 v117, 64, v116
    v_lshrrev_b32 v1, 5, v0
    v_lshlrev_b32 v118, 9, v1
    v_bfe_u32 v1, v0, 2, 2
    v_lshl_add_u32 v118, v1, 6, v118
    v_bfe_u32 v1, v0, 4, 1
    v_lshl_add_u32 v118, v1, 5, v118
    v_and_b32 v1, 3, v0
    v_lshl_add_u32 v118, v1, 3, v118
    v_add_u32 v118, 32768, v118
    v_lshlrev_b32 v10, 2, v0
    v_mov_b32 v11, 0
    ds_write_b32 v10, v11
    s_waitcnt lgkmcnt(0)
    s_barrier
    ds_read_b128 v[128:131], v112 offset:37888
    ds_read_b64_tr_b16 v[32:33], v116 offset:37888
    ds_read_b64_tr_b16 v[34:35], v116 offset:38400
    ds_read_b64_tr_b16 v[36:37], v117 offset:37888
    ds_read_b64_tr_b16 v[38:39], v117 offset:38400
    ds_read_b64_tr_b16 v[40:41], v118 offset:37888
    ds_read_b64_tr_b16 v[42:43], v118 offset:38144
    s_waitcnt lgkmcnt(4)
    v_mfma_f32_32x32x16_bf16 v[64:79], v[32:35], v[128:131], 0
    ds_read_b128 v[132:135], v113 offset:37888
    ds_read_b64_tr_b16 v[44:45], v116 offset:41984
    ds_read_b64_tr_b16 v[46:47], v116 offset:42496
    s_waitcnt lgkmcnt(5)
    v_mfma_f32_32x32x16_bf16 v[80:95], v[36:39], v[128:131], 0
    ds_read_b64_tr_b16 v[48:49], v117 offset:41984
    ds_read_b64_tr_b16 v[50:51], v117 offset:42496
    s_waitcnt lgkmcnt(5)
    v_mfma_f32_32x32x16_bf16 v[96:111], v[128:131], v[40:43], 0
    ds_read_b64_tr_b16 v[52:53], v118 offset:38912
    ds_read_b64_tr_b16 v[54:55], v118 offset:39168
    s_mov_b32 s44, s12
    s_mov_b32 s45, s13
    s_mov_b32 s46, 1835008
    s_mov_b32 s47, 0x20000
    v_and_b32 v126, 31, v0
    v_mul_u32_u24 v126, 3584, v126
    s_lshl_b32 s88, s62, 7
    s_and_b32 s89, s58, 15
    s_mul_i32 s89, s89, 114688
    s_add_u32 s89, s89, s88
    s_lshl_b32 s80, s57, 11
    s_mov_b32 s40, s14
    s_mov_b32 s41, s15
    s_mov_b32 s42, 8388608
    s_waitcnt lgkmcnt(4)
    v_mfma_f32_32x32x16_bf16 v[64:79], v[44:47], v[132:135], v[64:79]
    s_mov_b32 exec_lo, 65535
    s_mov_b32 exec_hi, 0
    buffer_load_dword v125, v126, s[44:47], s89 offen
    s_mov_b64 exec, -1
    ds_read_b128 v[128:131], v114 offset:37888
    ds_read_b64_tr_b16 v[32:33], v116 offset:46080
    ds_read_b64_tr_b16 v[34:35], v116 offset:46592
    s_waitcnt lgkmcnt(5)
    v_mfma_f32_32x32x16_bf16 v[80:95], v[48:51], v[132:135], v[80:95]
    ds_read_b64_tr_b16 v[36:37], v117 offset:46080
    ds_read_b64_tr_b16 v[38:39], v117 offset:46592
    s_waitcnt lgkmcnt(5)
    v_mfma_f32_32x32x16_bf16 v[96:111], v[132:135], v[52:55], v[96:111]
    ds_read_b64_tr_b16 v[40:41], v118 offset:39936
    ds_read_b64_tr_b16 v[42:43], v118 offset:40192
    s_mov_b32 s43, 0x20000
    v_and_b32 v124, 15, v0
    v_lshlrev_b32 v124, 12, v124
    v_bfe_u32 v10, v0, 4, 1
    v_lshl_add_u32 v124, v10, 7, v124
    s_lshr_b32 s92, s52, 1
    s_lshl_b32 s92, s92, 3
    s_and_b32 s3, s53, 7
    s_add_u32 s92, s92, s3
    s_lshl_b32 s92, s92, 2
    s_lshr_b32 s3, s53, 3
    s_add_u32 s92, s92, s3
    s_lshl_b32 s92, s92, 16
    s_lshl_b32 s3, s57, 10
    s_waitcnt lgkmcnt(4)
    v_mfma_f32_32x32x16_bf16 v[64:79], v[32:35], v[128:131], v[64:79]
    ds_read_b128 v[132:135], v115 offset:37888
    ds_read_b64_tr_b16 v[44:45], v116 offset:50176
    ds_read_b64_tr_b16 v[46:47], v116 offset:50688
    s_waitcnt lgkmcnt(5)
    v_mfma_f32_32x32x16_bf16 v[80:95], v[36:39], v[128:131], v[80:95]
    ds_read_b64_tr_b16 v[48:49], v117 offset:50176
    ds_read_b64_tr_b16 v[50:51], v117 offset:50688
    s_waitcnt lgkmcnt(5)
    v_mfma_f32_32x32x16_bf16 v[96:111], v[128:131], v[40:43], v[96:111]
    ds_read_b64_tr_b16 v[52:53], v118 offset:40960
    ds_read_b64_tr_b16 v[54:55], v118 offset:41216
    s_add_u32 s92, s92, s3
    s_lshl_b32 s93, s2, 2
    s_add_u32 s93, s93, s57
    s_lshr_b32 s75, s93, 3
    s_lshl_b32 s75, s75, 14
    s_mov_b32 s36, s8
    s_mov_b32 s37, s9
    s_mov_b32 s38, 524288
    s_mov_b32 s39, 0x20000
    s_cmp_lt_u32 s93, 256
    s_cbranch_scc1 L_rwo
    s_mov_b32 s36, s18
    s_mov_b32 s37, s19
    s_mov_b32 s38, 917504
    s_mov_b32 s39, 0x20000
    s_sub_u32 s75, s75, 524288
L_rwo:
    s_and_b32 s3, s93, 7
    s_lshl_b32 s3, s3, 7
    s_add_u32 s75, s75, s3
    v_lshrrev_b32 v8, 3, v0
    s_waitcnt lgkmcnt(4)
    v_mfma_f32_32x32x16_bf16 v[64:79], v[44:47], v[132:135], v[64:79]
    s_barrier
    s_mov_b32 exec_lo, 65535
    s_mov_b32 exec_hi, 0
    buffer_load_dword v125, v124, s[40:43], s92 offen
    s_mov_b64 exec, -1
    v_add_u32 v112, 74752, v112
    v_add_u32 v113, 74752, v113
    v_add_u32 v114, 74752, v114
    v_add_u32 v115, 74752, v115
    v_add_u32 v116, 74752, v116
    v_add_u32 v117, 74752, v117
    v_add_u32 v118, 74752, v118
    ds_read_b128 v[128:131], v112 offset:0
    ds_read_b64_tr_b16 v[32:33], v116 offset:0
    ds_read_b64_tr_b16 v[34:35], v116 offset:512
    s_waitcnt lgkmcnt(5)
    v_mfma_f32_32x32x16_bf16 v[80:95], v[48:51], v[132:135], v[80:95]
    ds_read_b64_tr_b16 v[36:37], v117 offset:0
    ds_read_b64_tr_b16 v[38:39], v117 offset:512
    s_waitcnt lgkmcnt(5)
    v_mfma_f32_32x32x16_bf16 v[96:111], v[132:135], v[52:55], v[96:111]
    ds_read_b64_tr_b16 v[40:41], v118 offset:0
    ds_read_b64_tr_b16 v[42:43], v118 offset:256
    v_lshlrev_b32 v8, 6, v8
    v_and_or_b32 v8, v0, 7, v8
    v_lshlrev_b32 v8, 4, v8
    v_lshrrev_b32 v10, 5, v0
    v_lshlrev_b32 v119, 9, v10
    v_bfe_u32 v10, v0, 2, 2
    v_lshl_add_u32 v119, v10, 7, v119
    v_bfe_u32 v10, v0, 4, 1
    v_lshl_add_u32 v119, v10, 5, v119
    v_and_b32 v10, 3, v0
    v_lshl_add_u32 v119, v10, 3, v119
    v_add_u32 v119, 152576, v119
    v_add_u32 v119, s80, v119
    v_and_b32 v120, 0x33, v0
    s_waitcnt lgkmcnt(4)
    v_mfma_f32_32x32x16_bf16 v[64:79], v[32:35], v[128:131], v[64:79]
    ds_read_b128 v[132:135], v113 offset:0
    ds_read_b64_tr_b16 v[44:45], v116 offset:4096
    ds_read_b64_tr_b16 v[46:47], v116 offset:4608
    s_waitcnt lgkmcnt(5)
    v_mfma_f32_32x32x16_bf16 v[80:95], v[36:39], v[128:131], v[80:95]
    ds_read_b64_tr_b16 v[48:49], v117 offset:4096
    ds_read_b64_tr_b16 v[50:51], v117 offset:4608
    s_waitcnt lgkmcnt(5)
    v_mfma_f32_32x32x16_bf16 v[96:111], v[128:131], v[40:43], v[96:111]
    ds_read_b64_tr_b16 v[52:53], v118 offset:1024
    ds_read_b64_tr_b16 v[54:55], v118 offset:1280
    v_bfe_u32 v1, v0, 2, 1
    v_lshl_or_b32 v120, v1, 3, v120
    v_bfe_u32 v1, v0, 3, 1
    v_lshl_or_b32 v120, v1, 2, v120
    v_lshlrev_b32 v120, 4, v120
    v_and_b32 v121, 15, v0
    v_lshrrev_b32 v1, 5, v0
    v_lshl_or_b32 v121, v1, 4, v121
    v_lshlrev_b32 v121, 4, v121
    v_bfe_u32 v1, v0, 4, 1
    v_lshl_or_b32 v121, v1, 17, v121
    s_lshl_b32 s59, s55, 7
    s_add_u32 s59, s59, s58
    s_lshl_b32 s70, s59, 11
    s_waitcnt lgkmcnt(4)
    v_mfma_f32_32x32x16_bf16 v[64:79], v[44:47], v[132:135], v[64:79]
    s_mov_b32 exec_lo, 4294901760
    s_mov_b32 exec_hi, 0
    buffer_load_dword v125, v126, s[44:47], s89 offen
    s_mov_b64 exec, -1
    ds_read_b128 v[128:131], v114 offset:0
    ds_read_b64_tr_b16 v[32:33], v116 offset:8192
    ds_read_b64_tr_b16 v[34:35], v116 offset:8704
    s_waitcnt lgkmcnt(5)
    v_mfma_f32_32x32x16_bf16 v[80:95], v[48:51], v[132:135], v[80:95]
    ds_read_b64_tr_b16 v[36:37], v117 offset:8192
    ds_read_b64_tr_b16 v[38:39], v117 offset:8704
    s_waitcnt lgkmcnt(5)
    v_mfma_f32_32x32x16_bf16 v[96:111], v[132:135], v[52:55], v[96:111]
    ds_read_b64_tr_b16 v[40:41], v118 offset:2048
    ds_read_b64_tr_b16 v[42:43], v118 offset:2304
    s_add_u32 s70, s70, 2097152
    s_lshr_b32 s59, s55, 1
    s_lshl_b32 s59, s59, 8
    s_add_u32 s59, s59, s58
    s_lshl_b32 s64, s59, 11
    s_add_u32 s64, s64, 2097152
    s_mov_b32 s68, 131072
    v_mov_b32 v122, 1.0
    s_bitcmp1_b32 s55, 0
    s_cbranch_scc1 L_isk
    s_lshl_b32 s64, s59, 10
    s_mov_b32 s68, 65536
    v_mov_b32 v122, 0x3eb8aa3b
    v_mov_b32 v120, v9
L_isk:
    s_add_u32 s65, s64, s68
    s_add_u32 s66, s65, s68
    s_add_u32 s67, s66, s68
    s_lshr_b32 s71, s55, 1
    s_lshl_b32 s71, s71, 4
    s_waitcnt lgkmcnt(4)
    v_mfma_f32_32x32x16_bf16 v[64:79], v[32:35], v[128:131], v[64:79]
    ds_read_b128 v[132:135], v115 offset:0
    ds_read_b64_tr_b16 v[44:45], v116 offset:12288
    ds_read_b64_tr_b16 v[46:47], v116 offset:12800
    s_waitcnt lgkmcnt(5)
    v_mfma_f32_32x32x16_bf16 v[80:95], v[36:39], v[128:131], v[80:95]
    ds_read_b64_tr_b16 v[48:49], v117 offset:12288
    ds_read_b64_tr_b16 v[50:51], v117 offset:12800
    s_waitcnt lgkmcnt(5)
    v_mfma_f32_32x32x16_bf16 v[96:111], v[128:131], v[40:43], v[96:111]
    ds_read_b64_tr_b16 v[52:53], v118 offset:3072
    ds_read_b64_tr_b16 v[54:55], v118 offset:3328
    s_and_b32 s59, s54, 12
    s_add_u32 s71, s71, s59
    s_lshl_b32 s71, s71, 1
    s_add_u32 s71, s71, 1536
    v_and_b32 v123, 15, v0
    v_lshlrev_b32 v123, 2, v123
    s_lshl_b32 s72, s52, 2
    s_lshr_b32 s59, s53, 3
    s_add_u32 s72, s72, s59
    s_and_b32 s74, s53, 7
    s_lshl_b32 s73, s74, 3
    s_lshl_b32 s59, s57, 1
    s_add_u32 s73, s73, s59
    s_lshl_b32 s78, s72, 6
    s_waitcnt lgkmcnt(4)
    v_mfma_f32_32x32x16_bf16 v[64:79], v[44:47], v[132:135], v[64:79]
    s_barrier
    ds_read_b128 v[128:131], v112 offset:36864
    ds_read_b64_tr_b16 v[32:33], v116 offset:36864
    ds_read_b64_tr_b16 v[34:35], v116 offset:37376
    s_waitcnt lgkmcnt(5)
    v_mfma_f32_32x32x16_bf16 v[80:95], v[48:51], v[132:135], v[80:95]
    ds_read_b64_tr_b16 v[36:37], v117 offset:36864
    ds_read_b64_tr_b16 v[38:39], v117 offset:37376
    s_waitcnt lgkmcnt(5)
    v_mfma_f32_32x32x16_bf16 v[96:111], v[132:135], v[52:55], v[96:111]
    ds_read_b64_tr_b16 v[40:41], v118 offset:36864
    ds_read_b64_tr_b16 v[42:43], v118 offset:37120
    s_add_u32 s78, s78, s73
    s_lshl_b32 s78, s78, 10
    s_lshl_b32 s79, s72, 17
    s_add_u32 s79, s79, 2097152
    s_lshl_b32 s80, s57, 11
    s_add_u32 s81, s79, s80
    s_and_b32 s76, s53, 0
    s_lshl_b32 s76, s76, 14
    s_lshl_b32 s82, s73, 7
    s_add_u32 s82, s82, 23068672
    s_mov_b32 s86, 0xffff
    s_mov_b32 s87, 0xffff
    s_mul_i32 s83, s73, 88
    s_add_u32 s83, s83, s72
    s_waitcnt lgkmcnt(4)
    v_mfma_f32_32x32x16_bf16 v[64:79], v[32:35], v[128:131], v[64:79]
    s_add_u32 m0, s80, 152576
    s_nop 0
    buffer_load_dwordx4 v8, s[36:39], s75 offen lds
    s_add_u32 s75, s75, 7168
    buffer_load_dwordx4 v8, s[36:39], s75 offen offset:1024 lds
    ds_read_b128 v[132:135], v113 offset:36864
    ds_read_b64_tr_b16 v[44:45], v116 offset:40960
    ds_read_b64_tr_b16 v[46:47], v116 offset:41472
    s_waitcnt lgkmcnt(5)
    v_mfma_f32_32x32x16_bf16 v[80:95], v[36:39], v[128:131], v[80:95]
    ds_read_b64_tr_b16 v[48:49], v117 offset:40960
    ds_read_b64_tr_b16 v[50:51], v117 offset:41472
    s_waitcnt lgkmcnt(5)
    v_mfma_f32_32x32x16_bf16 v[96:111], v[128:131], v[40:43], v[96:111]
    ds_read_b64_tr_b16 v[52:53], v118 offset:37888
    ds_read_b64_tr_b16 v[54:55], v118 offset:38144
    s_lshl_b32 s83, s83, 10
    s_add_u32 s83, s83, 14680064
    s_add_u32 s84, s83, 90112
    s_lshr_b32 s85, s72, 4
    s_add_u32 s85, s85, s73
    s_lshl_b32 s85, s85, 2
    s_add_u32 s85, s85, 1792
    v_lshlrev_b32 v4, 4, v0
    v_and_b32 v5, 31, v0
    s_lshr_b32 s59, s72, 2
    s_lshl_b32 s59, s59, 5
    s_add_u32 s59, s59, s74
    s_add_u32 s59, s59, 1536
    v_lshl_add_u32 v61, v0, 3, s59
    s_waitcnt lgkmcnt(4)
    v_mfma_f32_32x32x16_bf16 v[64:79], v[44:47], v[132:135], v[64:79]
    ds_read_b128 v[128:131], v114 offset:36864
    ds_read_b64_tr_b16 v[32:33], v116 offset:45056
    ds_read_b64_tr_b16 v[34:35], v116 offset:45568
    s_waitcnt lgkmcnt(5)
    v_mfma_f32_32x32x16_bf16 v[80:95], v[48:51], v[132:135], v[80:95]
    ds_read_b64_tr_b16 v[36:37], v117 offset:45056
    ds_read_b64_tr_b16 v[38:39], v117 offset:45568
    s_waitcnt lgkmcnt(5)
    v_mfma_f32_32x32x16_bf16 v[96:111], v[132:135], v[52:55], v[96:111]
    ds_read_b64_tr_b16 v[40:41], v118 offset:38912
    ds_read_b64_tr_b16 v[42:43], v118 offset:39168
    v_mul_u32_u24 v61, 256, v61
    v_mul_u32_u24 v63, 256, v0
    v_lshlrev_b32 v5, 2, v5
    v_mov_b32 v3, 0xdddd
    v_mov_b32 v1, v4
    v_and_b32 v2, 15, v0
    v_lshrrev_b32 v62, 5, v0
    v_lshl_or_b32 v2, v62, 4, v2
    v_lshlrev_b32 v2, 4, v2
    v_add_u32 v2, 1024, v2
    v_add_u32 v56, 0x10000, v1
    v_add_u32 v57, 0x10000, v2
    v_mov_b32 v58, 1
    s_lshl_b32 s59, s57, 2
    s_waitcnt lgkmcnt(4)
    v_mfma_f32_32x32x16_bf16 v[64:79], v[32:35], v[128:131], v[64:79]
    ds_read_b128 v[132:135], v115 offset:36864
    ds_read_b64_tr_b16 v[44:45], v116 offset:49152
    ds_read_b64_tr_b16 v[46:47], v116 offset:49664
    s_waitcnt lgkmcnt(5)
    v_mfma_f32_32x32x16_bf16 v[80:95], v[36:39], v[128:131], v[80:95]
    ds_read_b64_tr_b16 v[48:49], v117 offset:49152
    ds_read_b64_tr_b16 v[50:51], v117 offset:49664
    s_waitcnt lgkmcnt(5)
    v_mfma_f32_32x32x16_bf16 v[96:111], v[128:131], v[40:43], v[96:111]
    ds_read_b64_tr_b16 v[52:53], v118 offset:39936
    ds_read_b64_tr_b16 v[54:55], v118 offset:40192
    v_mov_b32 v59, s59
    v_mov_b32 v60, 0
    v_and_b32 v62, 27, v0
    v_cmp_eq_u32 vcc, 16, v62
    v_mov_b32 v62, 0x3f803f80
    s_nop 0
    v_cndmask_b32 v160, 0, v62, vcc
    v_mov_b32 v161, v160
    v_mov_b32 v162, v160
    v_mov_b32 v163, v160
    v_mov_b32 v164, v160
    v_mov_b32 v165, v160
    v_mov_b32 v166, v160
    v_mov_b32 v167, v160
    s_waitcnt lgkmcnt(4)
    v_mfma_f32_32x32x16_bf16 v[64:79], v[44:47], v[132:135], v[64:79]
    s_barrier
    v_add_u32 v112, 4294893568, v112
    v_add_u32 v113, 4294893568, v113
    v_add_u32 v114, 4294893568, v114
    v_add_u32 v115, 4294893568, v115
    v_add_u32 v116, 4294893568, v116
    v_add_u32 v117, 4294893568, v117
    v_add_u32 v118, 4294893568, v118
    ds_read_b128 v[128:131], v112 offset:0
    ds_read_b64_tr_b16 v[32:33], v116 offset:0
    ds_read_b64_tr_b16 v[34:35], v116 offset:512
    s_waitcnt lgkmcnt(5)
    v_mfma_f32_32x32x16_bf16 v[80:95], v[48:51], v[132:135], v[80:95]
    ds_read_b64_tr_b16 v[36:37], v117 offset:0
    ds_read_b64_tr_b16 v[38:39], v117 offset:512
    s_waitcnt lgkmcnt(5)
    v_mfma_f32_32x32x16_bf16 v[96:111], v[132:135], v[52:55], v[96:111]
    ds_read_b64_tr_b16 v[40:41], v118 offset:0
    ds_read_b64_tr_b16 v[42:43], v118 offset:256
    v_mov_b32 v168, v160
    v_mov_b32 v169, v160
    v_mov_b32 v170, v160
    v_mov_b32 v171, v160
    v_mov_b32 v172, v160
    v_mov_b32 v173, v160
    v_mov_b32 v174, v160
    v_mov_b32 v175, v160
    v_mov_b32 v176, v160
    v_mov_b32 v177, v160
    v_mov_b32 v178, v160
    v_mov_b32 v179, v160
    v_mov_b32 v180, v160
    v_mov_b32 v181, v160
    s_waitcnt lgkmcnt(4)
    v_mfma_f32_32x32x16_bf16 v[64:79], v[32:35], v[128:131], v[64:79]
    s_mov_b32 exec_lo, 4294901760
    s_mov_b32 exec_hi, 0
    buffer_load_dword v125, v124, s[40:43], s92 offen
    s_mov_b64 exec, -1
    ds_read_b128 v[132:135], v113 offset:0
    ds_read_b64_tr_b16 v[44:45], v116 offset:4096
    ds_read_b64_tr_b16 v[46:47], v116 offset:4608
    s_waitcnt lgkmcnt(5)
    v_mfma_f32_32x32x16_bf16 v[80:95], v[36:39], v[128:131], v[80:95]
    ds_read_b64_tr_b16 v[48:49], v117 offset:4096
    ds_read_b64_tr_b16 v[50:51], v117 offset:4608
    s_waitcnt lgkmcnt(5)
    v_mfma_f32_32x32x16_bf16 v[96:111], v[128:131], v[40:43], v[96:111]
    ds_read_b64_tr_b16 v[52:53], v118 offset:1024
    ds_read_b64_tr_b16 v[54:55], v118 offset:1280
    v_mov_b32 v182, v160
    v_mov_b32 v183, v160
    v_mov_b32 v184, v160
    v_mov_b32 v185, v160
    v_mov_b32 v186, v160
    v_mov_b32 v187, v160
    v_mov_b32 v188, v160
    v_mov_b32 v189, v160
    v_mov_b32 v190, v160
    v_mov_b32 v191, v160
    v_mov_b32 v200, 0
    v_mov_b32 v201, 0
    v_mov_b32 v202, 0
    v_mov_b32 v203, 0
    s_waitcnt lgkmcnt(4)
    v_mfma_f32_32x32x16_bf16 v[64:79], v[44:47], v[132:135], v[64:79]
    ds_read_b128 v[128:131], v114 offset:0
    ds_read_b64_tr_b16 v[32:33], v116 offset:8192
    ds_read_b64_tr_b16 v[34:35], v116 offset:8704
    s_waitcnt lgkmcnt(5)
    v_mfma_f32_32x32x16_bf16 v[80:95], v[48:51], v[132:135], v[80:95]
    ds_read_b64_tr_b16 v[36:37], v117 offset:8192
    ds_read_b64_tr_b16 v[38:39], v117 offset:8704
    s_waitcnt lgkmcnt(5)
    v_mfma_f32_32x32x16_bf16 v[96:111], v[132:135], v[52:55], v[96:111]
    ds_read_b64_tr_b16 v[40:41], v118 offset:2048
    ds_read_b64_tr_b16 v[42:43], v118 offset:2304
    v_mov_b32 v204, 0
    v_mov_b32 v205, 0
    v_mov_b32 v206, 0
    v_mov_b32 v207, 0
    v_mov_b32 v208, 0
    v_mov_b32 v209, 0
    v_mov_b32 v210, 0
    v_mov_b32 v211, 0
    v_mov_b32 v212, 0
    v_mov_b32 v213, 0
    v_mov_b32 v214, 0
    v_mov_b32 v215, 0
    v_mov_b32 v216, 0
    v_mov_b32 v217, 0
    s_waitcnt lgkmcnt(4)
    v_mfma_f32_32x32x16_bf16 v[64:79], v[32:35], v[128:131], v[64:79]
    ds_read_b128 v[132:135], v115 offset:0
    ds_read_b64_tr_b16 v[44:45], v116 offset:12288
    ds_read_b64_tr_b16 v[46:47], v116 offset:12800
    s_waitcnt lgkmcnt(5)
    v_mfma_f32_32x32x16_bf16 v[80:95], v[36:39], v[128:131], v[80:95]
    ds_read_b64_tr_b16 v[48:49], v117 offset:12288
    ds_read_b64_tr_b16 v[50:51], v117 offset:12800
    s_waitcnt lgkmcnt(5)
    v_mfma_f32_32x32x16_bf16 v[96:111], v[128:131], v[40:43], v[96:111]
    ds_read_b64_tr_b16 v[52:53], v118 offset:3072
    ds_read_b64_tr_b16 v[54:55], v118 offset:3328
    v_mov_b32 v218, 0
    v_mov_b32 v219, 0
    v_mov_b32 v220, 0
    v_mov_b32 v221, 0
    v_mov_b32 v222, 0
    v_mov_b32 v223, 0
    v_mov_b32 v224, 0
    v_mov_b32 v225, 0
    v_mov_b32 v226, 0
    v_mov_b32 v227, 0
    v_mov_b32 v228, 0
    v_mov_b32 v229, 0
    v_mov_b32 v230, 0
    v_mov_b32 v231, 0
    s_waitcnt lgkmcnt(4)
    v_mfma_f32_32x32x16_bf16 v[64:79], v[44:47], v[132:135], v[64:79]
    s_barrier
    ds_read_b128 v[128:131], v112 offset:36864
    ds_read_b64_tr_b16 v[32:33], v116 offset:36864
    ds_read_b64_tr_b16 v[34:35], v116 offset:37376
    s_waitcnt lgkmcnt(5)
    v_mfma_f32_32x32x16_bf16 v[80:95], v[48:51], v[132:135], v[80:95]
    ds_read_b64_tr_b16 v[36:37], v117 offset:36864
    ds_read_b64_tr_b16 v[38:39], v117 offset:37376
    s_waitcnt lgkmcnt(5)
    v_mfma_f32_32x32x16_bf16 v[96:111], v[132:135], v[52:55], v[96:111]
    ds_read_b64_tr_b16 v[40:41], v118 offset:36864
    ds_read_b64_tr_b16 v[42:43], v118 offset:37120
    s_waitcnt lgkmcnt(4)
    v_mfma_f32_32x32x16_bf16 v[64:79], v[32:35], v[128:131], v[64:79]
    ds_read_b128 v[132:135], v113 offset:36864
    ds_read_b64_tr_b16 v[44:45], v116 offset:40960
    ds_read_b64_tr_b16 v[46:47], v116 offset:41472
    s_waitcnt lgkmcnt(5)
    v_mfma_f32_32x32x16_bf16 v[80:95], v[36:39], v[128:131], v[80:95]
    ds_read_b64_tr_b16 v[48:49], v117 offset:40960
    ds_read_b64_tr_b16 v[50:51], v117 offset:41472
    s_waitcnt lgkmcnt(5)
    v_mfma_f32_32x32x16_bf16 v[96:111], v[128:131], v[40:43], v[96:111]
    ds_read_b64_tr_b16 v[52:53], v118 offset:37888
    ds_read_b64_tr_b16 v[54:55], v118 offset:38144
    s_waitcnt lgkmcnt(4)
    v_mfma_f32_32x32x16_bf16 v[64:79], v[44:47], v[132:135], v[64:79]
    ds_read_b128 v[128:131], v114 offset:36864
    ds_read_b64_tr_b16 v[32:33], v116 offset:45056
    ds_read_b64_tr_b16 v[34:35], v116 offset:45568
    s_waitcnt lgkmcnt(5)
    v_mfma_f32_32x32x16_bf16 v[80:95], v[48:51], v[132:135], v[80:95]
    ds_read_b64_tr_b16 v[36:37], v117 offset:45056
    ds_read_b64_tr_b16 v[38:39], v117 offset:45568
    s_waitcnt lgkmcnt(5)
    v_mfma_f32_32x32x16_bf16 v[96:111], v[132:135], v[52:55], v[96:111]
    ds_read_b64_tr_b16 v[40:41], v118 offset:38912
    ds_read_b64_tr_b16 v[42:43], v118 offset:39168
    s_waitcnt lgkmcnt(4)
    v_mfma_f32_32x32x16_bf16 v[64:79], v[32:35], v[128:131], v[64:79]
    ds_read_b128 v[132:135], v115 offset:36864
    ds_read_b64_tr_b16 v[44:45], v116 offset:49152
    ds_read_b64_tr_b16 v[46:47], v116 offset:49664
    s_waitcnt lgkmcnt(5)
    v_mfma_f32_32x32x16_bf16 v[80:95], v[36:39], v[128:131], v[80:95]
    ds_read_b64_tr_b16 v[48:49], v117 offset:49152
    ds_read_b64_tr_b16 v[50:51], v117 offset:49664
    s_waitcnt lgkmcnt(5)
    v_mfma_f32_32x32x16_bf16 v[96:111], v[128:131], v[40:43], v[96:111]
    ds_read_b64_tr_b16 v[52:53], v118 offset:39936
    ds_read_b64_tr_b16 v[54:55], v118 offset:40192
    s_waitcnt lgkmcnt(4)
    v_mfma_f32_32x32x16_bf16 v[64:79], v[44:47], v[132:135], v[64:79]
    s_barrier
    v_add_u32 v112, 73728, v112
    v_add_u32 v113, 73728, v113
    v_add_u32 v114, 73728, v114
    v_add_u32 v115, 73728, v115
    v_add_u32 v116, 73728, v116
    v_add_u32 v117, 73728, v117
    v_add_u32 v118, 73728, v118
    ds_read_b128 v[128:131], v112 offset:0
    ds_read_b64_tr_b16 v[32:33], v116 offset:0
    ds_read_b64_tr_b16 v[34:35], v116 offset:512
    s_waitcnt lgkmcnt(5)
    v_mfma_f32_32x32x16_bf16 v[80:95], v[48:51], v[132:135], v[80:95]
    ds_read_b64_tr_b16 v[36:37], v117 offset:0
    ds_read_b64_tr_b16 v[38:39], v117 offset:512
    s_waitcnt lgkmcnt(5)
    v_mfma_f32_32x32x16_bf16 v[96:111], v[132:135], v[52:55], v[96:111]
    ds_read_b64_tr_b16 v[40:41], v118 offset:0
    ds_read_b64_tr_b16 v[42:43], v118 offset:256
    s_waitcnt lgkmcnt(4)
    v_mfma_f32_32x32x16_bf16 v[64:79], v[32:35], v[128:131], v[64:79]
    ds_read_b128 v[132:135], v113 offset:0
    ds_read_b64_tr_b16 v[44:45], v116 offset:4096
    ds_read_b64_tr_b16 v[46:47], v116 offset:4608
    s_waitcnt lgkmcnt(5)
    v_mfma_f32_32x32x16_bf16 v[80:95], v[36:39], v[128:131], v[80:95]
    ds_read_b64_tr_b16 v[48:49], v117 offset:4096
    ds_read_b64_tr_b16 v[50:51], v117 offset:4608
    s_waitcnt lgkmcnt(5)
    v_mfma_f32_32x32x16_bf16 v[96:111], v[128:131], v[40:43], v[96:111]
    ds_read_b64_tr_b16 v[52:53], v118 offset:1024
    ds_read_b64_tr_b16 v[54:55], v118 offset:1280
    s_waitcnt lgkmcnt(4)
    v_mfma_f32_32x32x16_bf16 v[64:79], v[44:47], v[132:135], v[64:79]
    ds_read_b128 v[128:131], v114 offset:0
    ds_read_b64_tr_b16 v[32:33], v116 offset:8192
    ds_read_b64_tr_b16 v[34:35], v116 offset:8704
    s_waitcnt lgkmcnt(5)
    v_mfma_f32_32x32x16_bf16 v[80:95], v[48:51], v[132:135], v[80:95]
    ds_read_b64_tr_b16 v[36:37], v117 offset:8192
    ds_read_b64_tr_b16 v[38:39], v117 offset:8704
    s_waitcnt lgkmcnt(5)
    v_mfma_f32_32x32x16_bf16 v[96:111], v[132:135], v[52:55], v[96:111]
    ds_read_b64_tr_b16 v[40:41], v118 offset:2048
    ds_read_b64_tr_b16 v[42:43], v118 offset:2304
    s_waitcnt lgkmcnt(4)
    v_mfma_f32_32x32x16_bf16 v[64:79], v[32:35], v[128:131], v[64:79]
    ds_read_b128 v[132:135], v115 offset:0
    ds_read_b64_tr_b16 v[44:45], v116 offset:12288
    ds_read_b64_tr_b16 v[46:47], v116 offset:12800
    s_waitcnt lgkmcnt(5)
    v_mfma_f32_32x32x16_bf16 v[80:95], v[36:39], v[128:131], v[80:95]
    ds_read_b64_tr_b16 v[48:49], v117 offset:12288
    ds_read_b64_tr_b16 v[50:51], v117 offset:12800
    s_waitcnt lgkmcnt(5)
    v_mfma_f32_32x32x16_bf16 v[96:111], v[128:131], v[40:43], v[96:111]
    ds_read_b64_tr_b16 v[52:53], v118 offset:3072
    ds_read_b64_tr_b16 v[54:55], v118 offset:3328
    s_waitcnt lgkmcnt(4)
    v_mfma_f32_32x32x16_bf16 v[64:79], v[44:47], v[132:135], v[64:79]
    s_barrier
    ds_read_b128 v[128:131], v112 offset:36864
    ds_read_b64_tr_b16 v[32:33], v116 offset:36864
    ds_read_b64_tr_b16 v[34:35], v116 offset:37376
    s_waitcnt lgkmcnt(5)
    v_mfma_f32_32x32x16_bf16 v[80:95], v[48:51], v[132:135], v[80:95]
    ds_read_b64_tr_b16 v[36:37], v117 offset:36864
    ds_read_b64_tr_b16 v[38:39], v117 offset:37376
    s_waitcnt lgkmcnt(5)
    v_mfma_f32_32x32x16_bf16 v[96:111], v[132:135], v[52:55], v[96:111]
    ds_read_b64_tr_b16 v[40:41], v118 offset:36864
    ds_read_b64_tr_b16 v[42:43], v118 offset:37120
    s_waitcnt lgkmcnt(4)
    v_mfma_f32_32x32x16_bf16 v[64:79], v[32:35], v[128:131], v[64:79]
    ds_read_b128 v[132:135], v113 offset:36864
    ds_read_b64_tr_b16 v[44:45], v116 offset:40960
    ds_read_b64_tr_b16 v[46:47], v116 offset:41472
    s_waitcnt lgkmcnt(5)
    v_mfma_f32_32x32x16_bf16 v[80:95], v[36:39], v[128:131], v[80:95]
    ds_read_b64_tr_b16 v[48:49], v117 offset:40960
    ds_read_b64_tr_b16 v[50:51], v117 offset:41472
    s_waitcnt lgkmcnt(5)
    v_mfma_f32_32x32x16_bf16 v[96:111], v[128:131], v[40:43], v[96:111]
    ds_read_b64_tr_b16 v[52:53], v118 offset:37888
    ds_read_b64_tr_b16 v[54:55], v118 offset:38144
    s_waitcnt lgkmcnt(4)
    v_mfma_f32_32x32x16_bf16 v[64:79], v[44:47], v[132:135], v[64:79]
    buffer_load_dword v124, v123, s[32:35], 0 offen sc1
    ds_read_b128 v[128:131], v114 offset:36864
    ds_read_b64_tr_b16 v[32:33], v116 offset:45056
    ds_read_b64_tr_b16 v[34:35], v116 offset:45568
    s_waitcnt lgkmcnt(5)
    v_mfma_f32_32x32x16_bf16 v[80:95], v[48:51], v[132:135], v[80:95]
    ds_read_b64_tr_b16 v[36:37], v117 offset:45056
    ds_read_b64_tr_b16 v[38:39], v117 offset:45568
    s_waitcnt lgkmcnt(5)
    v_mfma_f32_32x32x16_bf16 v[96:111], v[132:135], v[52:55], v[96:111]
    ds_read_b64_tr_b16 v[40:41], v118 offset:38912
    ds_read_b64_tr_b16 v[42:43], v118 offset:39168
    s_waitcnt lgkmcnt(4)
    v_mfma_f32_32x32x16_bf16 v[64:79], v[32:35], v[128:131], v[64:79]
    ds_read_b128 v[132:135], v115 offset:36864
    ds_read_b64_tr_b16 v[44:45], v116 offset:49152
    ds_read_b64_tr_b16 v[46:47], v116 offset:49664
    s_waitcnt lgkmcnt(5)
    v_mfma_f32_32x32x16_bf16 v[80:95], v[36:39], v[128:131], v[80:95]
    ds_read_b64_tr_b16 v[48:49], v117 offset:49152
    ds_read_b64_tr_b16 v[50:51], v117 offset:49664
    s_waitcnt lgkmcnt(5)
    v_mfma_f32_32x32x16_bf16 v[96:111], v[128:131], v[40:43], v[96:111]
    ds_read_b64_tr_b16 v[52:53], v118 offset:39936
    ds_read_b64_tr_b16 v[54:55], v118 offset:40192
    s_waitcnt lgkmcnt(4)
    v_mfma_f32_32x32x16_bf16 v[64:79], v[44:47], v[132:135], v[64:79]
    s_barrier
    v_add_u32 v112, 4294893568, v112
    v_add_u32 v113, 4294893568, v113
    v_add_u32 v114, 4294893568, v114
    v_add_u32 v115, 4294893568, v115
    v_add_u32 v116, 4294893568, v116
    v_add_u32 v117, 4294893568, v117
    v_add_u32 v118, 4294893568, v118
    ds_read_b128 v[128:131], v112 offset:0
    ds_read_b64_tr_b16 v[32:33], v116 offset:0
    ds_read_b64_tr_b16 v[34:35], v116 offset:512
    s_waitcnt lgkmcnt(5)
    v_mfma_f32_32x32x16_bf16 v[80:95], v[48:51], v[132:135], v[80:95]
    ds_read_b64_tr_b16 v[36:37], v117 offset:0
    ds_read_b64_tr_b16 v[38:39], v117 offset:512
    s_waitcnt lgkmcnt(5)
    v_mfma_f32_32x32x16_bf16 v[96:111], v[132:135], v[52:55], v[96:111]
    ds_read_b64_tr_b16 v[40:41], v118 offset:0
    ds_read_b64_tr_b16 v[42:43], v118 offset:256
    s_waitcnt lgkmcnt(4)
    v_mfma_f32_32x32x16_bf16 v[64:79], v[32:35], v[128:131], v[64:79]
    ds_read_b128 v[132:135], v113 offset:0
    ds_read_b64_tr_b16 v[44:45], v116 offset:4096
    ds_read_b64_tr_b16 v[46:47], v116 offset:4608
    s_waitcnt lgkmcnt(5)
    v_mfma_f32_32x32x16_bf16 v[80:95], v[36:39], v[128:131], v[80:95]
    ds_read_b64_tr_b16 v[48:49], v117 offset:4096
    ds_read_b64_tr_b16 v[50:51], v117 offset:4608
    s_waitcnt lgkmcnt(5)
    v_mfma_f32_32x32x16_bf16 v[96:111], v[128:131], v[40:43], v[96:111]
    ds_read_b64_tr_b16 v[52:53], v118 offset:1024
    ds_read_b64_tr_b16 v[54:55], v118 offset:1280
    s_waitcnt lgkmcnt(4)
    v_mfma_f32_32x32x16_bf16 v[64:79], v[44:47], v[132:135], v[64:79]
    ds_read_b128 v[128:131], v114 offset:0
    ds_read_b64_tr_b16 v[32:33], v116 offset:8192
    ds_read_b64_tr_b16 v[34:35], v116 offset:8704
    s_waitcnt lgkmcnt(5)
    v_mfma_f32_32x32x16_bf16 v[80:95], v[48:51], v[132:135], v[80:95]
    ds_read_b64_tr_b16 v[36:37], v117 offset:8192
    ds_read_b64_tr_b16 v[38:39], v117 offset:8704
    s_waitcnt lgkmcnt(5)
    v_mfma_f32_32x32x16_bf16 v[96:111], v[132:135], v[52:55], v[96:111]
    ds_read_b64_tr_b16 v[40:41], v118 offset:2048
    ds_read_b64_tr_b16 v[42:43], v118 offset:2304
    s_waitcnt lgkmcnt(4)
    v_mfma_f32_32x32x16_bf16 v[64:79], v[32:35], v[128:131], v[64:79]
    ds_read_b128 v[132:135], v115 offset:0
    ds_read_b64_tr_b16 v[44:45], v116 offset:12288
    ds_read_b64_tr_b16 v[46:47], v116 offset:12800
    s_waitcnt lgkmcnt(5)
    v_mfma_f32_32x32x16_bf16 v[80:95], v[36:39], v[128:131], v[80:95]
    ds_read_b64_tr_b16 v[48:49], v117 offset:12288
    ds_read_b64_tr_b16 v[50:51], v117 offset:12800
    s_waitcnt lgkmcnt(5)
    v_mfma_f32_32x32x16_bf16 v[96:111], v[128:131], v[40:43], v[96:111]
    ds_read_b64_tr_b16 v[52:53], v118 offset:3072
    ds_read_b64_tr_b16 v[54:55], v118 offset:3328
    s_waitcnt lgkmcnt(4)
    v_mfma_f32_32x32x16_bf16 v[64:79], v[44:47], v[132:135], v[64:79]
    s_waitcnt lgkmcnt(2)
    v_mfma_f32_32x32x16_bf16 v[80:95], v[48:51], v[132:135], v[80:95]
    s_waitcnt lgkmcnt(0)
    v_mfma_f32_32x32x16_bf16 v[96:111], v[132:135], v[52:55], v[96:111]
    s_nop 7
    v_mul_f32 v64, v64, v122
    v_mul_f32 v65, v65, v122
    v_mul_f32 v66, v66, v122
    v_mul_f32 v67, v67, v122
    v_mul_f32 v68, v68, v122
    v_mul_f32 v69, v69, v122
    v_mul_f32 v70, v70, v122
    v_mul_f32 v71, v71, v122
    v_mul_f32 v72, v72, v122
    v_mul_f32 v73, v73, v122
    v_mul_f32 v74, v74, v122
    v_mul_f32 v75, v75, v122
    v_mul_f32 v76, v76, v122
    v_mul_f32 v77, v77, v122
    v_mul_f32 v78, v78, v122
    v_mul_f32 v79, v79, v122
    v_cvt_pk_bf16_f32 v8, v64, v65
    v_cvt_pk_bf16_f32 v9, v66, v67
    v_cvt_pk_bf16_f32 v10, v68, v69
    v_cvt_pk_bf16_f32 v11, v70, v71
    v_cvt_pk_bf16_f32 v12, v72, v73
    v_cvt_pk_bf16_f32 v13, v74, v75
    v_cvt_pk_bf16_f32 v14, v76, v77
    v_cvt_pk_bf16_f32 v15, v78, v79
    buffer_store_dwordx4 v[8:11], v120, s[28:31], s64 offen offset:0 sc1
    buffer_store_dwordx4 v[12:15], v120, s[28:31], s65 offen offset:0 sc1
    v_mul_f32 v80, v80, v122
    v_mul_f32 v81, v81, v122
    v_mul_f32 v82, v82, v122
    v_mul_f32 v83, v83, v122
    v_mul_f32 v84, v84, v122
    v_mul_f32 v85, v85, v122
    v_mul_f32 v86, v86, v122
    v_mul_f32 v87, v87, v122
    v_mul_f32 v88, v88, v122
    v_mul_f32 v89, v89, v122
    v_mul_f32 v90, v90, v122
    v_mul_f32 v91, v91, v122
    v_mul_f32 v92, v92, v122
    v_mul_f32 v93, v93, v122
    v_mul_f32 v94, v94, v122
    v_mul_f32 v95, v95, v122
    v_cvt_pk_bf16_f32 v16, v80, v81
    v_cvt_pk_bf16_f32 v17, v82, v83
    v_cvt_pk_bf16_f32 v18, v84, v85
    v_cvt_pk_bf16_f32 v19, v86, v87
    v_cvt_pk_bf16_f32 v20, v88, v89
    v_cvt_pk_bf16_f32 v21, v90, v91
    v_cvt_pk_bf16_f32 v22, v92, v93
    v_cvt_pk_bf16_f32 v23, v94, v95
    buffer_store_dwordx4 v[16:19], v120, s[28:31], s66 offen offset:0 sc1
    buffer_store_dwordx4 v[20:23], v120, s[28:31], s67 offen offset:0 sc1
    v_cvt_pk_bf16_f32 v24, v96, v97
    v_cvt_pk_bf16_f32 v25, v98, v99
    v_cvt_pk_bf16_f32 v26, v100, v101
    v_cvt_pk_bf16_f32 v27, v102, v103
    v_cvt_pk_bf16_f32 v28, v104, v105
    v_cvt_pk_bf16_f32 v29, v106, v107
    v_cvt_pk_bf16_f32 v30, v108, v109
    v_cvt_pk_bf16_f32 v31, v110, v111
    buffer_store_dwordx4 v[24:27], v121, s[28:31], s70 offen offset:1024 sc1
    buffer_store_dwordx4 v[28:31], v121, s[28:31], s70 offen offset:1536 sc1
    s_and_b32 s3, s93, 7
    s_mul_i32 s3, s3, 180224
    s_lshr_b32 s88, s93, 3
    s_lshl_b32 s88, s88, 10
    s_add_u32 s88, s88, s3
    s_add_u32 s88, s88, 20971520
    s_cmp_ge_u32 s93, 704
    s_cselect_b32 s88, 29360128, s88
    s_add_u32 s89, s88, 90112
    s_and_b32 s3, s93, 7
    s_lshl_b32 s3, s3, 4
    s_lshr_b32 s93, s93, 6
    s_add_u32 s93, s93, s3
    s_add_u32 s93, s93, 896
    s_waitcnt vmcnt(6)
    ds_read_b64_tr_b16 v[48:49], v119 offset:0
    ds_read_b64_tr_b16 v[50:51], v119 offset:1024
    ds_read_b64_tr_b16 v[52:53], v119 offset:64
    ds_read_b64_tr_b16 v[54:55], v119 offset:1088
    v_cmp_eq_u32 vcc, 0, v124
    s_waitcnt lgkmcnt(0)
    s_cmp_eq_u64 vcc, 0
    s_cbranch_scc1 L_clr1d
    s_mov_b32 s91, 65536
    buffer_load_dword v124, v123, s[32:35], 0 offen sc1
L_clr1:
    s_waitcnt vmcnt(0)
    v_cmp_eq_u32 vcc, 0, v124
    s_sub_u32 s91, s91, 1
    s_cbranch_scc1 L_clr1d
    s_cmp_eq_u64 vcc, 0
    s_cbranch_scc1 L_clr1d
    buffer_load_dword v124, v123, s[32:35], 0 offen sc1
    s_branch L_clr1
L_clr1d:
    ds_write_b32 v59, v58 offset:192
    s_waitcnt vmcnt(0)
    s_mul_i32 s71, s71, 256
    s_add_u32 s71, s71, 23592960
    s_mov_b64 exec, 255
    buffer_atomic_add v58, v63, s[28:31], s71 offen sc1
    s_mov_b64 exec, -1
    s_setprio 3
    s_mov_b32 s91, 65536
L_bz0:
    ds_read_b128 v[104:107], v60 offset:176
    s_waitcnt lgkmcnt(0)
    v_and_b32 v104, v104, v105
    v_and_b32 v106, v106, v107
    v_and_b32 v104, v104, v106
    s_sub_u32 s91, s91, 1
    v_readfirstlane_b32 s3, v104
    s_cbranch_scc1 L_bz0d
    s_cmp_lg_u32 s3, 0
    s_cbranch_scc1 L_bz0d
    s_sleep 2
    s_branch L_bz0
L_bz0d:
    s_lshl_b64 s[64:65], 1, s57
    s_mov_b32 s91, 65536
    s_mov_b64 exec, s[64:65]
    v_mov_b32 v114, 0
    buffer_atomic_add v114, v61, s[28:31], s90 offen sc0 sc1
    s_sleep 4
    v_mov_b32 v115, 0
    buffer_atomic_add v115, v61, s[28:31], s90 offen sc0 sc1
    s_sleep 4
L_pq:
    v_mov_b32 v116, 0
    buffer_atomic_add v116, v61, s[28:31], s90 offen sc0 sc1
    s_sleep 3
    s_waitcnt vmcnt(2)
    v_cmp_gt_u32 vcc, 32, v114
    s_sub_u32 s91, s91, 1
    s_cbranch_scc1 L_pqd
    s_and_b64 exec, exec, vcc
    s_cbranch_scc0 L_pqd
    v_mov_b32 v114, 0
    buffer_atomic_add v114, v61, s[28:31], s90 offen sc0 sc1
    s_sleep 3
    s_waitcnt vmcnt(2)
    v_cmp_gt_u32 vcc, 32, v115
    s_sub_u32 s91, s91, 1
    s_cbranch_scc1 L_pqd
    s_and_b64 exec, exec, vcc
    s_cbranch_scc0 L_pqd
    v_mov_b32 v115, 0
    buffer_atomic_add v115, v61, s[28:31], s90 offen sc0 sc1
    s_sleep 3
    s_waitcnt vmcnt(2)
    v_cmp_gt_u32 vcc, 32, v116
    s_sub_u32 s91, s91, 1
    s_cbranch_scc1 L_pqd
    s_and_b64 exec, exec, vcc
    s_cbranch_scc0 L_pqd
    s_branch L_pq
L_pqd:
    s_mov_b64 exec, -1
    ds_write_b32 v59, v58 offset:80
    s_mov_b32 s91, 65536
L_pq2:
    ds_read_b128 v[232:235], v60 offset:80
    s_waitcnt lgkmcnt(0)
    v_and_b32 v232, v232, v233
    v_and_b32 v234, v234, v235
    v_and_b32 v232, v232, v234
    s_sub_u32 s91, s91, 1
    v_readfirstlane_b32 s3, v232
    s_cbranch_scc1 L_pq2d
    s_cmp_lg_u32 s3, 0
    s_cbranch_scc1 L_pq2d
    s_sleep 2
    s_branch L_pq2
L_pq2d:
    s_add_u32 s59, s79, s76
    buffer_load_dwordx4 v[16:19], v4, s[28:31], s59 offen offset:0 sc1
    buffer_load_dwordx4 v[8:11], v4, s[28:31], s78 offen offset:0 sc1
    buffer_load_dwordx4 v[12:15], v4, s[28:31], s78 offen offset:1024 sc1
    s_add_u32 m0, s80, 0
    s_add_u32 s59, s76, 0
    s_and_b32 s59, s59, 0x1ffff
    s_add_u32 s59, s59, s81
    s_cmp_eq_u32 s57, 0
    s_cbranch_scc1 L_skipk0c
    buffer_load_dwordx4 v4, s[28:31], s59 offen sc1 lds
L_skipk0c:
    buffer_load_dwordx4 v4, s[28:31], s59 offen offset:1024 sc1 lds
    s_add_u32 m0, s80, 8192
    s_add_u32 s59, s76, 8192
    s_and_b32 s59, s59, 0x1ffff
    s_add_u32 s59, s59, s81
    buffer_load_dwordx4 v4, s[28:31], s59 offen sc1 lds
    buffer_load_dwordx4 v4, s[28:31], s59 offen offset:1024 sc1 lds
    s_add_u32 m0, s80, 16384
    s_add_u32 s59, s76, 16384
    s_and_b32 s59, s59, 0x1ffff
    s_add_u32 s59, s59, s81
    buffer_load_dwordx4 v4, s[28:31], s59 offen sc1 lds
    buffer_load_dwordx4 v4, s[28:31], s59 offen offset:1024 sc1 lds
    s_add_u32 m0, s80, 24576
    s_add_u32 s59, s76, 24576
    s_and_b32 s59, s59, 0x1ffff
    s_add_u32 s59, s59, s81
    buffer_load_dwordx4 v4, s[28:31], s59 offen sc1 lds
    buffer_load_dwordx4 v4, s[28:31], s59 offen offset:1024 sc1 lds
    s_waitcnt vmcnt(7)
    v_mfma_f32_32x32x16_bf16 v[64:79], v[16:19], v[8:11], 0
    v_mfma_f32_32x32x16_bf16 v[80:95], v[16:19], v[12:15], 0
    s_nop 7
    s_nop 2
    v_max3_f32 v232, v64, v65, v66
    v_max3_f32 v232, v232, v67, v68
    v_max3_f32 v232, v232, v69, v70
    v_max3_f32 v232, v232, v71, v72
    v_max3_f32 v232, v232, v73, v74
    v_max3_f32 v232, v232, v75, v76
    v_max3_f32 v232, v232, v77, v78
    v_max_f32 v232, v232, v79
    v_mov_b32 v234, v232
    s_nop 1
    v_permlane32_swap_b32 v232, v234
    v_max_f32 v232, v232, v234
    v_sub_f32 v128, 0, v232
    v_sub_f32 v129, 0, v232
    v_sub_f32 v130, 0, v232
    v_sub_f32 v131, 0, v232
    v_sub_f32 v132, 0, v232
    v_sub_f32 v133, 0, v232
    v_sub_f32 v134, 0, v232
    v_sub_f32 v135, 0, v232
    v_sub_f32 v136, 0, v232
    v_sub_f32 v137, 0, v232
    v_sub_f32 v138, 0, v232
    v_sub_f32 v139, 0, v232
    v_sub_f32 v140, 0, v232
    v_sub_f32 v141, 0, v232
    v_sub_f32 v142, 0, v232
    v_sub_f32 v143, 0, v232
    s_nop 1
    v_mfma_f32_32x32x16_bf16 v[64:79], v[16:19], v[8:11], v[128:143]
    s_waitcnt vmcnt(4)
    ds_write_b32 v59, v58 offset:144
    v_max3_f32 v233, v80, v81, v82
    v_max3_f32 v233, v233, v83, v84
    v_max3_f32 v233, v233, v85, v86
    v_max3_f32 v233, v233, v87, v88
    v_max3_f32 v233, v233, v89, v90
    v_max3_f32 v233, v233, v91, v92
    v_max3_f32 v233, v233, v93, v94
    v_max_f32 v233, v233, v95
    v_mov_b32 v234, v233
    s_nop 1
    v_permlane32_swap_b32 v233, v234
    v_max_f32 v233, v233, v234
    v_sub_f32 v144, 0, v233
    v_sub_f32 v145, 0, v233
    v_sub_f32 v146, 0, v233
    v_sub_f32 v147, 0, v233
    v_sub_f32 v148, 0, v233
    v_sub_f32 v149, 0, v233
    v_sub_f32 v150, 0, v233
    v_sub_f32 v151, 0, v233
    v_sub_f32 v152, 0, v233
    v_sub_f32 v153, 0, v233
    v_sub_f32 v154, 0, v233
    v_sub_f32 v155, 0, v233
    v_sub_f32 v156, 0, v233
    v_sub_f32 v157, 0, v233
    v_sub_f32 v158, 0, v233
    v_sub_f32 v159, 0, v233
    s_nop 1
    v_mfma_f32_32x32x16_bf16 v[80:95], v[16:19], v[12:15], v[144:159]
    s_mov_b32 s91, 65536
L_kv0:
    ds_read_b128 v[232:235], v60 offset:144
    s_waitcnt lgkmcnt(0)
    v_and_b32 v232, v232, v233
    v_and_b32 v234, v234, v235
    v_and_b32 v232, v232, v234
    s_sub_u32 s91, s91, 1
    v_readfirstlane_b32 s3, v232
    s_cbranch_scc1 L_kv0d
    s_cmp_lg_u32 s3, 0
    s_cbranch_scc1 L_kv0d
    s_sleep 2
    s_branch L_kv0
L_kv0d:
    ds_read_b128 v[20:23], v1 offset:2048
    ds_read_b128 v[24:27], v1 offset:4096
    ds_read_b128 v[28:31], v1 offset:6144
    s_mov_b64 exec, s[86:87]
    ds_read_b128 v[160:163], v2 offset:0
    ds_read_b128 v[164:167], v2 offset:512
    ds_read_b128 v[168:171], v2 offset:2048
    ds_read_b128 v[172:175], v2 offset:2560
    ds_read_b128 v[176:179], v2 offset:4096
    ds_read_b128 v[180:183], v2 offset:4608
    ds_read_b128 v[184:187], v2 offset:6144
    ds_read_b128 v[188:191], v2 offset:6656
    s_mov_b64 exec, -1
    s_setprio 0
    v_exp_f32 v64, v64
    v_exp_f32 v65, v65
    v_exp_f32 v66, v66
    v_exp_f32 v67, v67
    v_exp_f32 v68, v68
    v_exp_f32 v69, v69
    v_exp_f32 v70, v70
    s_waitcnt lgkmcnt(0)
    v_mfma_f32_32x32x16_bf16 v[96:111], v[20:23], v[8:11], v[128:143]
    v_exp_f32 v71, v71
    v_exp_f32 v72, v72
    v_exp_f32 v73, v73
    v_exp_f32 v74, v74
    v_exp_f32 v75, v75
    v_exp_f32 v76, v76
    v_smfmac_f32_32x32x32_bf16 v[200:215], v[160:163], v[64:71], v3
    v_exp_f32 v77, v77
    v_exp_f32 v78, v78
    v_exp_f32 v79, v79
    v_exp_f32 v80, v80
    v_exp_f32 v81, v81
    v_exp_f32 v82, v82
    v_smfmac_f32_32x32x32_bf16 v[200:215], v[164:167], v[72:79], v3
    v_exp_f32 v83, v83
    v_exp_f32 v84, v84
    v_exp_f32 v85, v85
    v_exp_f32 v86, v86
    v_exp_f32 v87, v87
    v_exp_f32 v88, v88
    v_mfma_f32_32x32x16_bf16 v[64:79], v[20:23], v[12:15], v[144:159]
    v_exp_f32 v89, v89
    v_exp_f32 v90, v90
    v_exp_f32 v91, v91
    v_exp_f32 v92, v92
    v_exp_f32 v93, v93
    v_exp_f32 v94, v94
    v_smfmac_f32_32x32x32_bf16 v[216:231], v[160:163], v[80:87], v3
    v_exp_f32 v95, v95
    v_exp_f32 v96, v96
    v_exp_f32 v97, v97
    v_exp_f32 v98, v98
    v_exp_f32 v99, v99
    v_exp_f32 v100, v100
    v_smfmac_f32_32x32x32_bf16 v[216:231], v[164:167], v[88:95], v3
    s_waitcnt lgkmcnt(0)
    s_waitcnt vmcnt(0)
    ds_write_b32 v59, v58 offset:208
    v_exp_f32 v101, v101
    v_exp_f32 v102, v102
    v_exp_f32 v103, v103
    v_exp_f32 v104, v104
    v_exp_f32 v105, v105
    v_exp_f32 v106, v106
    v_mfma_f32_32x32x16_bf16 v[80:95], v[24:27], v[8:11], v[128:143]
    v_exp_f32 v107, v107
    v_exp_f32 v108, v108
    v_exp_f32 v109, v109
    v_exp_f32 v110, v110
    v_exp_f32 v111, v111
    v_exp_f32 v64, v64
    v_smfmac_f32_32x32x32_bf16 v[200:215], v[168:171], v[96:103], v3
    v_exp_f32 v65, v65
    v_exp_f32 v66, v66
    v_exp_f32 v67, v67
    v_exp_f32 v68, v68
    v_exp_f32 v69, v69
    v_exp_f32 v70, v70
    v_smfmac_f32_32x32x32_bf16 v[200:215], v[172:175], v[104:111], v3
    v_exp_f32 v71, v71
    v_exp_f32 v72, v72
    v_exp_f32 v73, v73
    v_exp_f32 v74, v74
    v_exp_f32 v75, v75
    v_exp_f32 v76, v76
    v_mfma_f32_32x32x16_bf16 v[96:111], v[24:27], v[12:15], v[144:159]
    v_exp_f32 v77, v77
    v_exp_f32 v78, v78
    v_exp_f32 v79, v79
    v_exp_f32 v80, v80
    v_exp_f32 v81, v81
    v_exp_f32 v82, v82
    v_smfmac_f32_32x32x32_bf16 v[216:231], v[168:171], v[64:71], v3
    v_exp_f32 v83, v83
    v_exp_f32 v84, v84
    v_exp_f32 v85, v85
    v_exp_f32 v86, v86
    v_exp_f32 v87, v87
    v_exp_f32 v88, v88
    v_smfmac_f32_32x32x32_bf16 v[216:231], v[172:175], v[72:79], v3
    ds_read_b128 v[16:19], v1 offset:8192
    ds_read_b128 v[20:23], v1 offset:10240
    s_mov_b64 exec, s[86:87]
    ds_read_b128 v[160:163], v2 offset:8192
    ds_read_b128 v[164:167], v2 offset:8704
    ds_read_b128 v[168:171], v2 offset:10240
    ds_read_b128 v[172:175], v2 offset:10752
    s_mov_b64 exec, -1
    v_exp_f32 v89, v89
    v_exp_f32 v90, v90
    v_exp_f32 v91, v91
    v_mfma_f32_32x32x16_bf16 v[64:79], v[28:31], v[8:11], v[128:143]
    v_exp_f32 v92, v92
    v_exp_f32 v93, v93
    v_exp_f32 v94, v94
    v_exp_f32 v95, v95
    v_exp_f32 v96, v96
    v_exp_f32 v97, v97
    v_smfmac_f32_32x32x32_bf16 v[200:215], v[176:179], v[80:87], v3
    v_exp_f32 v98, v98
    v_exp_f32 v99, v99
    v_exp_f32 v100, v100
    v_exp_f32 v101, v101
    v_exp_f32 v102, v102
    v_exp_f32 v103, v103
    v_smfmac_f32_32x32x32_bf16 v[200:215], v[180:183], v[88:95], v3
    v_exp_f32 v104, v104
    v_exp_f32 v105, v105
    v_exp_f32 v106, v106
    v_exp_f32 v107, v107
    v_exp_f32 v108, v108
    v_exp_f32 v109, v109
    v_mfma_f32_32x32x16_bf16 v[80:95], v[28:31], v[12:15], v[144:159]
    v_exp_f32 v110, v110
    v_exp_f32 v111, v111
    v_exp_f32 v64, v64
    v_exp_f32 v65, v65
    v_exp_f32 v66, v66
    v_exp_f32 v67, v67
    v_smfmac_f32_32x32x32_bf16 v[216:231], v[176:179], v[96:103], v3
    v_exp_f32 v68, v68
    v_exp_f32 v69, v69
    v_exp_f32 v70, v70
    v_exp_f32 v71, v71
    v_exp_f32 v72, v72
    v_exp_f32 v73, v73
    v_smfmac_f32_32x32x32_bf16 v[216:231], v[180:183], v[104:111], v3
    s_waitcnt lgkmcnt(0)
    v_exp_f32 v74, v74
    v_exp_f32 v75, v75
    v_exp_f32 v76, v76
    v_exp_f32 v77, v77
    v_exp_f32 v78, v78
    v_exp_f32 v79, v79
    v_mfma_f32_32x32x16_bf16 v[96:111], v[16:19], v[8:11], v[128:143]
    v_exp_f32 v80, v80
    v_exp_f32 v81, v81
    v_exp_f32 v82, v82
    v_exp_f32 v83, v83
    v_exp_f32 v84, v84
    v_exp_f32 v85, v85
    v_smfmac_f32_32x32x32_bf16 v[200:215], v[184:187], v[64:71], v3
    v_exp_f32 v86, v86
    v_exp_f32 v87, v87
    v_exp_f32 v88, v88
    v_exp_f32 v89, v89
    v_exp_f32 v90, v90
    v_exp_f32 v91, v91
    v_smfmac_f32_32x32x32_bf16 v[200:215], v[188:191], v[72:79], v3
    v_exp_f32 v92, v92
    v_exp_f32 v93, v93
    v_exp_f32 v94, v94
    v_exp_f32 v95, v95
    v_exp_f32 v96, v96
    v_exp_f32 v97, v97
    v_mfma_f32_32x32x16_bf16 v[64:79], v[16:19], v[12:15], v[144:159]
    v_exp_f32 v98, v98
    v_exp_f32 v99, v99
    v_exp_f32 v100, v100
    v_exp_f32 v101, v101
    v_exp_f32 v102, v102
    v_exp_f32 v103, v103
    v_smfmac_f32_32x32x32_bf16 v[216:231], v[184:187], v[80:87], v3
    v_exp_f32 v104, v104
    v_exp_f32 v105, v105
    v_exp_f32 v106, v106
    v_exp_f32 v107, v107
    v_exp_f32 v108, v108
    v_exp_f32 v109, v109
    v_smfmac_f32_32x32x32_bf16 v[216:231], v[188:191], v[88:95], v3
    ds_read_b128 v[24:27], v1 offset:12288
    ds_read_b128 v[28:31], v1 offset:14336
    s_mov_b64 exec, s[86:87]
    ds_read_b128 v[176:179], v2 offset:12288
    ds_read_b128 v[180:183], v2 offset:12800
    ds_read_b128 v[184:187], v2 offset:14336
    ds_read_b128 v[188:191], v2 offset:14848
    s_mov_b64 exec, -1
    ds_read_b128 v[232:235], v60 offset:208
    v_exp_f32 v110, v110
    v_exp_f32 v111, v111
    v_exp_f32 v64, v64
    v_mfma_f32_32x32x16_bf16 v[80:95], v[20:23], v[8:11], v[128:143]
    v_exp_f32 v65, v65
    v_exp_f32 v66, v66
    v_exp_f32 v67, v67
    v_exp_f32 v68, v68
    v_exp_f32 v69, v69
    v_exp_f32 v70, v70
    v_smfmac_f32_32x32x32_bf16 v[200:215], v[160:163], v[96:103], v3
    v_exp_f32 v71, v71
    v_exp_f32 v72, v72
    v_exp_f32 v73, v73
    v_exp_f32 v74, v74
    v_exp_f32 v75, v75
    v_exp_f32 v76, v76
    v_smfmac_f32_32x32x32_bf16 v[200:215], v[164:167], v[104:111], v3
    v_exp_f32 v77, v77
    v_exp_f32 v78, v78
    v_exp_f32 v79, v79
    v_exp_f32 v80, v80
    v_exp_f32 v81, v81
    v_exp_f32 v82, v82
    v_mfma_f32_32x32x16_bf16 v[96:111], v[20:23], v[12:15], v[144:159]
    v_exp_f32 v83, v83
    v_exp_f32 v84, v84
    v_exp_f32 v85, v85
    v_exp_f32 v86, v86
    v_exp_f32 v87, v87
    v_exp_f32 v88, v88
    v_smfmac_f32_32x32x32_bf16 v[216:231], v[160:163], v[64:71], v3
    v_exp_f32 v89, v89
    v_exp_f32 v90, v90
    v_exp_f32 v91, v91
    v_exp_f32 v92, v92
    v_exp_f32 v93, v93
    v_exp_f32 v94, v94
    v_smfmac_f32_32x32x32_bf16 v[216:231], v[164:167], v[72:79], v3
    s_waitcnt lgkmcnt(0)
    v_exp_f32 v95, v95
    v_exp_f32 v96, v96
    v_exp_f32 v97, v97
    v_mfma_f32_32x32x16_bf16 v[64:79], v[24:27], v[8:11], v[128:143]
    v_exp_f32 v98, v98
    v_exp_f32 v99, v99
    v_exp_f32 v100, v100
    v_exp_f32 v101, v101
    v_exp_f32 v102, v102
    v_exp_f32 v103, v103
    v_smfmac_f32_32x32x32_bf16 v[200:215], v[168:171], v[80:87], v3
    v_exp_f32 v104, v104
    v_exp_f32 v105, v105
    v_exp_f32 v106, v106
    v_exp_f32 v107, v107
    v_exp_f32 v108, v108
    v_exp_f32 v109, v109
    v_smfmac_f32_32x32x32_bf16 v[200:215], v[172:175], v[88:95], v3
    v_exp_f32 v110, v110
    v_exp_f32 v111, v111
    v_exp_f32 v64, v64
    v_exp_f32 v65, v65
    v_exp_f32 v66, v66
    v_exp_f32 v67, v67
    v_mfma_f32_32x32x16_bf16 v[80:95], v[24:27], v[12:15], v[144:159]
    v_exp_f32 v68, v68
    v_exp_f32 v69, v69
    v_exp_f32 v70, v70
    v_exp_f32 v71, v71
    v_exp_f32 v72, v72
    v_exp_f32 v73, v73
    v_smfmac_f32_32x32x32_bf16 v[216:231], v[168:171], v[96:103], v3
    v_exp_f32 v74, v74
    v_exp_f32 v75, v75
    v_exp_f32 v76, v76
    v_exp_f32 v77, v77
    v_exp_f32 v78, v78
    v_exp_f32 v79, v79
    v_smfmac_f32_32x32x32_bf16 v[216:231], v[172:175], v[104:111], v3
    v_min3_u32 v232, v232, v233, v234
    v_and_b32 v232, v232, v235
    v_cmp_eq_u32 vcc, 0, v232
    s_nop 0
    s_cmp_eq_u64 vcc, 0
    s_cbranch_scc1 L_kvp12d
    s_mov_b32 s91, 65536
L_kvp12:
    ds_read_b128 v[232:235], v60 offset:208
    s_waitcnt lgkmcnt(0)
    v_and_b32 v232, v232, v233
    v_and_b32 v234, v234, v235
    v_and_b32 v232, v232, v234
    s_sub_u32 s91, s91, 1
    v_readfirstlane_b32 s3, v232
    s_cbranch_scc1 L_kvp12d
    s_cmp_lg_u32 s3, 0
    s_cbranch_scc1 L_kvp12d
    s_sleep 2
    s_branch L_kvp12
L_kvp12d:
    ds_read_b128 v[16:19], v1 offset:16384
    ds_read_b128 v[20:23], v1 offset:18432
    s_mov_b64 exec, s[86:87]
    ds_read_b128 v[160:163], v2 offset:16384
    ds_read_b128 v[164:167], v2 offset:16896
    ds_read_b128 v[168:171], v2 offset:18432
    ds_read_b128 v[172:175], v2 offset:18944
    s_mov_b64 exec, -1
    v_exp_f32 v80, v80
    v_exp_f32 v81, v81
    v_exp_f32 v82, v82
    v_mfma_f32_32x32x16_bf16 v[96:111], v[28:31], v[8:11], v[128:143]
    v_exp_f32 v83, v83
    v_exp_f32 v84, v84
    v_exp_f32 v85, v85
    v_exp_f32 v86, v86
    v_exp_f32 v87, v87
    v_exp_f32 v88, v88
    v_smfmac_f32_32x32x32_bf16 v[200:215], v[176:179], v[64:71], v3
    v_exp_f32 v89, v89
    v_exp_f32 v90, v90
    v_exp_f32 v91, v91
    v_exp_f32 v92, v92
    v_exp_f32 v93, v93
    v_exp_f32 v94, v94
    v_smfmac_f32_32x32x32_bf16 v[200:215], v[180:183], v[72:79], v3
    v_exp_f32 v95, v95
    v_exp_f32 v96, v96
    v_exp_f32 v97, v97
    v_mfma_f32_32x32x16_bf16 v[64:79], v[28:31], v[12:15], v[144:159]
    v_exp_f32 v98, v98
    v_exp_f32 v99, v99
    v_exp_f32 v100, v100
    v_exp_f32 v101, v101
    v_exp_f32 v102, v102
    v_exp_f32 v103, v103
    v_smfmac_f32_32x32x32_bf16 v[216:231], v[176:179], v[80:87], v3
    v_exp_f32 v104, v104
    v_exp_f32 v105, v105
    v_exp_f32 v106, v106
    v_exp_f32 v107, v107
    v_exp_f32 v108, v108
    v_exp_f32 v109, v109
    v_smfmac_f32_32x32x32_bf16 v[216:231], v[180:183], v[88:95], v3
    s_waitcnt lgkmcnt(0)
    v_exp_f32 v110, v110
    v_exp_f32 v111, v111
    v_exp_f32 v64, v64
    v_exp_f32 v65, v65
    v_exp_f32 v66, v66
    v_exp_f32 v67, v67
    v_mfma_f32_32x32x16_bf16 v[80:95], v[16:19], v[8:11], v[128:143]
    v_exp_f32 v68, v68
    v_exp_f32 v69, v69
    v_exp_f32 v70, v70
    v_exp_f32 v71, v71
    v_exp_f32 v72, v72
    v_exp_f32 v73, v73
    v_smfmac_f32_32x32x32_bf16 v[200:215], v[184:187], v[96:103], v3
    v_exp_f32 v74, v74
    v_exp_f32 v75, v75
    v_exp_f32 v76, v76
    v_exp_f32 v77, v77
    v_exp_f32 v78, v78
    v_exp_f32 v79, v79
    v_smfmac_f32_32x32x32_bf16 v[200:215], v[188:191], v[104:111], v3
    v_exp_f32 v80, v80
    v_exp_f32 v81, v81
    v_exp_f32 v82, v82
    v_mfma_f32_32x32x16_bf16 v[96:111], v[16:19], v[12:15], v[144:159]
    v_exp_f32 v83, v83
    v_exp_f32 v84, v84
    v_exp_f32 v85, v85
    v_exp_f32 v86, v86
    v_exp_f32 v87, v87
    v_exp_f32 v88, v88
    v_smfmac_f32_32x32x32_bf16 v[216:231], v[184:187], v[64:71], v3
    v_exp_f32 v89, v89
    v_exp_f32 v90, v90
    v_exp_f32 v91, v91
    v_exp_f32 v92, v92
    v_exp_f32 v93, v93
    v_exp_f32 v94, v94
    v_smfmac_f32_32x32x32_bf16 v[216:231], v[188:191], v[72:79], v3
    ds_read_b128 v[24:27], v1 offset:20480
    ds_read_b128 v[28:31], v1 offset:22528
    s_mov_b64 exec, s[86:87]
    ds_read_b128 v[176:179], v2 offset:20480
    ds_read_b128 v[180:183], v2 offset:20992
    ds_read_b128 v[184:187], v2 offset:22528
    ds_read_b128 v[188:191], v2 offset:23040
    s_mov_b64 exec, -1
    v_exp_f32 v95, v95
    v_exp_f32 v96, v96
    v_exp_f32 v97, v97
    v_mfma_f32_32x32x16_bf16 v[64:79], v[20:23], v[8:11], v[128:143]
    v_exp_f32 v98, v98
    v_exp_f32 v99, v99
    v_exp_f32 v100, v100
    v_exp_f32 v101, v101
    v_exp_f32 v102, v102
    v_exp_f32 v103, v103
    v_smfmac_f32_32x32x32_bf16 v[200:215], v[160:163], v[80:87], v3
    v_exp_f32 v104, v104
    v_exp_f32 v105, v105
    v_exp_f32 v106, v106
    v_exp_f32 v107, v107
    v_exp_f32 v108, v108
    v_exp_f32 v109, v109
    v_smfmac_f32_32x32x32_bf16 v[200:215], v[164:167], v[88:95], v3
    v_exp_f32 v110, v110
    v_exp_f32 v111, v111
    v_exp_f32 v64, v64
    v_exp_f32 v65, v65
    v_exp_f32 v66, v66
    v_exp_f32 v67, v67
    v_mfma_f32_32x32x16_bf16 v[80:95], v[20:23], v[12:15], v[144:159]
    v_exp_f32 v68, v68
    v_exp_f32 v69, v69
    v_exp_f32 v70, v70
    v_exp_f32 v71, v71
    v_exp_f32 v72, v72
    v_exp_f32 v73, v73
    v_smfmac_f32_32x32x32_bf16 v[216:231], v[160:163], v[96:103], v3
    v_exp_f32 v74, v74
    v_exp_f32 v75, v75
    v_exp_f32 v76, v76
    v_exp_f32 v77, v77
    v_exp_f32 v78, v78
    v_exp_f32 v79, v79
    v_smfmac_f32_32x32x32_bf16 v[216:231], v[164:167], v[104:111], v3
    s_waitcnt lgkmcnt(0)
    v_exp_f32 v80, v80
    v_exp_f32 v81, v81
    v_exp_f32 v82, v82
    v_mfma_f32_32x32x16_bf16 v[96:111], v[24:27], v[8:11], v[128:143]
    v_exp_f32 v83, v83
    v_exp_f32 v84, v84
    v_exp_f32 v85, v85
    v_exp_f32 v86, v86
    v_exp_f32 v87, v87
    v_exp_f32 v88, v88
    v_smfmac_f32_32x32x32_bf16 v[200:215], v[168:171], v[64:71], v3
    v_exp_f32 v89, v89
    v_exp_f32 v90, v90
    v_exp_f32 v91, v91
    v_exp_f32 v92, v92
    v_exp_f32 v93, v93
    v_exp_f32 v94, v94
    v_smfmac_f32_32x32x32_bf16 v[200:215], v[172:175], v[72:79], v3
    v_exp_f32 v95, v95
    v_exp_f32 v96, v96
    v_exp_f32 v97, v97
    v_mfma_f32_32x32x16_bf16 v[64:79], v[24:27], v[12:15], v[144:159]
    v_exp_f32 v98, v98
    v_exp_f32 v99, v99
    v_exp_f32 v100, v100
    v_exp_f32 v101, v101
    v_exp_f32 v102, v102
    v_exp_f32 v103, v103
    v_smfmac_f32_32x32x32_bf16 v[216:231], v[168:171], v[80:87], v3
    v_exp_f32 v104, v104
    v_exp_f32 v105, v105
    v_exp_f32 v106, v106
    v_exp_f32 v107, v107
    v_exp_f32 v108, v108
    v_exp_f32 v109, v109
    v_smfmac_f32_32x32x32_bf16 v[216:231], v[172:175], v[88:95], v3
    ds_read_b128 v[16:19], v1 offset:24576
    ds_read_b128 v[20:23], v1 offset:26624
    s_mov_b64 exec, s[86:87]
    ds_read_b128 v[160:163], v2 offset:24576
    ds_read_b128 v[164:167], v2 offset:25088
    ds_read_b128 v[168:171], v2 offset:26624
    ds_read_b128 v[172:175], v2 offset:27136
    s_mov_b64 exec, -1
    v_exp_f32 v110, v110
    v_exp_f32 v111, v111
    v_exp_f32 v64, v64
    v_mfma_f32_32x32x16_bf16 v[80:95], v[28:31], v[8:11], v[128:143]
    v_exp_f32 v65, v65
    v_exp_f32 v66, v66
    v_exp_f32 v67, v67
    v_exp_f32 v68, v68
    v_exp_f32 v69, v69
    v_exp_f32 v70, v70
    v_smfmac_f32_32x32x32_bf16 v[200:215], v[176:179], v[96:103], v3
    v_exp_f32 v71, v71
    v_exp_f32 v72, v72
    v_exp_f32 v73, v73
    v_exp_f32 v74, v74
    v_exp_f32 v75, v75
    v_exp_f32 v76, v76
    v_smfmac_f32_32x32x32_bf16 v[200:215], v[180:183], v[104:111], v3
    v_exp_f32 v77, v77
    v_exp_f32 v78, v78
    v_exp_f32 v79, v79
    v_exp_f32 v80, v80
    v_exp_f32 v81, v81
    v_exp_f32 v82, v82
    v_mfma_f32_32x32x16_bf16 v[96:111], v[28:31], v[12:15], v[144:159]
    v_exp_f32 v83, v83
    v_exp_f32 v84, v84
    v_exp_f32 v85, v85
    v_exp_f32 v86, v86
    v_exp_f32 v87, v87
    v_exp_f32 v88, v88
    v_smfmac_f32_32x32x32_bf16 v[216:231], v[176:179], v[64:71], v3
    v_exp_f32 v89, v89
    v_exp_f32 v90, v90
    v_exp_f32 v91, v91
    v_exp_f32 v92, v92
    v_exp_f32 v93, v93
    v_exp_f32 v94, v94
    v_smfmac_f32_32x32x32_bf16 v[216:231], v[180:183], v[72:79], v3
    s_waitcnt lgkmcnt(0)
    v_exp_f32 v95, v95
    v_exp_f32 v96, v96
    v_exp_f32 v97, v97
    v_mfma_f32_32x32x16_bf16 v[64:79], v[16:19], v[8:11], v[128:143]
    v_exp_f32 v98, v98
    v_exp_f32 v99, v99
    v_exp_f32 v100, v100
    v_exp_f32 v101, v101
    v_exp_f32 v102, v102
    v_exp_f32 v103, v103
    v_smfmac_f32_32x32x32_bf16 v[200:215], v[184:187], v[80:87], v3
    v_exp_f32 v104, v104
    v_exp_f32 v105, v105
    v_exp_f32 v106, v106
    v_exp_f32 v107, v107
    v_exp_f32 v108, v108
    v_exp_f32 v109, v109
    v_smfmac_f32_32x32x32_bf16 v[200:215], v[188:191], v[88:95], v3
    v_exp_f32 v110, v110
    v_exp_f32 v111, v111
    v_exp_f32 v64, v64
    v_exp_f32 v65, v65
    v_exp_f32 v66, v66
    v_exp_f32 v67, v67
    v_mfma_f32_32x32x16_bf16 v[80:95], v[16:19], v[12:15], v[144:159]
    v_exp_f32 v68, v68
    v_exp_f32 v69, v69
    v_exp_f32 v70, v70
    v_exp_f32 v71, v71
    v_exp_f32 v72, v72
    v_exp_f32 v73, v73
    v_smfmac_f32_32x32x32_bf16 v[216:231], v[184:187], v[96:103], v3
    v_exp_f32 v74, v74
    v_exp_f32 v75, v75
    v_exp_f32 v76, v76
    v_exp_f32 v77, v77
    v_exp_f32 v78, v78
    v_exp_f32 v79, v79
    v_smfmac_f32_32x32x32_bf16 v[216:231], v[188:191], v[104:111], v3
    ds_read_b128 v[24:27], v1 offset:28672
    ds_read_b128 v[28:31], v1 offset:30720
    s_mov_b64 exec, s[86:87]
    ds_read_b128 v[176:179], v2 offset:28672
    ds_read_b128 v[180:183], v2 offset:29184
    ds_read_b128 v[184:187], v2 offset:30720
    ds_read_b128 v[188:191], v2 offset:31232
    s_mov_b64 exec, -1
    ds_read_b128 v[232:235], v60 offset:32
    v_exp_f32 v80, v80
    v_exp_f32 v81, v81
    v_exp_f32 v82, v82
    v_mfma_f32_32x32x16_bf16 v[96:111], v[20:23], v[8:11], v[128:143]
    v_exp_f32 v83, v83
    v_exp_f32 v84, v84
    v_exp_f32 v85, v85
    v_exp_f32 v86, v86
    v_exp_f32 v87, v87
    v_exp_f32 v88, v88
    v_smfmac_f32_32x32x32_bf16 v[200:215], v[160:163], v[64:71], v3
    v_exp_f32 v89, v89
    v_exp_f32 v90, v90
    v_exp_f32 v91, v91
    v_exp_f32 v92, v92
    v_exp_f32 v93, v93
    v_exp_f32 v94, v94
    v_smfmac_f32_32x32x32_bf16 v[200:215], v[164:167], v[72:79], v3
    v_exp_f32 v95, v95
    v_exp_f32 v96, v96
    v_exp_f32 v97, v97
    v_mfma_f32_32x32x16_bf16 v[64:79], v[20:23], v[12:15], v[144:159]
    v_exp_f32 v98, v98
    v_exp_f32 v99, v99
    v_exp_f32 v100, v100
    v_exp_f32 v101, v101
    v_exp_f32 v102, v102
    v_exp_f32 v103, v103
    v_smfmac_f32_32x32x32_bf16 v[216:231], v[160:163], v[80:87], v3
    v_exp_f32 v104, v104
    v_exp_f32 v105, v105
    v_exp_f32 v106, v106
    v_exp_f32 v107, v107
    v_exp_f32 v108, v108
    v_exp_f32 v109, v109
    v_smfmac_f32_32x32x32_bf16 v[216:231], v[164:167], v[88:95], v3
    s_waitcnt lgkmcnt(0)
    v_exp_f32 v110, v110
    v_exp_f32 v111, v111
    v_exp_f32 v64, v64
    v_exp_f32 v65, v65
    v_exp_f32 v66, v66
    v_exp_f32 v67, v67
    v_mfma_f32_32x32x16_bf16 v[80:95], v[24:27], v[8:11], v[128:143]
    v_exp_f32 v68, v68
    v_exp_f32 v69, v69
    v_exp_f32 v70, v70
    v_exp_f32 v71, v71
    v_exp_f32 v72, v72
    v_exp_f32 v73, v73
    v_smfmac_f32_32x32x32_bf16 v[200:215], v[168:171], v[96:103], v3
    v_exp_f32 v74, v74
    v_exp_f32 v75, v75
    v_exp_f32 v76, v76
    v_exp_f32 v77, v77
    v_exp_f32 v78, v78
    v_exp_f32 v79, v79
    v_smfmac_f32_32x32x32_bf16 v[200:215], v[172:175], v[104:111], v3
    v_exp_f32 v80, v80
    v_exp_f32 v81, v81
    v_exp_f32 v82, v82
    v_mfma_f32_32x32x16_bf16 v[96:111], v[24:27], v[12:15], v[144:159]
    v_exp_f32 v83, v83
    v_exp_f32 v84, v84
    v_exp_f32 v85, v85
    v_exp_f32 v86, v86
    v_exp_f32 v87, v87
    v_exp_f32 v88, v88
    v_smfmac_f32_32x32x32_bf16 v[216:231], v[168:171], v[64:71], v3
    v_exp_f32 v89, v89
    v_exp_f32 v90, v90
    v_exp_f32 v91, v91
    v_exp_f32 v92, v92
    v_exp_f32 v93, v93
    v_exp_f32 v94, v94
    v_smfmac_f32_32x32x32_bf16 v[216:231], v[172:175], v[72:79], v3
    v_min3_u32 v232, v232, v233, v234
    v_and_b32 v232, v232, v235
    v_cmp_eq_u32 vcc, 0, v232
    s_nop 0
    s_cmp_eq_u64 vcc, 0
    s_cbranch_scc1 L_kvp28d
    s_mov_b32 s91, 65536
L_kvp28:
    ds_read_b128 v[232:235], v60 offset:32
    s_waitcnt lgkmcnt(0)
    v_and_b32 v232, v232, v233
    v_and_b32 v234, v234, v235
    v_and_b32 v232, v232, v234
    s_sub_u32 s91, s91, 1
    v_readfirstlane_b32 s3, v232
    s_cbranch_scc1 L_kvp28d
    s_cmp_lg_u32 s3, 0
    s_cbranch_scc1 L_kvp28d
    s_sleep 2
    s_branch L_kvp28
L_kvp28d:
    ds_read_b128 v[16:19], v1 offset:32768
    ds_read_b128 v[20:23], v1 offset:34816
    s_mov_b64 exec, s[86:87]
    ds_read_b128 v[160:163], v2 offset:32768
    ds_read_b128 v[164:167], v2 offset:33280
    ds_read_b128 v[168:171], v2 offset:34816
    ds_read_b128 v[172:175], v2 offset:35328
    s_mov_b64 exec, -1
    v_exp_f32 v95, v95
    v_exp_f32 v96, v96
    v_exp_f32 v97, v97
    v_mfma_f32_32x32x16_bf16 v[64:79], v[28:31], v[8:11], v[128:143]
    v_exp_f32 v98, v98
    v_exp_f32 v99, v99
    v_exp_f32 v100, v100
    v_exp_f32 v101, v101
    v_exp_f32 v102, v102
    v_exp_f32 v103, v103
    v_smfmac_f32_32x32x32_bf16 v[200:215], v[176:179], v[80:87], v3
    v_exp_f32 v104, v104
    v_exp_f32 v105, v105
    v_exp_f32 v106, v106
    v_exp_f32 v107, v107
    v_exp_f32 v108, v108
    v_exp_f32 v109, v109
    v_smfmac_f32_32x32x32_bf16 v[200:215], v[180:183], v[88:95], v3
    v_exp_f32 v110, v110
    v_exp_f32 v111, v111
    v_exp_f32 v64, v64
    v_exp_f32 v65, v65
    v_exp_f32 v66, v66
    v_exp_f32 v67, v67
    v_mfma_f32_32x32x16_bf16 v[80:95], v[28:31], v[12:15], v[144:159]
    v_exp_f32 v68, v68
    v_exp_f32 v69, v69
    v_exp_f32 v70, v70
    v_exp_f32 v71, v71
    v_exp_f32 v72, v72
    v_exp_f32 v73, v73
    v_smfmac_f32_32x32x32_bf16 v[216:231], v[176:179], v[96:103], v3
    v_exp_f32 v74, v74
    v_exp_f32 v75, v75
    v_exp_f32 v76, v76
    v_exp_f32 v77, v77
    v_exp_f32 v78, v78
    v_exp_f32 v79, v79
    v_smfmac_f32_32x32x32_bf16 v[216:231], v[180:183], v[104:111], v3
    s_waitcnt lgkmcnt(0)
    v_exp_f32 v80, v80
    v_exp_f32 v81, v81
    v_exp_f32 v82, v82
    v_mfma_f32_32x32x16_bf16 v[96:111], v[16:19], v[8:11], v[128:143]
    v_exp_f32 v83, v83
    v_exp_f32 v84, v84
    v_exp_f32 v85, v85
    v_exp_f32 v86, v86
    v_exp_f32 v87, v87
    v_exp_f32 v88, v88
    v_smfmac_f32_32x32x32_bf16 v[200:215], v[184:187], v[64:71], v3
    v_exp_f32 v89, v89
    v_exp_f32 v90, v90
    v_exp_f32 v91, v91
    v_exp_f32 v92, v92
    v_exp_f32 v93, v93
    v_exp_f32 v94, v94
    v_smfmac_f32_32x32x32_bf16 v[200:215], v[188:191], v[72:79], v3
    v_exp_f32 v95, v95
    v_exp_f32 v96, v96
    v_exp_f32 v97, v97
    v_mfma_f32_32x32x16_bf16 v[64:79], v[16:19], v[12:15], v[144:159]
    v_exp_f32 v98, v98
    v_exp_f32 v99, v99
    v_exp_f32 v100, v100
    v_exp_f32 v101, v101
    v_exp_f32 v102, v102
    v_exp_f32 v103, v103
    v_smfmac_f32_32x32x32_bf16 v[216:231], v[184:187], v[80:87], v3
    v_exp_f32 v104, v104
    v_exp_f32 v105, v105
    v_exp_f32 v106, v106
    v_exp_f32 v107, v107
    v_exp_f32 v108, v108
    v_exp_f32 v109, v109
    v_smfmac_f32_32x32x32_bf16 v[216:231], v[188:191], v[88:95], v3
    ds_read_b128 v[24:27], v1 offset:36864
    ds_read_b128 v[28:31], v1 offset:38912
    s_mov_b64 exec, s[86:87]
    ds_read_b128 v[176:179], v2 offset:36864
    ds_read_b128 v[180:183], v2 offset:37376
    ds_read_b128 v[184:187], v2 offset:38912
    ds_read_b128 v[188:191], v2 offset:39424
    s_mov_b64 exec, -1
    v_exp_f32 v110, v110
    v_exp_f32 v111, v111
    v_exp_f32 v64, v64
    v_mfma_f32_32x32x16_bf16 v[80:95], v[20:23], v[8:11], v[128:143]
    v_exp_f32 v65, v65
    v_exp_f32 v66, v66
    v_exp_f32 v67, v67
    v_exp_f32 v68, v68
    v_exp_f32 v69, v69
    v_exp_f32 v70, v70
    v_smfmac_f32_32x32x32_bf16 v[200:215], v[160:163], v[96:103], v3
    v_exp_f32 v71, v71
    v_exp_f32 v72, v72
    v_exp_f32 v73, v73
    v_exp_f32 v74, v74
    v_exp_f32 v75, v75
    v_exp_f32 v76, v76
    v_smfmac_f32_32x32x32_bf16 v[200:215], v[164:167], v[104:111], v3
    v_exp_f32 v77, v77
    v_exp_f32 v78, v78
    v_exp_f32 v79, v79
    v_exp_f32 v80, v80
    v_exp_f32 v81, v81
    v_exp_f32 v82, v82
    v_mfma_f32_32x32x16_bf16 v[96:111], v[20:23], v[12:15], v[144:159]
    buffer_store_dwordx4 v[48:51], v4, s[28:31], s88 offen sc1
    v_exp_f32 v83, v83
    v_exp_f32 v84, v84
    v_exp_f32 v85, v85
    v_exp_f32 v86, v86
    v_exp_f32 v87, v87
    v_exp_f32 v88, v88
    v_smfmac_f32_32x32x32_bf16 v[216:231], v[160:163], v[64:71], v3
    v_exp_f32 v89, v89
    v_exp_f32 v90, v90
    v_exp_f32 v91, v91
    v_exp_f32 v92, v92
    v_exp_f32 v93, v93
    v_exp_f32 v94, v94
    v_smfmac_f32_32x32x32_bf16 v[216:231], v[164:167], v[72:79], v3
    s_waitcnt lgkmcnt(0)
    v_exp_f32 v95, v95
    v_exp_f32 v96, v96
    v_exp_f32 v97, v97
    v_mfma_f32_32x32x16_bf16 v[64:79], v[24:27], v[8:11], v[128:143]
    v_exp_f32 v98, v98
    v_exp_f32 v99, v99
    v_exp_f32 v100, v100
    v_exp_f32 v101, v101
    v_exp_f32 v102, v102
    v_exp_f32 v103, v103
    v_smfmac_f32_32x32x32_bf16 v[200:215], v[168:171], v[80:87], v3
    v_exp_f32 v104, v104
    v_exp_f32 v105, v105
    v_exp_f32 v106, v106
    v_exp_f32 v107, v107
    v_exp_f32 v108, v108
    v_exp_f32 v109, v109
    v_smfmac_f32_32x32x32_bf16 v[200:215], v[172:175], v[88:95], v3
    v_exp_f32 v110, v110
    v_exp_f32 v111, v111
    v_exp_f32 v64, v64
    v_exp_f32 v65, v65
    v_exp_f32 v66, v66
    v_exp_f32 v67, v67
    v_mfma_f32_32x32x16_bf16 v[80:95], v[24:27], v[12:15], v[144:159]
    v_exp_f32 v68, v68
    v_exp_f32 v69, v69
    v_exp_f32 v70, v70
    v_exp_f32 v71, v71
    v_exp_f32 v72, v72
    v_exp_f32 v73, v73
    v_smfmac_f32_32x32x32_bf16 v[216:231], v[168:171], v[96:103], v3
    v_exp_f32 v74, v74
    v_exp_f32 v75, v75
    v_exp_f32 v76, v76
    v_exp_f32 v77, v77
    v_exp_f32 v78, v78
    v_exp_f32 v79, v79
    v_smfmac_f32_32x32x32_bf16 v[216:231], v[172:175], v[104:111], v3
    ds_read_b128 v[16:19], v1 offset:40960
    ds_read_b128 v[20:23], v1 offset:43008
    s_mov_b64 exec, s[86:87]
    ds_read_b128 v[160:163], v2 offset:40960
    ds_read_b128 v[164:167], v2 offset:41472
    ds_read_b128 v[168:171], v2 offset:43008
    ds_read_b128 v[172:175], v2 offset:43520
    s_mov_b64 exec, -1
    v_exp_f32 v80, v80
    v_exp_f32 v81, v81
    v_exp_f32 v82, v82
    v_mfma_f32_32x32x16_bf16 v[96:111], v[28:31], v[8:11], v[128:143]
    v_exp_f32 v83, v83
    v_exp_f32 v84, v84
    v_exp_f32 v85, v85
    v_exp_f32 v86, v86
    v_exp_f32 v87, v87
    v_exp_f32 v88, v88
    v_smfmac_f32_32x32x32_bf16 v[200:215], v[176:179], v[64:71], v3
    v_exp_f32 v89, v89
    v_exp_f32 v90, v90
    v_exp_f32 v91, v91
    v_exp_f32 v92, v92
    v_exp_f32 v93, v93
    v_exp_f32 v94, v94
    v_smfmac_f32_32x32x32_bf16 v[200:215], v[180:183], v[72:79], v3
    v_exp_f32 v95, v95
    v_exp_f32 v96, v96
    v_exp_f32 v97, v97
    v_mfma_f32_32x32x16_bf16 v[64:79], v[28:31], v[12:15], v[144:159]
    v_exp_f32 v98, v98
    v_exp_f32 v99, v99
    v_exp_f32 v100, v100
    v_exp_f32 v101, v101
    v_exp_f32 v102, v102
    v_exp_f32 v103, v103
    v_smfmac_f32_32x32x32_bf16 v[216:231], v[176:179], v[80:87], v3
    v_exp_f32 v104, v104
    v_exp_f32 v105, v105
    v_exp_f32 v106, v106
    v_exp_f32 v107, v107
    v_exp_f32 v108, v108
    v_exp_f32 v109, v109
    v_smfmac_f32_32x32x32_bf16 v[216:231], v[180:183], v[88:95], v3
    s_waitcnt lgkmcnt(0)
    v_exp_f32 v110, v110
    v_exp_f32 v111, v111
    v_exp_f32 v64, v64
    v_exp_f32 v65, v65
    v_exp_f32 v66, v66
    v_exp_f32 v67, v67
    v_mfma_f32_32x32x16_bf16 v[80:95], v[16:19], v[8:11], v[128:143]
    v_exp_f32 v68, v68
    v_exp_f32 v69, v69
    v_exp_f32 v70, v70
    v_exp_f32 v71, v71
    v_exp_f32 v72, v72
    v_exp_f32 v73, v73
    v_smfmac_f32_32x32x32_bf16 v[200:215], v[184:187], v[96:103], v3
    v_exp_f32 v74, v74
    v_exp_f32 v75, v75
    v_exp_f32 v76, v76
    v_exp_f32 v77, v77
    v_exp_f32 v78, v78
    v_exp_f32 v79, v79
    v_smfmac_f32_32x32x32_bf16 v[200:215], v[188:191], v[104:111], v3
    v_exp_f32 v80, v80
    v_exp_f32 v81, v81
    v_exp_f32 v82, v82
    v_mfma_f32_32x32x16_bf16 v[96:111], v[16:19], v[12:15], v[144:159]
    buffer_store_dwordx4 v[52:55], v4, s[28:31], s89 offen sc1
    v_exp_f32 v83, v83
    v_exp_f32 v84, v84
    v_exp_f32 v85, v85
    v_exp_f32 v86, v86
    v_exp_f32 v87, v87
    v_exp_f32 v88, v88
    v_smfmac_f32_32x32x32_bf16 v[216:231], v[184:187], v[64:71], v3
    v_exp_f32 v89, v89
    v_exp_f32 v90, v90
    v_exp_f32 v91, v91
    v_exp_f32 v92, v92
    v_exp_f32 v93, v93
    v_exp_f32 v94, v94
    v_smfmac_f32_32x32x32_bf16 v[216:231], v[188:191], v[72:79], v3
    ds_read_b128 v[24:27], v1 offset:45056
    ds_read_b128 v[28:31], v1 offset:47104
    s_mov_b64 exec, s[86:87]
    ds_read_b128 v[176:179], v2 offset:45056
    ds_read_b128 v[180:183], v2 offset:45568
    ds_read_b128 v[184:187], v2 offset:47104
    ds_read_b128 v[188:191], v2 offset:47616
    s_mov_b64 exec, -1
    v_exp_f32 v95, v95
    v_exp_f32 v96, v96
    v_exp_f32 v97, v97
    v_mfma_f32_32x32x16_bf16 v[64:79], v[20:23], v[8:11], v[128:143]
    v_exp_f32 v98, v98
    v_exp_f32 v99, v99
    v_exp_f32 v100, v100
    v_exp_f32 v101, v101
    v_exp_f32 v102, v102
    v_exp_f32 v103, v103
    v_smfmac_f32_32x32x32_bf16 v[200:215], v[160:163], v[80:87], v3
    v_exp_f32 v104, v104
    v_exp_f32 v105, v105
    v_exp_f32 v106, v106
    v_exp_f32 v107, v107
    v_exp_f32 v108, v108
    v_exp_f32 v109, v109
    v_smfmac_f32_32x32x32_bf16 v[200:215], v[164:167], v[88:95], v3
    v_exp_f32 v110, v110
    v_exp_f32 v111, v111
    v_exp_f32 v64, v64
    v_exp_f32 v65, v65
    v_exp_f32 v66, v66
    v_exp_f32 v67, v67
    v_mfma_f32_32x32x16_bf16 v[80:95], v[20:23], v[12:15], v[144:159]
    v_exp_f32 v68, v68
    v_exp_f32 v69, v69
    v_exp_f32 v70, v70
    v_exp_f32 v71, v71
    v_exp_f32 v72, v72
    v_exp_f32 v73, v73
    v_smfmac_f32_32x32x32_bf16 v[216:231], v[160:163], v[96:103], v3
    v_exp_f32 v74, v74
    v_exp_f32 v75, v75
    v_exp_f32 v76, v76
    v_exp_f32 v77, v77
    v_exp_f32 v78, v78
    v_exp_f32 v79, v79
    v_smfmac_f32_32x32x32_bf16 v[216:231], v[164:167], v[104:111], v3
    s_waitcnt lgkmcnt(0)
    v_exp_f32 v80, v80
    v_exp_f32 v81, v81
    v_exp_f32 v82, v82
    v_mfma_f32_32x32x16_bf16 v[96:111], v[24:27], v[8:11], v[128:143]
    v_exp_f32 v83, v83
    v_exp_f32 v84, v84
    v_exp_f32 v85, v85
    v_exp_f32 v86, v86
    v_exp_f32 v87, v87
    v_exp_f32 v88, v88
    v_smfmac_f32_32x32x32_bf16 v[200:215], v[168:171], v[64:71], v3
    v_exp_f32 v89, v89
    v_exp_f32 v90, v90
    v_exp_f32 v91, v91
    v_exp_f32 v92, v92
    v_exp_f32 v93, v93
    v_exp_f32 v94, v94
    v_smfmac_f32_32x32x32_bf16 v[200:215], v[172:175], v[72:79], v3
    v_exp_f32 v95, v95
    v_exp_f32 v96, v96
    v_exp_f32 v97, v97
    v_mfma_f32_32x32x16_bf16 v[64:79], v[24:27], v[12:15], v[144:159]
    v_exp_f32 v98, v98
    v_exp_f32 v99, v99
    v_exp_f32 v100, v100
    v_exp_f32 v101, v101
    v_exp_f32 v102, v102
    v_exp_f32 v103, v103
    v_smfmac_f32_32x32x32_bf16 v[216:231], v[168:171], v[80:87], v3
    v_exp_f32 v104, v104
    v_exp_f32 v105, v105
    v_exp_f32 v106, v106
    v_exp_f32 v107, v107
    v_exp_f32 v108, v108
    v_exp_f32 v109, v109
    v_smfmac_f32_32x32x32_bf16 v[216:231], v[172:175], v[88:95], v3
    ds_read_b128 v[16:19], v1 offset:49152
    ds_read_b128 v[20:23], v1 offset:51200
    s_mov_b64 exec, s[86:87]
    ds_read_b128 v[160:163], v2 offset:49152
    ds_read_b128 v[164:167], v2 offset:49664
    ds_read_b128 v[168:171], v2 offset:51200
    ds_read_b128 v[172:175], v2 offset:51712
    s_mov_b64 exec, -1
    v_exp_f32 v110, v110
    v_exp_f32 v111, v111
    v_exp_f32 v64, v64
    v_mfma_f32_32x32x16_bf16 v[80:95], v[28:31], v[8:11], v[128:143]
    v_exp_f32 v65, v65
    v_exp_f32 v66, v66
    v_exp_f32 v67, v67
    v_exp_f32 v68, v68
    v_exp_f32 v69, v69
    v_exp_f32 v70, v70
    v_smfmac_f32_32x32x32_bf16 v[200:215], v[176:179], v[96:103], v3
    v_exp_f32 v71, v71
    v_exp_f32 v72, v72
    v_exp_f32 v73, v73
    v_exp_f32 v74, v74
    v_exp_f32 v75, v75
    v_exp_f32 v76, v76
    v_smfmac_f32_32x32x32_bf16 v[200:215], v[180:183], v[104:111], v3
    v_exp_f32 v77, v77
    v_exp_f32 v78, v78
    v_exp_f32 v79, v79
    v_exp_f32 v80, v80
    v_exp_f32 v81, v81
    v_exp_f32 v82, v82
    v_mfma_f32_32x32x16_bf16 v[96:111], v[28:31], v[12:15], v[144:159]
    v_exp_f32 v83, v83
    v_exp_f32 v84, v84
    v_exp_f32 v85, v85
    v_exp_f32 v86, v86
    v_exp_f32 v87, v87
    v_exp_f32 v88, v88
    v_smfmac_f32_32x32x32_bf16 v[216:231], v[176:179], v[64:71], v3
    v_exp_f32 v89, v89
    v_exp_f32 v90, v90
    v_exp_f32 v91, v91
    v_exp_f32 v92, v92
    v_exp_f32 v93, v93
    v_exp_f32 v94, v94
    v_smfmac_f32_32x32x32_bf16 v[216:231], v[180:183], v[72:79], v3
    s_waitcnt lgkmcnt(0)
    v_exp_f32 v95, v95
    v_exp_f32 v96, v96
    v_exp_f32 v97, v97
    v_mfma_f32_32x32x16_bf16 v[64:79], v[16:19], v[8:11], v[128:143]
    v_exp_f32 v98, v98
    v_exp_f32 v99, v99
    v_exp_f32 v100, v100
    v_exp_f32 v101, v101
    v_exp_f32 v102, v102
    v_exp_f32 v103, v103
    v_smfmac_f32_32x32x32_bf16 v[200:215], v[184:187], v[80:87], v3
    v_exp_f32 v104, v104
    v_exp_f32 v105, v105
    v_exp_f32 v106, v106
    v_exp_f32 v107, v107
    v_exp_f32 v108, v108
    v_exp_f32 v109, v109
    v_smfmac_f32_32x32x32_bf16 v[200:215], v[188:191], v[88:95], v3
    v_exp_f32 v110, v110
    v_exp_f32 v111, v111
    v_exp_f32 v64, v64
    v_exp_f32 v65, v65
    v_exp_f32 v66, v66
    v_exp_f32 v67, v67
    v_mfma_f32_32x32x16_bf16 v[80:95], v[16:19], v[12:15], v[144:159]
    v_exp_f32 v68, v68
    v_exp_f32 v69, v69
    v_exp_f32 v70, v70
    v_exp_f32 v71, v71
    v_exp_f32 v72, v72
    v_exp_f32 v73, v73
    v_smfmac_f32_32x32x32_bf16 v[216:231], v[184:187], v[96:103], v3
    v_exp_f32 v74, v74
    v_exp_f32 v75, v75
    v_exp_f32 v76, v76
    v_exp_f32 v77, v77
    v_exp_f32 v78, v78
    v_exp_f32 v79, v79
    v_smfmac_f32_32x32x32_bf16 v[216:231], v[188:191], v[104:111], v3
    ds_read_b128 v[24:27], v1 offset:53248
    ds_read_b128 v[28:31], v1 offset:55296
    s_mov_b64 exec, s[86:87]
    ds_read_b128 v[176:179], v2 offset:53248
    ds_read_b128 v[180:183], v2 offset:53760
    ds_read_b128 v[184:187], v2 offset:55296
    ds_read_b128 v[188:191], v2 offset:55808
    s_mov_b64 exec, -1
    v_exp_f32 v80, v80
    v_exp_f32 v81, v81
    v_exp_f32 v82, v82
    v_mfma_f32_32x32x16_bf16 v[96:111], v[20:23], v[8:11], v[128:143]
    v_exp_f32 v83, v83
    v_exp_f32 v84, v84
    v_exp_f32 v85, v85
    v_exp_f32 v86, v86
    v_exp_f32 v87, v87
    v_exp_f32 v88, v88
    v_smfmac_f32_32x32x32_bf16 v[200:215], v[160:163], v[64:71], v3
    v_exp_f32 v89, v89
    v_exp_f32 v90, v90
    v_exp_f32 v91, v91
    v_exp_f32 v92, v92
    v_exp_f32 v93, v93
    v_exp_f32 v94, v94
    v_smfmac_f32_32x32x32_bf16 v[200:215], v[164:167], v[72:79], v3
    v_exp_f32 v95, v95
    v_exp_f32 v96, v96
    v_exp_f32 v97, v97
    v_mfma_f32_32x32x16_bf16 v[64:79], v[20:23], v[12:15], v[144:159]
    s_waitcnt vmcnt(0)
    s_mul_i32 s93, s93, 256
    s_add_u32 s93, s93, 23592960
    s_mov_b64 exec, 1
    buffer_atomic_add v58, v60, s[28:31], s93 offen sc1
    s_mov_b64 exec, -1
    v_exp_f32 v98, v98
    v_exp_f32 v99, v99
    v_exp_f32 v100, v100
    v_exp_f32 v101, v101
    v_exp_f32 v102, v102
    v_exp_f32 v103, v103
    v_smfmac_f32_32x32x32_bf16 v[216:231], v[160:163], v[80:87], v3
    v_exp_f32 v104, v104
    v_exp_f32 v105, v105
    v_exp_f32 v106, v106
    v_exp_f32 v107, v107
    v_exp_f32 v108, v108
    v_exp_f32 v109, v109
    v_smfmac_f32_32x32x32_bf16 v[216:231], v[164:167], v[88:95], v3
    s_waitcnt lgkmcnt(0)
    v_exp_f32 v110, v110
    v_exp_f32 v111, v111
    v_exp_f32 v64, v64
    v_exp_f32 v65, v65
    v_exp_f32 v66, v66
    v_exp_f32 v67, v67
    v_mfma_f32_32x32x16_bf16 v[80:95], v[24:27], v[8:11], v[128:143]
    v_exp_f32 v68, v68
    v_exp_f32 v69, v69
    v_exp_f32 v70, v70
    v_exp_f32 v71, v71
    v_exp_f32 v72, v72
    v_exp_f32 v73, v73
    v_smfmac_f32_32x32x32_bf16 v[200:215], v[168:171], v[96:103], v3
    v_exp_f32 v74, v74
    v_exp_f32 v75, v75
    v_exp_f32 v76, v76
    v_exp_f32 v77, v77
    v_exp_f32 v78, v78
    v_exp_f32 v79, v79
    v_smfmac_f32_32x32x32_bf16 v[200:215], v[172:175], v[104:111], v3
    v_exp_f32 v80, v80
    v_exp_f32 v81, v81
    v_exp_f32 v82, v82
    v_mfma_f32_32x32x16_bf16 v[96:111], v[24:27], v[12:15], v[144:159]
    v_exp_f32 v83, v83
    v_exp_f32 v84, v84
    v_exp_f32 v85, v85
    v_exp_f32 v86, v86
    v_exp_f32 v87, v87
    v_exp_f32 v88, v88
    v_smfmac_f32_32x32x32_bf16 v[216:231], v[168:171], v[64:71], v3
    v_exp_f32 v89, v89
    v_exp_f32 v90, v90
    v_exp_f32 v91, v91
    v_exp_f32 v92, v92
    v_exp_f32 v93, v93
    v_exp_f32 v94, v94
    v_smfmac_f32_32x32x32_bf16 v[216:231], v[172:175], v[72:79], v3
    ds_read_b128 v[16:19], v1 offset:57344
    ds_read_b128 v[20:23], v1 offset:59392
    s_mov_b64 exec, s[86:87]
    ds_read_b128 v[160:163], v2 offset:57344
    ds_read_b128 v[164:167], v2 offset:57856
    ds_read_b128 v[168:171], v2 offset:59392
    ds_read_b128 v[172:175], v2 offset:59904
    s_mov_b64 exec, -1
    v_exp_f32 v95, v95
    v_exp_f32 v96, v96
    v_exp_f32 v97, v97
    v_mfma_f32_32x32x16_bf16 v[64:79], v[28:31], v[8:11], v[128:143]
    v_exp_f32 v98, v98
    v_exp_f32 v99, v99
    v_exp_f32 v100, v100
    v_exp_f32 v101, v101
    v_exp_f32 v102, v102
    v_exp_f32 v103, v103
    v_smfmac_f32_32x32x32_bf16 v[200:215], v[176:179], v[80:87], v3
    v_exp_f32 v104, v104
    v_exp_f32 v105, v105
    v_exp_f32 v106, v106
    v_exp_f32 v107, v107
    v_exp_f32 v108, v108
    v_exp_f32 v109, v109
    v_smfmac_f32_32x32x32_bf16 v[200:215], v[180:183], v[88:95], v3
    v_exp_f32 v110, v110
    v_exp_f32 v111, v111
    v_exp_f32 v64, v64
    v_exp_f32 v65, v65
    v_exp_f32 v66, v66
    v_exp_f32 v67, v67
    v_mfma_f32_32x32x16_bf16 v[80:95], v[28:31], v[12:15], v[144:159]
    v_exp_f32 v68, v68
    v_exp_f32 v69, v69
    v_exp_f32 v70, v70
    v_exp_f32 v71, v71
    v_exp_f32 v72, v72
    v_exp_f32 v73, v73
    v_smfmac_f32_32x32x32_bf16 v[216:231], v[176:179], v[96:103], v3
    v_exp_f32 v74, v74
    v_exp_f32 v75, v75
    v_exp_f32 v76, v76
    v_exp_f32 v77, v77
    v_exp_f32 v78, v78
    v_exp_f32 v79, v79
    v_smfmac_f32_32x32x32_bf16 v[216:231], v[180:183], v[104:111], v3
    s_waitcnt lgkmcnt(0)
    v_exp_f32 v80, v80
    v_exp_f32 v81, v81
    v_exp_f32 v82, v82
    v_mfma_f32_32x32x16_bf16 v[96:111], v[16:19], v[8:11], v[128:143]
    v_exp_f32 v83, v83
    v_exp_f32 v84, v84
    v_exp_f32 v85, v85
    v_exp_f32 v86, v86
    v_exp_f32 v87, v87
    v_exp_f32 v88, v88
    v_smfmac_f32_32x32x32_bf16 v[200:215], v[184:187], v[64:71], v3
    v_exp_f32 v89, v89
    v_exp_f32 v90, v90
    v_exp_f32 v91, v91
    v_exp_f32 v92, v92
    v_exp_f32 v93, v93
    v_exp_f32 v94, v94
    v_smfmac_f32_32x32x32_bf16 v[200:215], v[188:191], v[72:79], v3
    v_exp_f32 v95, v95
    v_exp_f32 v96, v96
    v_exp_f32 v97, v97
    v_mfma_f32_32x32x16_bf16 v[64:79], v[16:19], v[12:15], v[144:159]
    v_exp_f32 v98, v98
    v_exp_f32 v99, v99
    v_exp_f32 v100, v100
    v_exp_f32 v101, v101
    v_exp_f32 v102, v102
    v_exp_f32 v103, v103
    v_smfmac_f32_32x32x32_bf16 v[216:231], v[184:187], v[80:87], v3
    v_exp_f32 v104, v104
    v_exp_f32 v105, v105
    v_exp_f32 v106, v106
    v_exp_f32 v107, v107
    v_exp_f32 v108, v108
    v_exp_f32 v109, v109
    v_smfmac_f32_32x32x32_bf16 v[216:231], v[188:191], v[88:95], v3
    ds_read_b128 v[24:27], v1 offset:61440
    ds_read_b128 v[28:31], v1 offset:63488
    s_mov_b64 exec, s[86:87]
    ds_read_b128 v[176:179], v2 offset:61440
    ds_read_b128 v[180:183], v2 offset:61952
    ds_read_b128 v[184:187], v2 offset:63488
    ds_read_b128 v[188:191], v2 offset:64000
    s_mov_b64 exec, -1
    ds_read_b128 v[232:235], v60 offset:48
    v_exp_f32 v110, v110
    v_exp_f32 v111, v111
    v_exp_f32 v64, v64
    v_mfma_f32_32x32x16_bf16 v[80:95], v[20:23], v[8:11], v[128:143]
    v_exp_f32 v65, v65
    v_exp_f32 v66, v66
    v_exp_f32 v67, v67
    v_exp_f32 v68, v68
    v_exp_f32 v69, v69
    v_exp_f32 v70, v70
    v_smfmac_f32_32x32x32_bf16 v[200:215], v[160:163], v[96:103], v3
    v_exp_f32 v71, v71
    v_exp_f32 v72, v72
    v_exp_f32 v73, v73
    v_exp_f32 v74, v74
    v_exp_f32 v75, v75
    v_exp_f32 v76, v76
    v_smfmac_f32_32x32x32_bf16 v[200:215], v[164:167], v[104:111], v3
    v_exp_f32 v77, v77
    v_exp_f32 v78, v78
    v_exp_f32 v79, v79
    v_exp_f32 v80, v80
    v_exp_f32 v81, v81
    v_exp_f32 v82, v82
    v_mfma_f32_32x32x16_bf16 v[96:111], v[20:23], v[12:15], v[144:159]
    v_exp_f32 v83, v83
    v_exp_f32 v84, v84
    v_exp_f32 v85, v85
    v_exp_f32 v86, v86
    v_exp_f32 v87, v87
    v_exp_f32 v88, v88
    v_smfmac_f32_32x32x32_bf16 v[216:231], v[160:163], v[64:71], v3
    v_exp_f32 v89, v89
    v_exp_f32 v90, v90
    v_exp_f32 v91, v91
    v_exp_f32 v92, v92
    v_exp_f32 v93, v93
    v_exp_f32 v94, v94
    v_smfmac_f32_32x32x32_bf16 v[216:231], v[164:167], v[72:79], v3
    s_waitcnt lgkmcnt(0)
    v_exp_f32 v95, v95
    v_exp_f32 v96, v96
    v_exp_f32 v97, v97
    v_mfma_f32_32x32x16_bf16 v[64:79], v[24:27], v[8:11], v[128:143]
    v_exp_f32 v98, v98
    v_exp_f32 v99, v99
    v_exp_f32 v100, v100
    v_exp_f32 v101, v101
    v_exp_f32 v102, v102
    v_exp_f32 v103, v103
    v_smfmac_f32_32x32x32_bf16 v[200:215], v[168:171], v[80:87], v3
    v_exp_f32 v104, v104
    v_exp_f32 v105, v105
    v_exp_f32 v106, v106
    v_exp_f32 v107, v107
    v_exp_f32 v108, v108
    v_exp_f32 v109, v109
    v_smfmac_f32_32x32x32_bf16 v[200:215], v[172:175], v[88:95], v3
    v_exp_f32 v110, v110
    v_exp_f32 v111, v111
    v_exp_f32 v64, v64
    v_exp_f32 v65, v65
    v_exp_f32 v66, v66
    v_exp_f32 v67, v67
    v_mfma_f32_32x32x16_bf16 v[80:95], v[24:27], v[12:15], v[144:159]
    v_exp_f32 v68, v68
    v_exp_f32 v69, v69
    v_exp_f32 v70, v70
    v_exp_f32 v71, v71
    v_exp_f32 v72, v72
    v_exp_f32 v73, v73
    v_smfmac_f32_32x32x32_bf16 v[216:231], v[168:171], v[96:103], v3
    v_exp_f32 v74, v74
    v_exp_f32 v75, v75
    v_exp_f32 v76, v76
    v_exp_f32 v77, v77
    v_exp_f32 v78, v78
    v_exp_f32 v79, v79
    v_smfmac_f32_32x32x32_bf16 v[216:231], v[172:175], v[104:111], v3
    v_min3_u32 v232, v232, v233, v234
    v_and_b32 v232, v232, v235
    v_cmp_eq_u32 vcc, 0, v232
    s_nop 0
    s_cmp_eq_u64 vcc, 0
    s_cbranch_scc1 L_kvp60d
    s_mov_b32 s91, 65536
L_kvp60:
    ds_read_b128 v[232:235], v60 offset:48
    s_waitcnt lgkmcnt(0)
    v_and_b32 v232, v232, v233
    v_and_b32 v234, v234, v235
    v_and_b32 v232, v232, v234
    s_sub_u32 s91, s91, 1
    v_readfirstlane_b32 s3, v232
    s_cbranch_scc1 L_kvp60d
    s_cmp_lg_u32 s3, 0
    s_cbranch_scc1 L_kvp60d
    s_sleep 2
    s_branch L_kvp60
L_kvp60d:
    ds_read_b128 v[16:19], v56 offset:0
    ds_read_b128 v[20:23], v56 offset:2048
    s_mov_b64 exec, s[86:87]
    ds_read_b128 v[160:163], v57 offset:0
    ds_read_b128 v[164:167], v57 offset:512
    ds_read_b128 v[168:171], v57 offset:2048
    ds_read_b128 v[172:175], v57 offset:2560
    s_mov_b64 exec, -1
    v_exp_f32 v80, v80
    v_exp_f32 v81, v81
    v_exp_f32 v82, v82
    v_mfma_f32_32x32x16_bf16 v[96:111], v[28:31], v[8:11], v[128:143]
    v_exp_f32 v83, v83
    v_exp_f32 v84, v84
    v_exp_f32 v85, v85
    v_exp_f32 v86, v86
    v_exp_f32 v87, v87
    v_exp_f32 v88, v88
    v_smfmac_f32_32x32x32_bf16 v[200:215], v[176:179], v[64:71], v3
    v_exp_f32 v89, v89
    v_exp_f32 v90, v90
    v_exp_f32 v91, v91
    v_exp_f32 v92, v92
    v_exp_f32 v93, v93
    v_exp_f32 v94, v94
    v_smfmac_f32_32x32x32_bf16 v[200:215], v[180:183], v[72:79], v3
    v_exp_f32 v95, v95
    v_exp_f32 v96, v96
    v_exp_f32 v97, v97
    v_mfma_f32_32x32x16_bf16 v[64:79], v[28:31], v[12:15], v[144:159]
    v_exp_f32 v98, v98
    v_exp_f32 v99, v99
    v_exp_f32 v100, v100
    v_exp_f32 v101, v101
    v_exp_f32 v102, v102
    v_exp_f32 v103, v103
    v_smfmac_f32_32x32x32_bf16 v[216:231], v[176:179], v[80:87], v3
    v_exp_f32 v104, v104
    v_exp_f32 v105, v105
    v_exp_f32 v106, v106
    v_exp_f32 v107, v107
    v_exp_f32 v108, v108
    v_exp_f32 v109, v109
    v_smfmac_f32_32x32x32_bf16 v[216:231], v[180:183], v[88:95], v3
    s_waitcnt lgkmcnt(0)
    v_exp_f32 v110, v110
    v_exp_f32 v111, v111
    v_exp_f32 v64, v64
    v_exp_f32 v65, v65
    v_exp_f32 v66, v66
    v_exp_f32 v67, v67
    v_mfma_f32_32x32x16_bf16 v[80:95], v[16:19], v[8:11], v[128:143]
    v_exp_f32 v68, v68
    v_exp_f32 v69, v69
    v_exp_f32 v70, v70
    v_exp_f32 v71, v71
    v_exp_f32 v72, v72
    v_exp_f32 v73, v73
    v_smfmac_f32_32x32x32_bf16 v[200:215], v[184:187], v[96:103], v3
    v_exp_f32 v74, v74
    v_exp_f32 v75, v75
    v_exp_f32 v76, v76
    v_exp_f32 v77, v77
    v_exp_f32 v78, v78
    v_exp_f32 v79, v79
    v_smfmac_f32_32x32x32_bf16 v[200:215], v[188:191], v[104:111], v3
    v_exp_f32 v80, v80
    v_exp_f32 v81, v81
    v_exp_f32 v82, v82
    v_mfma_f32_32x32x16_bf16 v[96:111], v[16:19], v[12:15], v[144:159]
    v_exp_f32 v83, v83
    v_exp_f32 v84, v84
    v_exp_f32 v85, v85
    v_exp_f32 v86, v86
    v_exp_f32 v87, v87
    v_exp_f32 v88, v88
    v_smfmac_f32_32x32x32_bf16 v[216:231], v[184:187], v[64:71], v3
    v_exp_f32 v89, v89
    v_exp_f32 v90, v90
    v_exp_f32 v91, v91
    v_exp_f32 v92, v92
    v_exp_f32 v93, v93
    v_exp_f32 v94, v94
    v_smfmac_f32_32x32x32_bf16 v[216:231], v[188:191], v[72:79], v3
    ds_read_b128 v[24:27], v56 offset:4096
    ds_read_b128 v[28:31], v56 offset:6144
    s_mov_b64 exec, s[86:87]
    ds_read_b128 v[176:179], v57 offset:4096
    ds_read_b128 v[180:183], v57 offset:4608
    ds_read_b128 v[184:187], v57 offset:6144
    ds_read_b128 v[188:191], v57 offset:6656
    s_mov_b64 exec, -1
    v_exp_f32 v95, v95
    v_exp_f32 v96, v96
    v_exp_f32 v97, v97
    v_mfma_f32_32x32x16_bf16 v[64:79], v[20:23], v[8:11], v[128:143]
    v_exp_f32 v98, v98
    v_exp_f32 v99, v99
    v_exp_f32 v100, v100
    v_exp_f32 v101, v101
    v_exp_f32 v102, v102
    v_exp_f32 v103, v103
    v_smfmac_f32_32x32x32_bf16 v[200:215], v[160:163], v[80:87], v3
    v_exp_f32 v104, v104
    v_exp_f32 v105, v105
    v_exp_f32 v106, v106
    v_exp_f32 v107, v107
    v_exp_f32 v108, v108
    v_exp_f32 v109, v109
    v_smfmac_f32_32x32x32_bf16 v[200:215], v[164:167], v[88:95], v3
    v_exp_f32 v110, v110
    v_exp_f32 v111, v111
    v_exp_f32 v64, v64
    v_exp_f32 v65, v65
    v_exp_f32 v66, v66
    v_exp_f32 v67, v67
    v_mfma_f32_32x32x16_bf16 v[80:95], v[20:23], v[12:15], v[144:159]
    v_exp_f32 v68, v68
    v_exp_f32 v69, v69
    v_exp_f32 v70, v70
    v_exp_f32 v71, v71
    v_exp_f32 v72, v72
    v_exp_f32 v73, v73
    v_smfmac_f32_32x32x32_bf16 v[216:231], v[160:163], v[96:103], v3
    v_exp_f32 v74, v74
    v_exp_f32 v75, v75
    v_exp_f32 v76, v76
    v_exp_f32 v77, v77
    v_exp_f32 v78, v78
    v_exp_f32 v79, v79
    v_smfmac_f32_32x32x32_bf16 v[216:231], v[164:167], v[104:111], v3
    s_waitcnt lgkmcnt(0)
    v_exp_f32 v80, v80
    v_exp_f32 v81, v81
    v_exp_f32 v82, v82
    v_mfma_f32_32x32x16_bf16 v[96:111], v[24:27], v[8:11], v[128:143]
    v_exp_f32 v83, v83
    v_exp_f32 v84, v84
    v_exp_f32 v85, v85
    v_exp_f32 v86, v86
    v_exp_f32 v87, v87
    v_exp_f32 v88, v88
    v_smfmac_f32_32x32x32_bf16 v[200:215], v[168:171], v[64:71], v3
    v_exp_f32 v89, v89
    v_exp_f32 v90, v90
    v_exp_f32 v91, v91
    v_exp_f32 v92, v92
    v_exp_f32 v93, v93
    v_exp_f32 v94, v94
    v_smfmac_f32_32x32x32_bf16 v[200:215], v[172:175], v[72:79], v3
    v_exp_f32 v95, v95
    v_exp_f32 v96, v96
    v_exp_f32 v97, v97
    v_mfma_f32_32x32x16_bf16 v[64:79], v[24:27], v[12:15], v[144:159]
    v_exp_f32 v98, v98
    v_exp_f32 v99, v99
    v_exp_f32 v100, v100
    v_exp_f32 v101, v101
    v_exp_f32 v102, v102
    v_exp_f32 v103, v103
    v_smfmac_f32_32x32x32_bf16 v[216:231], v[168:171], v[80:87], v3
    v_exp_f32 v104, v104
    v_exp_f32 v105, v105
    v_exp_f32 v106, v106
    v_exp_f32 v107, v107
    v_exp_f32 v108, v108
    v_exp_f32 v109, v109
    v_smfmac_f32_32x32x32_bf16 v[216:231], v[172:175], v[88:95], v3
    ds_read_b128 v[16:19], v56 offset:8192
    ds_read_b128 v[20:23], v56 offset:10240
    s_mov_b64 exec, s[86:87]
    ds_read_b128 v[160:163], v57 offset:8192
    ds_read_b128 v[164:167], v57 offset:8704
    ds_read_b128 v[168:171], v57 offset:10240
    ds_read_b128 v[172:175], v57 offset:10752
    s_mov_b64 exec, -1
    v_exp_f32 v110, v110
    v_exp_f32 v111, v111
    v_exp_f32 v64, v64
    v_mfma_f32_32x32x16_bf16 v[80:95], v[28:31], v[8:11], v[128:143]
    v_exp_f32 v65, v65
    v_exp_f32 v66, v66
    v_exp_f32 v67, v67
    v_exp_f32 v68, v68
    v_exp_f32 v69, v69
    v_exp_f32 v70, v70
    v_smfmac_f32_32x32x32_bf16 v[200:215], v[176:179], v[96:103], v3
    v_exp_f32 v71, v71
    v_exp_f32 v72, v72
    v_exp_f32 v73, v73
    v_exp_f32 v74, v74
    v_exp_f32 v75, v75
    v_exp_f32 v76, v76
    v_smfmac_f32_32x32x32_bf16 v[200:215], v[180:183], v[104:111], v3
    v_exp_f32 v77, v77
    v_exp_f32 v78, v78
    v_exp_f32 v79, v79
    v_exp_f32 v80, v80
    v_exp_f32 v81, v81
    v_exp_f32 v82, v82
    v_mfma_f32_32x32x16_bf16 v[96:111], v[28:31], v[12:15], v[144:159]
    v_exp_f32 v83, v83
    v_exp_f32 v84, v84
    v_exp_f32 v85, v85
    v_exp_f32 v86, v86
    v_exp_f32 v87, v87
    v_exp_f32 v88, v88
    v_smfmac_f32_32x32x32_bf16 v[216:231], v[176:179], v[64:71], v3
    v_exp_f32 v89, v89
    v_exp_f32 v90, v90
    v_exp_f32 v91, v91
    v_exp_f32 v92, v92
    v_exp_f32 v93, v93
    v_exp_f32 v94, v94
    v_smfmac_f32_32x32x32_bf16 v[216:231], v[180:183], v[72:79], v3
    s_waitcnt lgkmcnt(0)
    v_exp_f32 v95, v95
    v_exp_f32 v96, v96
    v_exp_f32 v97, v97
    v_mfma_f32_32x32x16_bf16 v[64:79], v[16:19], v[8:11], v[128:143]
    v_exp_f32 v98, v98
    v_exp_f32 v99, v99
    v_exp_f32 v100, v100
    v_exp_f32 v101, v101
    v_exp_f32 v102, v102
    v_exp_f32 v103, v103
    v_smfmac_f32_32x32x32_bf16 v[200:215], v[184:187], v[80:87], v3
    v_exp_f32 v104, v104
    v_exp_f32 v105, v105
    v_exp_f32 v106, v106
    v_exp_f32 v107, v107
    v_exp_f32 v108, v108
    v_exp_f32 v109, v109
    v_smfmac_f32_32x32x32_bf16 v[200:215], v[188:191], v[88:95], v3
    v_exp_f32 v110, v110
    v_exp_f32 v111, v111
    v_exp_f32 v64, v64
    v_exp_f32 v65, v65
    v_exp_f32 v66, v66
    v_exp_f32 v67, v67
    v_mfma_f32_32x32x16_bf16 v[80:95], v[16:19], v[12:15], v[144:159]
    v_exp_f32 v68, v68
    v_exp_f32 v69, v69
    v_exp_f32 v70, v70
    v_exp_f32 v71, v71
    v_exp_f32 v72, v72
    v_exp_f32 v73, v73
    v_smfmac_f32_32x32x32_bf16 v[216:231], v[184:187], v[96:103], v3
    v_exp_f32 v74, v74
    v_exp_f32 v75, v75
    v_exp_f32 v76, v76
    v_exp_f32 v77, v77
    v_exp_f32 v78, v78
    v_exp_f32 v79, v79
    v_smfmac_f32_32x32x32_bf16 v[216:231], v[188:191], v[104:111], v3
    ds_read_b128 v[24:27], v56 offset:12288
    ds_read_b128 v[28:31], v56 offset:14336
    s_mov_b64 exec, s[86:87]
    ds_read_b128 v[176:179], v57 offset:12288
    ds_read_b128 v[180:183], v57 offset:12800
    ds_read_b128 v[184:187], v57 offset:14336
    ds_read_b128 v[188:191], v57 offset:14848
    s_mov_b64 exec, -1
    v_exp_f32 v80, v80
    v_exp_f32 v81, v81
    v_exp_f32 v82, v82
    v_mfma_f32_32x32x16_bf16 v[96:111], v[20:23], v[8:11], v[128:143]
    v_exp_f32 v83, v83
    v_exp_f32 v84, v84
    v_exp_f32 v85, v85
    v_exp_f32 v86, v86
    v_exp_f32 v87, v87
    v_exp_f32 v88, v88
    v_smfmac_f32_32x32x32_bf16 v[200:215], v[160:163], v[64:71], v3
    v_exp_f32 v89, v89
    v_exp_f32 v90, v90
    v_exp_f32 v91, v91
    v_exp_f32 v92, v92
    v_exp_f32 v93, v93
    v_exp_f32 v94, v94
    v_smfmac_f32_32x32x32_bf16 v[200:215], v[164:167], v[72:79], v3
    v_exp_f32 v95, v95
    v_exp_f32 v96, v96
    v_exp_f32 v97, v97
    v_mfma_f32_32x32x16_bf16 v[64:79], v[20:23], v[12:15], v[144:159]
    v_exp_f32 v98, v98
    v_exp_f32 v99, v99
    v_exp_f32 v100, v100
    v_exp_f32 v101, v101
    v_exp_f32 v102, v102
    v_exp_f32 v103, v103
    v_smfmac_f32_32x32x32_bf16 v[216:231], v[160:163], v[80:87], v3
    v_exp_f32 v104, v104
    v_exp_f32 v105, v105
    v_exp_f32 v106, v106
    v_exp_f32 v107, v107
    v_exp_f32 v108, v108
    v_exp_f32 v109, v109
    v_smfmac_f32_32x32x32_bf16 v[216:231], v[164:167], v[88:95], v3
    s_waitcnt lgkmcnt(0)
    v_exp_f32 v110, v110
    v_exp_f32 v111, v111
    v_exp_f32 v64, v64
    v_exp_f32 v65, v65
    v_exp_f32 v66, v66
    v_exp_f32 v67, v67
    v_mfma_f32_32x32x16_bf16 v[80:95], v[24:27], v[8:11], v[128:143]
    v_exp_f32 v68, v68
    v_exp_f32 v69, v69
    v_exp_f32 v70, v70
    v_exp_f32 v71, v71
    v_exp_f32 v72, v72
    v_exp_f32 v73, v73
    v_smfmac_f32_32x32x32_bf16 v[200:215], v[168:171], v[96:103], v3
    v_exp_f32 v74, v74
    v_exp_f32 v75, v75
    v_exp_f32 v76, v76
    v_exp_f32 v77, v77
    v_exp_f32 v78, v78
    v_exp_f32 v79, v79
    v_smfmac_f32_32x32x32_bf16 v[200:215], v[172:175], v[104:111], v3
    v_exp_f32 v80, v80
    v_exp_f32 v81, v81
    v_exp_f32 v82, v82
    v_mfma_f32_32x32x16_bf16 v[96:111], v[24:27], v[12:15], v[144:159]
    v_exp_f32 v83, v83
    v_exp_f32 v84, v84
    v_exp_f32 v85, v85
    v_exp_f32 v86, v86
    v_exp_f32 v87, v87
    v_exp_f32 v88, v88
    v_smfmac_f32_32x32x32_bf16 v[216:231], v[168:171], v[64:71], v3
    v_exp_f32 v89, v89
    v_exp_f32 v90, v90
    v_exp_f32 v91, v91
    v_exp_f32 v92, v92
    v_exp_f32 v93, v93
    v_exp_f32 v94, v94
    v_smfmac_f32_32x32x32_bf16 v[216:231], v[172:175], v[72:79], v3
    ds_read_b128 v[16:19], v56 offset:16384
    ds_read_b128 v[20:23], v56 offset:18432
    s_mov_b64 exec, s[86:87]
    ds_read_b128 v[160:163], v57 offset:16384
    ds_read_b128 v[164:167], v57 offset:16896
    ds_read_b128 v[168:171], v57 offset:18432
    ds_read_b128 v[172:175], v57 offset:18944
    s_mov_b64 exec, -1
    v_exp_f32 v95, v95
    v_exp_f32 v96, v96
    v_exp_f32 v97, v97
    v_mfma_f32_32x32x16_bf16 v[64:79], v[28:31], v[8:11], v[128:143]
    v_exp_f32 v98, v98
    v_exp_f32 v99, v99
    v_exp_f32 v100, v100
    v_exp_f32 v101, v101
    v_exp_f32 v102, v102
    v_exp_f32 v103, v103
    v_smfmac_f32_32x32x32_bf16 v[200:215], v[176:179], v[80:87], v3
    v_exp_f32 v104, v104
    v_exp_f32 v105, v105
    v_exp_f32 v106, v106
    v_exp_f32 v107, v107
    v_exp_f32 v108, v108
    v_exp_f32 v109, v109
    v_smfmac_f32_32x32x32_bf16 v[200:215], v[180:183], v[88:95], v3
    v_exp_f32 v110, v110
    v_exp_f32 v111, v111
    v_exp_f32 v64, v64
    v_exp_f32 v65, v65
    v_exp_f32 v66, v66
    v_exp_f32 v67, v67
    v_mfma_f32_32x32x16_bf16 v[80:95], v[28:31], v[12:15], v[144:159]
    v_exp_f32 v68, v68
    v_exp_f32 v69, v69
    v_exp_f32 v70, v70
    v_exp_f32 v71, v71
    v_exp_f32 v72, v72
    v_exp_f32 v73, v73
    v_smfmac_f32_32x32x32_bf16 v[216:231], v[176:179], v[96:103], v3
    v_exp_f32 v74, v74
    v_exp_f32 v75, v75
    v_exp_f32 v76, v76
    v_exp_f32 v77, v77
    v_exp_f32 v78, v78
    v_exp_f32 v79, v79
    v_smfmac_f32_32x32x32_bf16 v[216:231], v[180:183], v[104:111], v3
    s_waitcnt lgkmcnt(0)
    v_exp_f32 v80, v80
    v_exp_f32 v81, v81
    v_exp_f32 v82, v82
    v_mfma_f32_32x32x16_bf16 v[96:111], v[16:19], v[8:11], v[128:143]
    v_exp_f32 v83, v83
    v_exp_f32 v84, v84
    v_exp_f32 v85, v85
    v_exp_f32 v86, v86
    v_exp_f32 v87, v87
    v_exp_f32 v88, v88
    v_smfmac_f32_32x32x32_bf16 v[200:215], v[184:187], v[64:71], v3
    v_exp_f32 v89, v89
    v_exp_f32 v90, v90
    v_exp_f32 v91, v91
    v_exp_f32 v92, v92
    v_exp_f32 v93, v93
    v_exp_f32 v94, v94
    v_smfmac_f32_32x32x32_bf16 v[200:215], v[188:191], v[72:79], v3
    v_exp_f32 v95, v95
    v_exp_f32 v96, v96
    v_exp_f32 v97, v97
    v_mfma_f32_32x32x16_bf16 v[64:79], v[16:19], v[12:15], v[144:159]
    v_exp_f32 v98, v98
    v_exp_f32 v99, v99
    v_exp_f32 v100, v100
    v_exp_f32 v101, v101
    v_exp_f32 v102, v102
    v_exp_f32 v103, v103
    v_smfmac_f32_32x32x32_bf16 v[216:231], v[184:187], v[80:87], v3
    v_exp_f32 v104, v104
    v_exp_f32 v105, v105
    v_exp_f32 v106, v106
    v_exp_f32 v107, v107
    v_exp_f32 v108, v108
    v_exp_f32 v109, v109
    v_smfmac_f32_32x32x32_bf16 v[216:231], v[188:191], v[88:95], v3
    ds_read_b128 v[24:27], v56 offset:20480
    ds_read_b128 v[28:31], v56 offset:22528
    s_mov_b64 exec, s[86:87]
    ds_read_b128 v[176:179], v57 offset:20480
    ds_read_b128 v[180:183], v57 offset:20992
    ds_read_b128 v[184:187], v57 offset:22528
    ds_read_b128 v[188:191], v57 offset:23040
    s_mov_b64 exec, -1
    v_exp_f32 v110, v110
    v_exp_f32 v111, v111
    v_exp_f32 v64, v64
    v_mfma_f32_32x32x16_bf16 v[80:95], v[20:23], v[8:11], v[128:143]
    v_exp_f32 v65, v65
    v_exp_f32 v66, v66
    v_exp_f32 v67, v67
    v_exp_f32 v68, v68
    v_exp_f32 v69, v69
    v_exp_f32 v70, v70
    v_smfmac_f32_32x32x32_bf16 v[200:215], v[160:163], v[96:103], v3
    v_exp_f32 v71, v71
    v_exp_f32 v72, v72
    v_exp_f32 v73, v73
    v_exp_f32 v74, v74
    v_exp_f32 v75, v75
    v_exp_f32 v76, v76
    v_smfmac_f32_32x32x32_bf16 v[200:215], v[164:167], v[104:111], v3
    v_exp_f32 v77, v77
    v_exp_f32 v78, v78
    v_exp_f32 v79, v79
    v_exp_f32 v80, v80
    v_exp_f32 v81, v81
    v_exp_f32 v82, v82
    v_mfma_f32_32x32x16_bf16 v[96:111], v[20:23], v[12:15], v[144:159]
    v_exp_f32 v83, v83
    v_exp_f32 v84, v84
    v_exp_f32 v85, v85
    v_exp_f32 v86, v86
    v_exp_f32 v87, v87
    v_exp_f32 v88, v88
    v_smfmac_f32_32x32x32_bf16 v[216:231], v[160:163], v[64:71], v3
    v_exp_f32 v89, v89
    v_exp_f32 v90, v90
    v_exp_f32 v91, v91
    v_exp_f32 v92, v92
    v_exp_f32 v93, v93
    v_exp_f32 v94, v94
    v_smfmac_f32_32x32x32_bf16 v[216:231], v[164:167], v[72:79], v3
    s_waitcnt lgkmcnt(0)
    v_exp_f32 v95, v95
    v_exp_f32 v96, v96
    v_exp_f32 v97, v97
    v_mfma_f32_32x32x16_bf16 v[64:79], v[24:27], v[8:11], v[128:143]
    v_exp_f32 v98, v98
    v_exp_f32 v99, v99
    v_exp_f32 v100, v100
    v_exp_f32 v101, v101
    v_exp_f32 v102, v102
    v_exp_f32 v103, v103
    v_smfmac_f32_32x32x32_bf16 v[200:215], v[168:171], v[80:87], v3
    v_exp_f32 v104, v104
    v_exp_f32 v105, v105
    v_exp_f32 v106, v106
    v_exp_f32 v107, v107
    v_exp_f32 v108, v108
    v_exp_f32 v109, v109
    v_smfmac_f32_32x32x32_bf16 v[200:215], v[172:175], v[88:95], v3
    v_exp_f32 v110, v110
    v_exp_f32 v111, v111
    v_exp_f32 v64, v64
    v_exp_f32 v65, v65
    v_exp_f32 v66, v66
    v_exp_f32 v67, v67
    v_mfma_f32_32x32x16_bf16 v[80:95], v[24:27], v[12:15], v[144:159]
    v_exp_f32 v68, v68
    v_exp_f32 v69, v69
    v_exp_f32 v70, v70
    v_exp_f32 v71, v71
    v_exp_f32 v72, v72
    v_exp_f32 v73, v73
    v_smfmac_f32_32x32x32_bf16 v[216:231], v[168:171], v[96:103], v3
    v_exp_f32 v74, v74
    v_exp_f32 v75, v75
    v_exp_f32 v76, v76
    v_exp_f32 v77, v77
    v_exp_f32 v78, v78
    v_exp_f32 v79, v79
    v_smfmac_f32_32x32x32_bf16 v[216:231], v[172:175], v[104:111], v3
    ds_read_b128 v[16:19], v56 offset:24576
    ds_read_b128 v[20:23], v56 offset:26624
    s_mov_b64 exec, s[86:87]
    ds_read_b128 v[160:163], v57 offset:24576
    ds_read_b128 v[164:167], v57 offset:25088
    ds_read_b128 v[168:171], v57 offset:26624
    ds_read_b128 v[172:175], v57 offset:27136
    s_mov_b64 exec, -1
    v_exp_f32 v80, v80
    v_exp_f32 v81, v81
    v_exp_f32 v82, v82
    v_mfma_f32_32x32x16_bf16 v[96:111], v[28:31], v[8:11], v[128:143]
    v_exp_f32 v83, v83
    v_exp_f32 v84, v84
    v_exp_f32 v85, v85
    v_exp_f32 v86, v86
    v_exp_f32 v87, v87
    v_exp_f32 v88, v88
    v_smfmac_f32_32x32x32_bf16 v[200:215], v[176:179], v[64:71], v3
    v_exp_f32 v89, v89
    v_exp_f32 v90, v90
    v_exp_f32 v91, v91
    v_exp_f32 v92, v92
    v_exp_f32 v93, v93
    v_exp_f32 v94, v94
    v_smfmac_f32_32x32x32_bf16 v[200:215], v[180:183], v[72:79], v3
    v_exp_f32 v95, v95
    v_exp_f32 v96, v96
    v_exp_f32 v97, v97
    v_mfma_f32_32x32x16_bf16 v[64:79], v[28:31], v[12:15], v[144:159]
    v_exp_f32 v98, v98
    v_exp_f32 v99, v99
    v_exp_f32 v100, v100
    v_exp_f32 v101, v101
    v_exp_f32 v102, v102
    v_exp_f32 v103, v103
    v_smfmac_f32_32x32x32_bf16 v[216:231], v[176:179], v[80:87], v3
    v_exp_f32 v104, v104
    v_exp_f32 v105, v105
    v_exp_f32 v106, v106
    v_exp_f32 v107, v107
    v_exp_f32 v108, v108
    v_exp_f32 v109, v109
    v_smfmac_f32_32x32x32_bf16 v[216:231], v[180:183], v[88:95], v3
    s_waitcnt lgkmcnt(0)
    ds_write_b32 v59, v58
    v_exp_f32 v110, v110
    v_exp_f32 v111, v111
    v_exp_f32 v64, v64
    v_exp_f32 v65, v65
    v_exp_f32 v66, v66
    v_exp_f32 v67, v67
    v_mfma_f32_32x32x16_bf16 v[80:95], v[16:19], v[8:11], v[128:143]
    v_exp_f32 v68, v68
    v_exp_f32 v69, v69
    v_exp_f32 v70, v70
    v_exp_f32 v71, v71
    v_exp_f32 v72, v72
    v_exp_f32 v73, v73
    v_smfmac_f32_32x32x32_bf16 v[200:215], v[184:187], v[96:103], v3
    v_exp_f32 v74, v74
    v_exp_f32 v75, v75
    v_exp_f32 v76, v76
    v_exp_f32 v77, v77
    v_exp_f32 v78, v78
    v_exp_f32 v79, v79
    v_smfmac_f32_32x32x32_bf16 v[200:215], v[188:191], v[104:111], v3
    v_exp_f32 v80, v80
    v_exp_f32 v81, v81
    v_exp_f32 v82, v82
    v_mfma_f32_32x32x16_bf16 v[96:111], v[16:19], v[12:15], v[144:159]
    v_exp_f32 v83, v83
    v_exp_f32 v84, v84
    v_exp_f32 v85, v85
    v_exp_f32 v86, v86
    v_exp_f32 v87, v87
    v_exp_f32 v88, v88
    v_smfmac_f32_32x32x32_bf16 v[216:231], v[184:187], v[64:71], v3
    v_exp_f32 v89, v89
    v_exp_f32 v90, v90
    v_exp_f32 v91, v91
    v_exp_f32 v92, v92
    v_exp_f32 v93, v93
    v_exp_f32 v94, v94
    v_smfmac_f32_32x32x32_bf16 v[216:231], v[188:191], v[72:79], v3
    ds_read_b128 v[24:27], v56 offset:28672
    ds_read_b128 v[28:31], v56 offset:30720
    s_mov_b64 exec, s[86:87]
    ds_read_b128 v[176:179], v57 offset:28672
    ds_read_b128 v[180:183], v57 offset:29184
    ds_read_b128 v[184:187], v57 offset:30720
    ds_read_b128 v[188:191], v57 offset:31232
    s_mov_b64 exec, -1
    ds_read_b128 v[232:235], v60 offset:64
    v_exp_f32 v95, v95
    v_exp_f32 v96, v96
    v_exp_f32 v97, v97
    v_mfma_f32_32x32x16_bf16 v[64:79], v[20:23], v[8:11], v[128:143]
    v_exp_f32 v98, v98
    v_exp_f32 v99, v99
    v_exp_f32 v100, v100
    v_exp_f32 v101, v101
    v_exp_f32 v102, v102
    v_exp_f32 v103, v103
    v_smfmac_f32_32x32x32_bf16 v[200:215], v[160:163], v[80:87], v3
    v_exp_f32 v104, v104
    v_exp_f32 v105, v105
    v_exp_f32 v106, v106
    v_exp_f32 v107, v107
    v_exp_f32 v108, v108
    v_exp_f32 v109, v109
    v_smfmac_f32_32x32x32_bf16 v[200:215], v[164:167], v[88:95], v3
    v_exp_f32 v110, v110
    v_exp_f32 v111, v111
    v_exp_f32 v64, v64
    v_exp_f32 v65, v65
    v_exp_f32 v66, v66
    v_exp_f32 v67, v67
    v_mfma_f32_32x32x16_bf16 v[80:95], v[20:23], v[12:15], v[144:159]
    v_exp_f32 v68, v68
    v_exp_f32 v69, v69
    v_exp_f32 v70, v70
    v_exp_f32 v71, v71
    v_exp_f32 v72, v72
    v_exp_f32 v73, v73
    v_smfmac_f32_32x32x32_bf16 v[216:231], v[160:163], v[96:103], v3
    v_exp_f32 v74, v74
    v_exp_f32 v75, v75
    v_exp_f32 v76, v76
    v_exp_f32 v77, v77
    v_exp_f32 v78, v78
    v_exp_f32 v79, v79
    v_smfmac_f32_32x32x32_bf16 v[216:231], v[164:167], v[104:111], v3
    s_waitcnt lgkmcnt(0)
    v_exp_f32 v80, v80
    v_exp_f32 v81, v81
    v_exp_f32 v82, v82
    v_mfma_f32_32x32x16_bf16 v[96:111], v[24:27], v[8:11], v[128:143]
    v_exp_f32 v83, v83
    v_exp_f32 v84, v84
    v_exp_f32 v85, v85
    v_exp_f32 v86, v86
    v_exp_f32 v87, v87
    v_exp_f32 v88, v88
    v_smfmac_f32_32x32x32_bf16 v[200:215], v[168:171], v[64:71], v3
    v_exp_f32 v89, v89
    v_exp_f32 v90, v90
    v_exp_f32 v91, v91
    v_exp_f32 v92, v92
    v_exp_f32 v93, v93
    v_exp_f32 v94, v94
    v_smfmac_f32_32x32x32_bf16 v[200:215], v[172:175], v[72:79], v3
    v_exp_f32 v95, v95
    v_exp_f32 v96, v96
    v_exp_f32 v97, v97
    v_mfma_f32_32x32x16_bf16 v[64:79], v[24:27], v[12:15], v[144:159]
    v_exp_f32 v98, v98
    v_exp_f32 v99, v99
    v_exp_f32 v100, v100
    v_exp_f32 v101, v101
    v_exp_f32 v102, v102
    v_exp_f32 v103, v103
    v_smfmac_f32_32x32x32_bf16 v[216:231], v[168:171], v[80:87], v3
    v_exp_f32 v104, v104
    v_exp_f32 v105, v105
    v_exp_f32 v106, v106
    v_exp_f32 v107, v107
    v_exp_f32 v108, v108
    v_exp_f32 v109, v109
    v_smfmac_f32_32x32x32_bf16 v[216:231], v[172:175], v[88:95], v3
    v_min3_u32 v232, v232, v233, v234
    v_and_b32 v232, v232, v235
    v_cmp_eq_u32 vcc, 0, v232
    s_nop 0
    s_cmp_eq_u64 vcc, 0
    s_cbranch_scc1 L_kvp92d
    s_mov_b32 s91, 65536
L_kvp92:
    ds_read_b128 v[232:235], v60 offset:64
    s_waitcnt lgkmcnt(0)
    v_and_b32 v232, v232, v233
    v_and_b32 v234, v234, v235
    v_and_b32 v232, v232, v234
    s_sub_u32 s91, s91, 1
    v_readfirstlane_b32 s3, v232
    s_cbranch_scc1 L_kvp92d
    s_cmp_lg_u32 s3, 0
    s_cbranch_scc1 L_kvp92d
    s_sleep 2
    s_branch L_kvp92
L_kvp92d:
    ds_read_b128 v[16:19], v56 offset:32768
    ds_read_b128 v[20:23], v56 offset:34816
    s_mov_b64 exec, s[86:87]
    ds_read_b128 v[160:163], v57 offset:32768
    ds_read_b128 v[164:167], v57 offset:33280
    ds_read_b128 v[168:171], v57 offset:34816
    ds_read_b128 v[172:175], v57 offset:35328
    s_mov_b64 exec, -1
    v_exp_f32 v110, v110
    v_exp_f32 v111, v111
    v_exp_f32 v64, v64
    v_mfma_f32_32x32x16_bf16 v[80:95], v[28:31], v[8:11], v[128:143]
    v_exp_f32 v65, v65
    v_exp_f32 v66, v66
    v_exp_f32 v67, v67
    v_exp_f32 v68, v68
    v_exp_f32 v69, v69
    v_exp_f32 v70, v70
    v_smfmac_f32_32x32x32_bf16 v[200:215], v[176:179], v[96:103], v3
    v_exp_f32 v71, v71
    v_exp_f32 v72, v72
    v_exp_f32 v73, v73
    v_exp_f32 v74, v74
    v_exp_f32 v75, v75
    v_exp_f32 v76, v76
    v_smfmac_f32_32x32x32_bf16 v[200:215], v[180:183], v[104:111], v3
    v_exp_f32 v77, v77
    v_exp_f32 v78, v78
    v_exp_f32 v79, v79
    v_exp_f32 v80, v80
    v_exp_f32 v81, v81
    v_exp_f32 v82, v82
    v_mfma_f32_32x32x16_bf16 v[96:111], v[28:31], v[12:15], v[144:159]
    v_exp_f32 v83, v83
    v_exp_f32 v84, v84
    v_exp_f32 v85, v85
    v_exp_f32 v86, v86
    v_exp_f32 v87, v87
    v_exp_f32 v88, v88
    v_smfmac_f32_32x32x32_bf16 v[216:231], v[176:179], v[64:71], v3
    v_exp_f32 v89, v89
    v_exp_f32 v90, v90
    v_exp_f32 v91, v91
    v_exp_f32 v92, v92
    v_exp_f32 v93, v93
    v_exp_f32 v94, v94
    v_smfmac_f32_32x32x32_bf16 v[216:231], v[180:183], v[72:79], v3
    s_waitcnt lgkmcnt(0)
    v_exp_f32 v95, v95
    v_exp_f32 v96, v96
    v_exp_f32 v97, v97
    v_mfma_f32_32x32x16_bf16 v[64:79], v[16:19], v[8:11], v[128:143]
    v_exp_f32 v98, v98
    v_exp_f32 v99, v99
    v_exp_f32 v100, v100
    v_exp_f32 v101, v101
    v_exp_f32 v102, v102
    v_exp_f32 v103, v103
    v_smfmac_f32_32x32x32_bf16 v[200:215], v[184:187], v[80:87], v3
    v_exp_f32 v104, v104
    v_exp_f32 v105, v105
    v_exp_f32 v106, v106
    v_exp_f32 v107, v107
    v_exp_f32 v108, v108
    v_exp_f32 v109, v109
    v_smfmac_f32_32x32x32_bf16 v[200:215], v[188:191], v[88:95], v3
    v_exp_f32 v110, v110
    v_exp_f32 v111, v111
    v_exp_f32 v64, v64
    v_exp_f32 v65, v65
    v_exp_f32 v66, v66
    v_exp_f32 v67, v67
    v_mfma_f32_32x32x16_bf16 v[80:95], v[16:19], v[12:15], v[144:159]
    v_exp_f32 v68, v68
    v_exp_f32 v69, v69
    v_exp_f32 v70, v70
    v_exp_f32 v71, v71
    v_exp_f32 v72, v72
    v_exp_f32 v73, v73
    v_smfmac_f32_32x32x32_bf16 v[216:231], v[184:187], v[96:103], v3
    v_exp_f32 v74, v74
    v_exp_f32 v75, v75
    v_exp_f32 v76, v76
    v_exp_f32 v77, v77
    v_exp_f32 v78, v78
    v_exp_f32 v79, v79
    v_smfmac_f32_32x32x32_bf16 v[216:231], v[188:191], v[104:111], v3
    ds_read_b128 v[24:27], v56 offset:36864
    ds_read_b128 v[28:31], v56 offset:38912
    s_mov_b64 exec, s[86:87]
    ds_read_b128 v[176:179], v57 offset:36864
    ds_read_b128 v[180:183], v57 offset:37376
    ds_read_b128 v[184:187], v57 offset:38912
    ds_read_b128 v[188:191], v57 offset:39424
    s_mov_b64 exec, -1
    v_exp_f32 v80, v80
    v_exp_f32 v81, v81
    v_exp_f32 v82, v82
    v_mfma_f32_32x32x16_bf16 v[96:111], v[20:23], v[8:11], v[128:143]
    v_exp_f32 v83, v83
    v_exp_f32 v84, v84
    v_exp_f32 v85, v85
    v_exp_f32 v86, v86
    v_exp_f32 v87, v87
    v_exp_f32 v88, v88
    v_smfmac_f32_32x32x32_bf16 v[200:215], v[160:163], v[64:71], v3
    v_exp_f32 v89, v89
    v_exp_f32 v90, v90
    v_exp_f32 v91, v91
    v_exp_f32 v92, v92
    v_exp_f32 v93, v93
    v_exp_f32 v94, v94
    v_smfmac_f32_32x32x32_bf16 v[200:215], v[164:167], v[72:79], v3
    v_exp_f32 v95, v95
    v_exp_f32 v96, v96
    v_exp_f32 v97, v97
    v_mfma_f32_32x32x16_bf16 v[64:79], v[20:23], v[12:15], v[144:159]
    v_exp_f32 v98, v98
    v_exp_f32 v99, v99
    v_exp_f32 v100, v100
    v_exp_f32 v101, v101
    v_exp_f32 v102, v102
    v_exp_f32 v103, v103
    v_smfmac_f32_32x32x32_bf16 v[216:231], v[160:163], v[80:87], v3
    v_exp_f32 v104, v104
    v_exp_f32 v105, v105
    v_exp_f32 v106, v106
    v_exp_f32 v107, v107
    v_exp_f32 v108, v108
    v_exp_f32 v109, v109
    v_smfmac_f32_32x32x32_bf16 v[216:231], v[164:167], v[88:95], v3
    s_waitcnt lgkmcnt(0)
    v_exp_f32 v110, v110
    v_exp_f32 v111, v111
    v_exp_f32 v64, v64
    v_exp_f32 v65, v65
    v_exp_f32 v66, v66
    v_exp_f32 v67, v67
    v_mfma_f32_32x32x16_bf16 v[80:95], v[24:27], v[8:11], v[128:143]
    v_exp_f32 v68, v68
    v_exp_f32 v69, v69
    v_exp_f32 v70, v70
    v_exp_f32 v71, v71
    v_exp_f32 v72, v72
    v_exp_f32 v73, v73
    v_smfmac_f32_32x32x32_bf16 v[200:215], v[168:171], v[96:103], v3
    v_exp_f32 v74, v74
    v_exp_f32 v75, v75
    v_exp_f32 v76, v76
    v_exp_f32 v77, v77
    v_exp_f32 v78, v78
    v_exp_f32 v79, v79
    v_smfmac_f32_32x32x32_bf16 v[200:215], v[172:175], v[104:111], v3
    v_exp_f32 v80, v80
    v_exp_f32 v81, v81
    v_exp_f32 v82, v82
    v_mfma_f32_32x32x16_bf16 v[96:111], v[24:27], v[12:15], v[144:159]
    v_exp_f32 v83, v83
    v_exp_f32 v84, v84
    v_exp_f32 v85, v85
    v_exp_f32 v86, v86
    v_exp_f32 v87, v87
    v_exp_f32 v88, v88
    v_smfmac_f32_32x32x32_bf16 v[216:231], v[168:171], v[64:71], v3
    v_exp_f32 v89, v89
    v_exp_f32 v90, v90
    v_exp_f32 v91, v91
    v_exp_f32 v92, v92
    v_exp_f32 v93, v93
    v_exp_f32 v94, v94
    v_smfmac_f32_32x32x32_bf16 v[216:231], v[172:175], v[72:79], v3
    ds_read_b128 v[16:19], v56 offset:40960
    ds_read_b128 v[20:23], v56 offset:43008
    s_mov_b64 exec, s[86:87]
    ds_read_b128 v[160:163], v57 offset:40960
    ds_read_b128 v[164:167], v57 offset:41472
    ds_read_b128 v[168:171], v57 offset:43008
    ds_read_b128 v[172:175], v57 offset:43520
    s_mov_b64 exec, -1
    v_exp_f32 v95, v95
    v_exp_f32 v96, v96
    v_exp_f32 v97, v97
    v_mfma_f32_32x32x16_bf16 v[64:79], v[28:31], v[8:11], v[128:143]
    v_exp_f32 v98, v98
    v_exp_f32 v99, v99
    v_exp_f32 v100, v100
    v_exp_f32 v101, v101
    v_exp_f32 v102, v102
    v_exp_f32 v103, v103
    v_smfmac_f32_32x32x32_bf16 v[200:215], v[176:179], v[80:87], v3
    v_exp_f32 v104, v104
    v_exp_f32 v105, v105
    v_exp_f32 v106, v106
    v_exp_f32 v107, v107
    v_exp_f32 v108, v108
    v_exp_f32 v109, v109
    v_smfmac_f32_32x32x32_bf16 v[200:215], v[180:183], v[88:95], v3
    v_exp_f32 v110, v110
    v_exp_f32 v111, v111
    v_exp_f32 v64, v64
    v_exp_f32 v65, v65
    v_exp_f32 v66, v66
    v_exp_f32 v67, v67
    v_mfma_f32_32x32x16_bf16 v[80:95], v[28:31], v[12:15], v[144:159]
    v_exp_f32 v68, v68
    v_exp_f32 v69, v69
    v_exp_f32 v70, v70
    v_exp_f32 v71, v71
    v_exp_f32 v72, v72
    v_exp_f32 v73, v73
    v_smfmac_f32_32x32x32_bf16 v[216:231], v[176:179], v[96:103], v3
    v_exp_f32 v74, v74
    v_exp_f32 v75, v75
    v_exp_f32 v76, v76
    v_exp_f32 v77, v77
    v_exp_f32 v78, v78
    v_exp_f32 v79, v79
    v_smfmac_f32_32x32x32_bf16 v[216:231], v[180:183], v[104:111], v3
    s_waitcnt lgkmcnt(0)
    buffer_load_dword v6, v5, s[28:31], s82 offen sc1
    buffer_load_dword v7, v5, s[28:31], s82 offen offset:128 sc1
    v_exp_f32 v80, v80
    v_exp_f32 v81, v81
    v_exp_f32 v82, v82
    v_mfma_f32_32x32x16_bf16 v[96:111], v[16:19], v[8:11], v[128:143]
    v_exp_f32 v83, v83
    v_exp_f32 v84, v84
    v_exp_f32 v85, v85
    v_exp_f32 v86, v86
    v_exp_f32 v87, v87
    v_exp_f32 v88, v88
    v_smfmac_f32_32x32x32_bf16 v[200:215], v[184:187], v[64:71], v3
    v_exp_f32 v89, v89
    v_exp_f32 v90, v90
    v_exp_f32 v91, v91
    v_exp_f32 v92, v92
    v_exp_f32 v93, v93
    v_exp_f32 v94, v94
    v_smfmac_f32_32x32x32_bf16 v[200:215], v[188:191], v[72:79], v3
    v_exp_f32 v95, v95
    v_exp_f32 v96, v96
    v_exp_f32 v97, v97
    v_mfma_f32_32x32x16_bf16 v[64:79], v[16:19], v[12:15], v[144:159]
    v_exp_f32 v98, v98
    v_exp_f32 v99, v99
    v_exp_f32 v100, v100
    v_exp_f32 v101, v101
    v_exp_f32 v102, v102
    v_exp_f32 v103, v103
    v_smfmac_f32_32x32x32_bf16 v[216:231], v[184:187], v[80:87], v3
    v_exp_f32 v104, v104
    v_exp_f32 v105, v105
    v_exp_f32 v106, v106
    v_exp_f32 v107, v107
    v_exp_f32 v108, v108
    v_exp_f32 v109, v109
    v_smfmac_f32_32x32x32_bf16 v[216:231], v[188:191], v[88:95], v3
    ds_read_b128 v[24:27], v56 offset:45056
    ds_read_b128 v[28:31], v56 offset:47104
    s_mov_b64 exec, s[86:87]
    ds_read_b128 v[176:179], v57 offset:45056
    ds_read_b128 v[180:183], v57 offset:45568
    ds_read_b128 v[184:187], v57 offset:47104
    ds_read_b128 v[188:191], v57 offset:47616
    s_mov_b64 exec, -1
    v_exp_f32 v110, v110
    v_exp_f32 v111, v111
    v_exp_f32 v64, v64
    v_mfma_f32_32x32x16_bf16 v[80:95], v[20:23], v[8:11], v[128:143]
    v_exp_f32 v65, v65
    v_exp_f32 v66, v66
    v_exp_f32 v67, v67
    v_exp_f32 v68, v68
    v_exp_f32 v69, v69
    v_exp_f32 v70, v70
    v_smfmac_f32_32x32x32_bf16 v[200:215], v[160:163], v[96:103], v3
    v_exp_f32 v71, v71
    v_exp_f32 v72, v72
    v_exp_f32 v73, v73
    v_exp_f32 v74, v74
    v_exp_f32 v75, v75
    v_exp_f32 v76, v76
    v_smfmac_f32_32x32x32_bf16 v[200:215], v[164:167], v[104:111], v3
    v_exp_f32 v77, v77
    v_exp_f32 v78, v78
    v_exp_f32 v79, v79
    v_exp_f32 v80, v80
    v_exp_f32 v81, v81
    v_exp_f32 v82, v82
    v_mfma_f32_32x32x16_bf16 v[96:111], v[20:23], v[12:15], v[144:159]
    v_exp_f32 v83, v83
    v_exp_f32 v84, v84
    v_exp_f32 v85, v85
    v_exp_f32 v86, v86
    v_exp_f32 v87, v87
    v_exp_f32 v88, v88
    v_smfmac_f32_32x32x32_bf16 v[216:231], v[160:163], v[64:71], v3
    v_exp_f32 v89, v89
    v_exp_f32 v90, v90
    v_exp_f32 v91, v91
    v_exp_f32 v92, v92
    v_exp_f32 v93, v93
    v_exp_f32 v94, v94
    v_smfmac_f32_32x32x32_bf16 v[216:231], v[164:167], v[72:79], v3
    s_waitcnt lgkmcnt(0)
    v_exp_f32 v95, v95
    v_exp_f32 v96, v96
    v_exp_f32 v97, v97
    v_mfma_f32_32x32x16_bf16 v[64:79], v[24:27], v[8:11], v[128:143]
    v_exp_f32 v98, v98
    v_exp_f32 v99, v99
    v_exp_f32 v100, v100
    v_exp_f32 v101, v101
    v_exp_f32 v102, v102
    v_exp_f32 v103, v103
    v_smfmac_f32_32x32x32_bf16 v[200:215], v[168:171], v[80:87], v3
    v_exp_f32 v104, v104
    v_exp_f32 v105, v105
    v_exp_f32 v106, v106
    v_exp_f32 v107, v107
    v_exp_f32 v108, v108
    v_exp_f32 v109, v109
    v_smfmac_f32_32x32x32_bf16 v[200:215], v[172:175], v[88:95], v3
    v_exp_f32 v110, v110
    v_exp_f32 v111, v111
    v_exp_f32 v64, v64
    v_exp_f32 v65, v65
    v_exp_f32 v66, v66
    v_exp_f32 v67, v67
    v_mfma_f32_32x32x16_bf16 v[80:95], v[24:27], v[12:15], v[144:159]
    v_exp_f32 v68, v68
    v_exp_f32 v69, v69
    v_exp_f32 v70, v70
    v_exp_f32 v71, v71
    v_exp_f32 v72, v72
    v_exp_f32 v73, v73
    v_smfmac_f32_32x32x32_bf16 v[216:231], v[168:171], v[96:103], v3
    v_exp_f32 v74, v74
    v_exp_f32 v75, v75
    v_exp_f32 v76, v76
    v_exp_f32 v77, v77
    v_exp_f32 v78, v78
    v_exp_f32 v79, v79
    v_smfmac_f32_32x32x32_bf16 v[216:231], v[172:175], v[104:111], v3
    ds_read_b128 v[16:19], v56 offset:49152
    ds_read_b128 v[20:23], v56 offset:51200
    s_mov_b64 exec, s[86:87]
    ds_read_b128 v[160:163], v57 offset:49152
    ds_read_b128 v[164:167], v57 offset:49664
    ds_read_b128 v[168:171], v57 offset:51200
    ds_read_b128 v[172:175], v57 offset:51712
    s_mov_b64 exec, -1
    v_exp_f32 v80, v80
    v_exp_f32 v81, v81
    v_exp_f32 v82, v82
    v_mfma_f32_32x32x16_bf16 v[96:111], v[28:31], v[8:11], v[128:143]
    v_exp_f32 v83, v83
    v_exp_f32 v84, v84
    v_exp_f32 v85, v85
    v_exp_f32 v86, v86
    v_exp_f32 v87, v87
    v_exp_f32 v88, v88
    v_smfmac_f32_32x32x32_bf16 v[200:215], v[176:179], v[64:71], v3
    v_exp_f32 v89, v89
    v_exp_f32 v90, v90
    v_exp_f32 v91, v91
    v_exp_f32 v92, v92
    v_exp_f32 v93, v93
    v_exp_f32 v94, v94
    v_smfmac_f32_32x32x32_bf16 v[200:215], v[180:183], v[72:79], v3
    v_exp_f32 v95, v95
    v_exp_f32 v96, v96
    v_exp_f32 v97, v97
    v_mfma_f32_32x32x16_bf16 v[64:79], v[28:31], v[12:15], v[144:159]
    v_exp_f32 v98, v98
    v_exp_f32 v99, v99
    v_exp_f32 v100, v100
    v_exp_f32 v101, v101
    v_exp_f32 v102, v102
    v_exp_f32 v103, v103
    v_smfmac_f32_32x32x32_bf16 v[216:231], v[176:179], v[80:87], v3
    v_exp_f32 v104, v104
    v_exp_f32 v105, v105
    v_exp_f32 v106, v106
    v_exp_f32 v107, v107
    v_exp_f32 v108, v108
    v_exp_f32 v109, v109
    v_smfmac_f32_32x32x32_bf16 v[216:231], v[180:183], v[88:95], v3
    s_waitcnt lgkmcnt(0)
    v_exp_f32 v110, v110
    v_exp_f32 v111, v111
    v_exp_f32 v64, v64
    v_exp_f32 v65, v65
    v_exp_f32 v66, v66
    v_exp_f32 v67, v67
    v_mfma_f32_32x32x16_bf16 v[80:95], v[16:19], v[8:11], v[128:143]
    v_exp_f32 v68, v68
    v_exp_f32 v69, v69
    v_exp_f32 v70, v70
    v_exp_f32 v71, v71
    v_exp_f32 v72, v72
    v_exp_f32 v73, v73
    v_smfmac_f32_32x32x32_bf16 v[200:215], v[184:187], v[96:103], v3
    v_exp_f32 v74, v74
    v_exp_f32 v75, v75
    v_exp_f32 v76, v76
    v_exp_f32 v77, v77
    v_exp_f32 v78, v78
    v_exp_f32 v79, v79
    v_smfmac_f32_32x32x32_bf16 v[200:215], v[188:191], v[104:111], v3
    v_exp_f32 v80, v80
    v_exp_f32 v81, v81
    v_exp_f32 v82, v82
    v_mfma_f32_32x32x16_bf16 v[96:111], v[16:19], v[12:15], v[144:159]
    v_exp_f32 v83, v83
    v_exp_f32 v84, v84
    v_exp_f32 v85, v85
    v_exp_f32 v86, v86
    v_exp_f32 v87, v87
    v_exp_f32 v88, v88
    v_smfmac_f32_32x32x32_bf16 v[216:231], v[184:187], v[64:71], v3
    v_exp_f32 v89, v89
    v_exp_f32 v90, v90
    v_exp_f32 v91, v91
    v_exp_f32 v92, v92
    v_exp_f32 v93, v93
    v_exp_f32 v94, v94
    v_smfmac_f32_32x32x32_bf16 v[216:231], v[188:191], v[72:79], v3
    ds_read_b128 v[24:27], v56 offset:53248
    ds_read_b128 v[28:31], v56 offset:55296
    s_mov_b64 exec, s[86:87]
    ds_read_b128 v[176:179], v57 offset:53248
    ds_read_b128 v[180:183], v57 offset:53760
    ds_read_b128 v[184:187], v57 offset:55296
    ds_read_b128 v[188:191], v57 offset:55808
    s_mov_b64 exec, -1
    v_exp_f32 v95, v95
    v_exp_f32 v96, v96
    v_exp_f32 v97, v97
    v_mfma_f32_32x32x16_bf16 v[64:79], v[20:23], v[8:11], v[128:143]
    v_exp_f32 v98, v98
    v_exp_f32 v99, v99
    v_exp_f32 v100, v100
    v_exp_f32 v101, v101
    v_exp_f32 v102, v102
    v_exp_f32 v103, v103
    v_smfmac_f32_32x32x32_bf16 v[200:215], v[160:163], v[80:87], v3
    v_exp_f32 v104, v104
    v_exp_f32 v105, v105
    v_exp_f32 v106, v106
    v_exp_f32 v107, v107
    v_exp_f32 v108, v108
    v_exp_f32 v109, v109
    v_smfmac_f32_32x32x32_bf16 v[200:215], v[164:167], v[88:95], v3
    v_exp_f32 v110, v110
    v_exp_f32 v111, v111
    v_exp_f32 v64, v64
    v_exp_f32 v65, v65
    v_exp_f32 v66, v66
    v_exp_f32 v67, v67
    v_mfma_f32_32x32x16_bf16 v[80:95], v[20:23], v[12:15], v[144:159]
    v_exp_f32 v68, v68
    v_exp_f32 v69, v69
    v_exp_f32 v70, v70
    v_exp_f32 v71, v71
    v_exp_f32 v72, v72
    v_exp_f32 v73, v73
    v_smfmac_f32_32x32x32_bf16 v[216:231], v[160:163], v[96:103], v3
    v_exp_f32 v74, v74
    v_exp_f32 v75, v75
    v_exp_f32 v76, v76
    v_exp_f32 v77, v77
    v_exp_f32 v78, v78
    v_exp_f32 v79, v79
    v_smfmac_f32_32x32x32_bf16 v[216:231], v[164:167], v[104:111], v3
    s_waitcnt lgkmcnt(0)
    v_exp_f32 v80, v80
    v_exp_f32 v81, v81
    v_exp_f32 v82, v82
    v_mfma_f32_32x32x16_bf16 v[96:111], v[24:27], v[8:11], v[128:143]
    v_exp_f32 v83, v83
    v_exp_f32 v84, v84
    v_exp_f32 v85, v85
    v_exp_f32 v86, v86
    v_exp_f32 v87, v87
    v_exp_f32 v88, v88
    v_smfmac_f32_32x32x32_bf16 v[200:215], v[168:171], v[64:71], v3
    v_exp_f32 v89, v89
    v_exp_f32 v90, v90
    v_exp_f32 v91, v91
    v_exp_f32 v92, v92
    v_exp_f32 v93, v93
    v_exp_f32 v94, v94
    v_smfmac_f32_32x32x32_bf16 v[200:215], v[172:175], v[72:79], v3
    v_exp_f32 v95, v95
    v_exp_f32 v96, v96
    v_exp_f32 v97, v97
    v_mfma_f32_32x32x16_bf16 v[64:79], v[24:27], v[12:15], v[144:159]
    v_exp_f32 v98, v98
    v_exp_f32 v99, v99
    v_exp_f32 v100, v100
    v_exp_f32 v101, v101
    v_exp_f32 v102, v102
    v_exp_f32 v103, v103
    v_smfmac_f32_32x32x32_bf16 v[216:231], v[168:171], v[80:87], v3
    v_exp_f32 v104, v104
    v_exp_f32 v105, v105
    v_exp_f32 v106, v106
    v_exp_f32 v107, v107
    v_exp_f32 v108, v108
    v_exp_f32 v109, v109
    v_smfmac_f32_32x32x32_bf16 v[216:231], v[172:175], v[88:95], v3
    ds_read_b128 v[16:19], v56 offset:57344
    ds_read_b128 v[20:23], v56 offset:59392
    s_mov_b64 exec, s[86:87]
    ds_read_b128 v[160:163], v57 offset:57344
    ds_read_b128 v[164:167], v57 offset:57856
    ds_read_b128 v[168:171], v57 offset:59392
    ds_read_b128 v[172:175], v57 offset:59904
    s_mov_b64 exec, -1
    v_exp_f32 v110, v110
    v_exp_f32 v111, v111
    v_exp_f32 v64, v64
    v_mfma_f32_32x32x16_bf16 v[80:95], v[28:31], v[8:11], v[128:143]
    v_exp_f32 v65, v65
    v_exp_f32 v66, v66
    v_exp_f32 v67, v67
    v_exp_f32 v68, v68
    v_exp_f32 v69, v69
    v_exp_f32 v70, v70
    v_smfmac_f32_32x32x32_bf16 v[200:215], v[176:179], v[96:103], v3
    v_exp_f32 v71, v71
    v_exp_f32 v72, v72
    v_exp_f32 v73, v73
    v_exp_f32 v74, v74
    v_exp_f32 v75, v75
    v_exp_f32 v76, v76
    v_smfmac_f32_32x32x32_bf16 v[200:215], v[180:183], v[104:111], v3
    v_exp_f32 v77, v77
    v_exp_f32 v78, v78
    v_exp_f32 v79, v79
    v_exp_f32 v80, v80
    v_exp_f32 v81, v81
    v_exp_f32 v82, v82
    v_mfma_f32_32x32x16_bf16 v[96:111], v[28:31], v[12:15], v[144:159]
    v_exp_f32 v83, v83
    v_exp_f32 v84, v84
    v_exp_f32 v85, v85
    v_exp_f32 v86, v86
    v_exp_f32 v87, v87
    v_exp_f32 v88, v88
    v_smfmac_f32_32x32x32_bf16 v[216:231], v[176:179], v[64:71], v3
    v_exp_f32 v89, v89
    v_exp_f32 v90, v90
    v_exp_f32 v91, v91
    v_exp_f32 v92, v92
    v_exp_f32 v93, v93
    v_exp_f32 v94, v94
    v_smfmac_f32_32x32x32_bf16 v[216:231], v[180:183], v[72:79], v3
    s_waitcnt lgkmcnt(0)
    v_exp_f32 v95, v95
    v_exp_f32 v96, v96
    v_exp_f32 v97, v97
    v_mfma_f32_32x32x16_bf16 v[64:79], v[16:19], v[8:11], v[128:143]
    v_exp_f32 v98, v98
    v_exp_f32 v99, v99
    v_exp_f32 v100, v100
    v_exp_f32 v101, v101
    v_exp_f32 v102, v102
    v_exp_f32 v103, v103
    v_smfmac_f32_32x32x32_bf16 v[200:215], v[184:187], v[80:87], v3
    v_exp_f32 v104, v104
    v_exp_f32 v105, v105
    v_exp_f32 v106, v106
    v_exp_f32 v107, v107
    v_exp_f32 v108, v108
    v_exp_f32 v109, v109
    v_smfmac_f32_32x32x32_bf16 v[200:215], v[188:191], v[88:95], v3
    v_exp_f32 v110, v110
    v_exp_f32 v111, v111
    v_exp_f32 v64, v64
    v_exp_f32 v65, v65
    v_exp_f32 v66, v66
    v_exp_f32 v67, v67
    v_mfma_f32_32x32x16_bf16 v[80:95], v[16:19], v[12:15], v[144:159]
    v_exp_f32 v68, v68
    v_exp_f32 v69, v69
    v_exp_f32 v70, v70
    v_exp_f32 v71, v71
    v_exp_f32 v72, v72
    v_exp_f32 v73, v73
    v_smfmac_f32_32x32x32_bf16 v[216:231], v[184:187], v[96:103], v3
    v_exp_f32 v74, v74
    v_exp_f32 v75, v75
    v_exp_f32 v76, v76
    v_exp_f32 v77, v77
    v_exp_f32 v78, v78
    v_exp_f32 v79, v79
    v_smfmac_f32_32x32x32_bf16 v[216:231], v[188:191], v[104:111], v3
    ds_read_b128 v[24:27], v56 offset:61440
    ds_read_b128 v[28:31], v56 offset:63488
    s_mov_b64 exec, s[86:87]
    ds_read_b128 v[176:179], v57 offset:61440
    ds_read_b128 v[180:183], v57 offset:61952
    ds_read_b128 v[184:187], v57 offset:63488
    ds_read_b128 v[188:191], v57 offset:64000
    s_mov_b64 exec, -1
    v_exp_f32 v80, v80
    v_exp_f32 v81, v81
    v_exp_f32 v82, v82
    v_mfma_f32_32x32x16_bf16 v[96:111], v[20:23], v[8:11], v[128:143]
    v_exp_f32 v83, v83
    v_exp_f32 v84, v84
    v_exp_f32 v85, v85
    v_exp_f32 v86, v86
    v_exp_f32 v87, v87
    v_exp_f32 v88, v88
    v_smfmac_f32_32x32x32_bf16 v[200:215], v[160:163], v[64:71], v3
    v_exp_f32 v89, v89
    v_exp_f32 v90, v90
    v_exp_f32 v91, v91
    v_exp_f32 v92, v92
    v_exp_f32 v93, v93
    v_exp_f32 v94, v94
    v_smfmac_f32_32x32x32_bf16 v[200:215], v[164:167], v[72:79], v3
    v_exp_f32 v95, v95
    v_exp_f32 v96, v96
    v_exp_f32 v97, v97
    v_mfma_f32_32x32x16_bf16 v[64:79], v[20:23], v[12:15], v[144:159]
    v_exp_f32 v98, v98
    v_exp_f32 v99, v99
    v_exp_f32 v100, v100
    v_exp_f32 v101, v101
    v_exp_f32 v102, v102
    v_exp_f32 v103, v103
    v_smfmac_f32_32x32x32_bf16 v[216:231], v[160:163], v[80:87], v3
    v_exp_f32 v104, v104
    v_exp_f32 v105, v105
    v_exp_f32 v106, v106
    v_exp_f32 v107, v107
    v_exp_f32 v108, v108
    v_exp_f32 v109, v109
    v_smfmac_f32_32x32x32_bf16 v[216:231], v[164:167], v[88:95], v3
    s_waitcnt lgkmcnt(0)
    v_exp_f32 v110, v110
    v_exp_f32 v111, v111
    v_exp_f32 v64, v64
    v_exp_f32 v65, v65
    v_exp_f32 v66, v66
    v_exp_f32 v67, v67
    v_mfma_f32_32x32x16_bf16 v[80:95], v[24:27], v[8:11], v[128:143]
    v_exp_f32 v68, v68
    v_exp_f32 v69, v69
    v_exp_f32 v70, v70
    v_exp_f32 v71, v71
    v_exp_f32 v72, v72
    v_exp_f32 v73, v73
    v_smfmac_f32_32x32x32_bf16 v[200:215], v[168:171], v[96:103], v3
    v_exp_f32 v74, v74
    v_exp_f32 v75, v75
    v_exp_f32 v76, v76
    v_exp_f32 v77, v77
    v_exp_f32 v78, v78
    v_exp_f32 v79, v79
    v_smfmac_f32_32x32x32_bf16 v[200:215], v[172:175], v[104:111], v3
    v_exp_f32 v80, v80
    v_exp_f32 v81, v81
    v_exp_f32 v82, v82
    v_mfma_f32_32x32x16_bf16 v[96:111], v[24:27], v[12:15], v[144:159]
    v_exp_f32 v83, v83
    v_exp_f32 v84, v84
    v_exp_f32 v85, v85
    v_exp_f32 v86, v86
    v_exp_f32 v87, v87
    v_exp_f32 v88, v88
    v_smfmac_f32_32x32x32_bf16 v[216:231], v[168:171], v[64:71], v3
    v_exp_f32 v89, v89
    v_exp_f32 v90, v90
    v_exp_f32 v91, v91
    v_exp_f32 v92, v92
    v_exp_f32 v93, v93
    v_exp_f32 v94, v94
    v_smfmac_f32_32x32x32_bf16 v[216:231], v[172:175], v[72:79], v3
    v_exp_f32 v95, v95
    v_exp_f32 v96, v96
    v_exp_f32 v97, v97
    v_mfma_f32_32x32x16_bf16 v[64:79], v[28:31], v[8:11], v[128:143]
    v_exp_f32 v98, v98
    v_exp_f32 v99, v99
    v_exp_f32 v100, v100
    v_exp_f32 v101, v101
    v_exp_f32 v102, v102
    v_exp_f32 v103, v103
    v_smfmac_f32_32x32x32_bf16 v[200:215], v[176:179], v[80:87], v3
    v_exp_f32 v104, v104
    v_exp_f32 v105, v105
    v_exp_f32 v106, v106
    v_exp_f32 v107, v107
    v_exp_f32 v108, v108
    v_exp_f32 v109, v109
    v_smfmac_f32_32x32x32_bf16 v[200:215], v[180:183], v[88:95], v3
    v_exp_f32 v110, v110
    v_exp_f32 v111, v111
    v_exp_f32 v64, v64
    v_exp_f32 v65, v65
    v_exp_f32 v66, v66
    v_exp_f32 v67, v67
    v_mfma_f32_32x32x16_bf16 v[80:95], v[28:31], v[12:15], v[144:159]
    v_exp_f32 v68, v68
    v_exp_f32 v69, v69
    v_exp_f32 v70, v70
    v_exp_f32 v71, v71
    v_exp_f32 v72, v72
    v_exp_f32 v73, v73
    v_smfmac_f32_32x32x32_bf16 v[216:231], v[176:179], v[96:103], v3
    v_exp_f32 v74, v74
    v_exp_f32 v75, v75
    v_exp_f32 v76, v76
    v_exp_f32 v77, v77
    v_exp_f32 v78, v78
    v_exp_f32 v79, v79
    v_smfmac_f32_32x32x32_bf16 v[216:231], v[180:183], v[104:111], v3
    v_exp_f32 v80, v80
    v_exp_f32 v81, v81
    v_exp_f32 v82, v82
    v_exp_f32 v83, v83
    v_exp_f32 v84, v84
    v_exp_f32 v85, v85
    v_smfmac_f32_32x32x32_bf16 v[200:215], v[184:187], v[64:71], v3
    v_exp_f32 v86, v86
    v_exp_f32 v87, v87
    v_exp_f32 v88, v88
    v_exp_f32 v89, v89
    v_exp_f32 v90, v90
    v_exp_f32 v91, v91
    v_smfmac_f32_32x32x32_bf16 v[200:215], v[188:191], v[72:79], v3
    v_exp_f32 v92, v92
    v_exp_f32 v93, v93
    v_exp_f32 v94, v94
    v_exp_f32 v95, v95
    v_smfmac_f32_32x32x32_bf16 v[216:231], v[184:187], v[80:87], v3
    s_nop 1
    v_smfmac_f32_32x32x32_bf16 v[216:231], v[188:191], v[88:95], v3
    s_setprio 3
    s_mov_b32 s70, 0x5f800000
    s_mov_b32 s71, 0x1f800000
    s_mov_b32 s91, 65536
L_ag:
    s_waitcnt vmcnt(0)
    v_or_b32 v232, v6, v7
    v_cmp_gt_i32 vcc, 0, v232
    s_sub_u32 s91, s91, 1
    s_cbranch_scc1 L_agd
    s_cmp_eq_u64 vcc, 0
    s_cbranch_scc1 L_agd
    buffer_load_dword v6, v5, s[28:31], s82 offen sc1
    buffer_load_dword v7, v5, s[28:31], s82 offen offset:128 sc1
    s_branch L_ag
L_agd:
    s_nop 4
    v_max_f32 v232, v208, v224
    v_min_f32 v233, v208, v224
    v_add_f32 v234, v208, v224
    v_cmp_gt_f32 s[72:73], s70, v232
    v_cmp_lt_f32 s[74:75], s71, v233
    v_cmp_o_f32 vcc, v234, v234
    s_nop 1
    s_and_b64 s[72:73], s[72:73], s[74:75]
    s_and_b64 s[72:73], s[72:73], vcc
    s_cmp_eq_u64 s[72:73], -1
    s_cbranch_scc0 L_slow
L_afin:
    v_rcp_f32 v232, v208
    s_nop 0
    v_mul_f32 v232, v232, v6
    v_mul_f32 v200, v200, v232
    v_mul_f32 v201, v201, v232
    v_mul_f32 v202, v202, v232
    v_mul_f32 v203, v203, v232
    v_mul_f32 v204, v204, v232
    v_mul_f32 v205, v205, v232
    v_mul_f32 v206, v206, v232
    v_mul_f32 v207, v207, v232
    v_cvt_pk_bf16_f32 v236, v200, v201
    v_cvt_pk_bf16_f32 v237, v202, v203
    v_cvt_pk_bf16_f32 v238, v204, v205
    v_cvt_pk_bf16_f32 v239, v206, v207
    buffer_store_dwordx4 v[236:239], v4, s[28:31], s83 offen offset:0 sc1
    v_rcp_f32 v232, v224
    s_nop 0
    v_mul_f32 v232, v232, v7
    v_mul_f32 v216, v216, v232
    v_mul_f32 v217, v217, v232
    v_mul_f32 v218, v218, v232
    v_mul_f32 v219, v219, v232
    v_mul_f32 v220, v220, v232
    v_mul_f32 v221, v221, v232
    v_mul_f32 v222, v222, v232
    v_mul_f32 v223, v223, v232
    v_cvt_pk_bf16_f32 v240, v216, v217
    v_cvt_pk_bf16_f32 v241, v218, v219
    v_cvt_pk_bf16_f32 v242, v220, v221
    v_cvt_pk_bf16_f32 v243, v222, v223
    buffer_store_dwordx4 v[240:243], v4, s[28:31], s84 offen offset:0 sc1
    ds_write_b32 v59, v58 offset:96
    s_lshl_b32 s54, s52, 2
    s_and_b32 s59, s53, 3
    s_add_u32 s54, s54, s59
    s_lshr_b32 s55, s53, 2
    s_lshl_b32 s60, s54, 1
    s_lshr_b32 s59, s57, 1
    s_add_u32 s60, s60, s59
    s_xor_b32 s61, s60, 1
    s_lshl_b32 s62, s55, 1
    s_and_b32 s59, s57, 1
    s_add_u32 s62, s62, s59
    s_xor_b32 s63, s62, 1
    s_and_b32 s72, s57, 1
    s_lshl_b32 s73, s72, 14
    s_mul_i32 s59, s60, 90112
    s_add_u32 s59, s59, s73
    s_add_u32 s64, s59, 14680064
    s_mul_i32 s59, s72, 24576
    s_add_u32 s59, s59, 131072
    v_add_u32 v6, s59, v4
    s_lshl_b32 s59, s72, 13
    s_sub_u32 s59, 147456, s59
    v_add_u32 v7, s59, v4
    v_add_u32 v2, 4294895616, v6
    v_add_u32 v3, 4294895616, v7
    s_lshl_b32 s59, s54, 1
    s_add_u32 s59, s59, s72
    s_lshl_b32 s59, s59, 1
    s_lshr_b32 s72, s57, 1
    s_add_u32 s59, s59, s72
    s_lshl_b32 s59, s59, 1
    s_and_b32 s72, s55, 1
    s_add_u32 s59, s59, s72
    s_mul_i32 s59, s59, 256
    s_add_u32 s59, s59, 458752
    v_mov_b32 v8, s59
    s_xor_b32 s59, s57, 0
    s_mul_i32 s59, s59, 6144
    s_add_u32 s59, s59, 106496
    v_add_u32 v10, s59, v4
    s_xor_b32 s59, s57, 1
    s_mul_i32 s59, s59, 6144
    s_add_u32 s59, s59, 106496
    v_add_u32 v11, s59, v4
    s_xor_b32 s59, s57, 0
    s_mul_i32 s59, s59, 14336
    s_add_u32 s59, s59, 2048
    v_add_u32 v12, s59, v4
    v_and_b32 v13, 31, v0
    v_lshlrev_b32 v13, 10, v13
    v_lshrrev_b32 v14, 5, v0
    v_lshl_add_u32 v13, v14, 4, v13
    s_lshl_b32 s76, s60, 15
    s_lshl_b32 s59, s62, 6
    s_add_u32 s76, s76, s59
    s_mov_b32 s44, s22
    s_mov_b32 s45, s23
    s_mov_b32 s46, 2097152
    s_mov_b32 s47, 0x20000
    v_mov_b32 v9, 0
    s_waitcnt vmcnt(0)
    s_mul_i32 s85, s85, 256
    s_add_u32 s85, s85, 23592960
    s_mov_b64 exec, 15
    buffer_atomic_add v58, v63, s[28:31], s85 offen sc1
    s_mov_b64 exec, -1
    s_mov_b32 s91, 65536
    s_mov_b64 exec, 1
    v_mov_b32 v244, 0
    buffer_atomic_add v244, v8, s[28:31], s90 offen sc0 sc1
    s_sleep 4
    v_mov_b32 v245, 0
    buffer_atomic_add v245, v8, s[28:31], s90 offen sc0 sc1
    s_sleep 4
L_po:
    v_mov_b32 v246, 0
    buffer_atomic_add v246, v8, s[28:31], s90 offen sc0 sc1
    s_sleep 3
    s_waitcnt vmcnt(2)
    v_cmp_gt_u32 vcc, 16, v244
    s_sub_u32 s91, s91, 1
    s_cbranch_scc1 L_pod
    s_and_b64 exec, exec, vcc
    s_cbranch_scc0 L_pod
    v_mov_b32 v244, 0
    buffer_atomic_add v244, v8, s[28:31], s90 offen sc0 sc1
    s_sleep 3
    s_waitcnt vmcnt(2)
    v_cmp_gt_u32 vcc, 16, v245
    s_sub_u32 s91, s91, 1
    s_cbranch_scc1 L_pod
    s_and_b64 exec, exec, vcc
    s_cbranch_scc0 L_pod
    v_mov_b32 v245, 0
    buffer_atomic_add v245, v8, s[28:31], s90 offen sc0 sc1
    s_sleep 3
    s_waitcnt vmcnt(2)
    v_cmp_gt_u32 vcc, 16, v246
    s_sub_u32 s91, s91, 1
    s_cbranch_scc1 L_pod
    s_and_b64 exec, exec, vcc
    s_cbranch_scc0 L_pod
    s_branch L_po
L_pod:
    s_mov_b64 exec, -1
    buffer_load_dwordx4 v[144:147], v4, s[28:31], s64 offen offset:0 sc1
    buffer_load_dwordx4 v[148:151], v4, s[28:31], s64 offen offset:1024 sc1
    buffer_load_dwordx4 v[152:155], v4, s[28:31], s64 offen offset:2048 sc1
    buffer_load_dwordx4 v[156:159], v4, s[28:31], s64 offen offset:3072 sc1
    s_add_u32 s64, s64, 4096
    buffer_load_dwordx4 v[160:163], v4, s[28:31], s64 offen offset:0 sc1
    buffer_load_dwordx4 v[164:167], v4, s[28:31], s64 offen offset:1024 sc1
    buffer_load_dwordx4 v[168:171], v4, s[28:31], s64 offen offset:2048 sc1
    buffer_load_dwordx4 v[172:175], v4, s[28:31], s64 offen offset:3072 sc1
    s_add_u32 s64, s64, 4096
    buffer_load_dwordx4 v[176:179], v4, s[28:31], s64 offen offset:0 sc1
    buffer_load_dwordx4 v[180:183], v4, s[28:31], s64 offen offset:1024 sc1
    buffer_load_dwordx4 v[184:187], v4, s[28:31], s64 offen offset:2048 sc1
    buffer_load_dwordx4 v[188:191], v4, s[28:31], s64 offen offset:3072 sc1
    s_add_u32 s64, s64, 4096
    buffer_load_dwordx4 v[192:195], v4, s[28:31], s64 offen offset:0 sc1
    buffer_load_dwordx4 v[196:199], v4, s[28:31], s64 offen offset:1024 sc1
    buffer_load_dwordx4 v[200:203], v4, s[28:31], s64 offen offset:2048 sc1
    buffer_load_dwordx4 v[204:207], v4, s[28:31], s64 offen offset:3072 sc1
    s_add_u32 s64, s64, 4096
    s_mov_b32 s91, 65536
L_adn:
    ds_read_b128 v[240:243], v9 offset:96
    s_waitcnt lgkmcnt(0)
    v_and_b32 v240, v240, v241
    v_and_b32 v242, v242, v243
    v_and_b32 v240, v240, v242
    s_sub_u32 s91, s91, 1
    v_readfirstlane_b32 s3, v240
    s_cbranch_scc1 L_adnd
    s_cmp_lg_u32 s3, 0
    s_cbranch_scc1 L_adnd
    s_sleep 2
    s_branch L_adn
L_adnd:
    s_mov_b32 s91, 65536
L_wol:
    ds_read_b128 v[240:243], v9 offset:128
    s_waitcnt lgkmcnt(0)
    v_and_b32 v240, v240, v241
    v_and_b32 v242, v242, v243
    v_and_b32 v240, v240, v242
    s_sub_u32 s91, s91, 1
    v_readfirstlane_b32 s3, v240
    s_cbranch_scc1 L_wold
    s_cmp_lg_u32 s3, 0
    s_cbranch_scc1 L_wold
    s_sleep 2
    s_branch L_wol
L_wold:
    ds_read_b128 v[16:19], v6 offset:0
    ds_read_b128 v[20:23], v7 offset:0
    ds_read_b128 v[24:27], v6 offset:1024
    ds_read_b128 v[28:31], v7 offset:1024
    ds_read_b128 v[32:35], v6 offset:2048
    ds_read_b128 v[36:39], v7 offset:2048
    ds_read_b128 v[40:43], v6 offset:3072
    ds_read_b128 v[44:47], v7 offset:3072
    ds_read_b128 v[48:51], v6 offset:4096
    ds_read_b128 v[52:55], v7 offset:4096
    ds_read_b128 v[56:59], v6 offset:5120
    ds_read_b128 v[60:63], v7 offset:5120
    ds_read_b128 v[64:67], v6 offset:6144
    ds_read_b128 v[68:71], v7 offset:6144
    s_waitcnt vmcnt(15) lgkmcnt(12)
    v_mfma_f32_32x32x16_bf16 v[224:239], v[20:23], v[144:147], 0
    v_mfma_f32_32x32x16_bf16 v[208:223], v[16:19], v[144:147], 0
    ds_read_b128 v[72:75], v6 offset:7168
    ds_read_b128 v[76:79], v7 offset:7168
    s_waitcnt vmcnt(14) lgkmcnt(12)
    v_mfma_f32_32x32x16_bf16 v[224:239], v[28:31], v[148:151], v[224:239]
    v_mfma_f32_32x32x16_bf16 v[208:223], v[24:27], v[148:151], v[208:223]
    ds_read_b128 v[80:83], v2 offset:0
    ds_read_b128 v[84:87], v3 offset:0
    s_waitcnt vmcnt(13) lgkmcnt(12)
    v_mfma_f32_32x32x16_bf16 v[224:239], v[36:39], v[152:155], v[224:239]
    v_mfma_f32_32x32x16_bf16 v[208:223], v[32:35], v[152:155], v[208:223]
    ds_read_b128 v[88:91], v2 offset:1024
    ds_read_b128 v[92:95], v3 offset:1024
    s_waitcnt vmcnt(12) lgkmcnt(12)
    v_mfma_f32_32x32x16_bf16 v[224:239], v[44:47], v[156:159], v[224:239]
    v_mfma_f32_32x32x16_bf16 v[208:223], v[40:43], v[156:159], v[208:223]
    ds_read_b128 v[96:99], v2 offset:2048
    ds_read_b128 v[100:103], v3 offset:2048
    s_waitcnt vmcnt(11) lgkmcnt(12)
    v_mfma_f32_32x32x16_bf16 v[224:239], v[52:55], v[160:163], v[224:239]
    v_mfma_f32_32x32x16_bf16 v[208:223], v[48:51], v[160:163], v[208:223]
    ds_read_b128 v[104:107], v2 offset:3072
    ds_read_b128 v[108:111], v3 offset:3072
    s_waitcnt vmcnt(10) lgkmcnt(12)
    v_mfma_f32_32x32x16_bf16 v[224:239], v[60:63], v[164:167], v[224:239]
    v_mfma_f32_32x32x16_bf16 v[208:223], v[56:59], v[164:167], v[208:223]
    ds_read_b128 v[112:115], v2 offset:4096
    ds_read_b128 v[116:119], v3 offset:4096
    s_waitcnt vmcnt(9) lgkmcnt(12)
    v_mfma_f32_32x32x16_bf16 v[224:239], v[68:71], v[168:171], v[224:239]
    v_mfma_f32_32x32x16_bf16 v[208:223], v[64:67], v[168:171], v[208:223]
    ds_read_b128 v[120:123], v2 offset:5120
    ds_read_b128 v[124:127], v3 offset:5120
    s_waitcnt vmcnt(8) lgkmcnt(12)
    v_mfma_f32_32x32x16_bf16 v[224:239], v[76:79], v[172:175], v[224:239]
    v_mfma_f32_32x32x16_bf16 v[208:223], v[72:75], v[172:175], v[208:223]
    ds_read_b128 v[128:131], v2 offset:6144
    ds_read_b128 v[132:135], v3 offset:6144
    s_waitcnt vmcnt(7) lgkmcnt(12)
    v_mfma_f32_32x32x16_bf16 v[224:239], v[84:87], v[176:179], v[224:239]
    v_mfma_f32_32x32x16_bf16 v[208:223], v[80:83], v[176:179], v[208:223]
    ds_read_b128 v[136:139], v2 offset:7168
    ds_read_b128 v[140:143], v3 offset:7168
    s_waitcnt vmcnt(6) lgkmcnt(12)
    v_mfma_f32_32x32x16_bf16 v[224:239], v[92:95], v[180:183], v[224:239]
    v_mfma_f32_32x32x16_bf16 v[208:223], v[88:91], v[180:183], v[208:223]
    s_waitcnt vmcnt(5) lgkmcnt(10)
    v_mfma_f32_32x32x16_bf16 v[224:239], v[100:103], v[184:187], v[224:239]
    v_mfma_f32_32x32x16_bf16 v[208:223], v[96:99], v[184:187], v[208:223]
    s_waitcnt vmcnt(4) lgkmcnt(8)
    v_mfma_f32_32x32x16_bf16 v[224:239], v[108:111], v[188:191], v[224:239]
    v_mfma_f32_32x32x16_bf16 v[208:223], v[104:107], v[188:191], v[208:223]
    s_waitcnt vmcnt(3) lgkmcnt(6)
    v_mfma_f32_32x32x16_bf16 v[224:239], v[116:119], v[192:195], v[224:239]
    v_mfma_f32_32x32x16_bf16 v[208:223], v[112:115], v[192:195], v[208:223]
    s_waitcnt vmcnt(2) lgkmcnt(4)
    v_mfma_f32_32x32x16_bf16 v[224:239], v[124:127], v[196:199], v[224:239]
    v_mfma_f32_32x32x16_bf16 v[208:223], v[120:123], v[196:199], v[208:223]
    s_waitcnt vmcnt(1) lgkmcnt(2)
    v_mfma_f32_32x32x16_bf16 v[224:239], v[132:135], v[200:203], v[224:239]
    v_mfma_f32_32x32x16_bf16 v[208:223], v[128:131], v[200:203], v[208:223]
    s_waitcnt vmcnt(0) lgkmcnt(0)
    v_mfma_f32_32x32x16_bf16 v[224:239], v[140:143], v[204:207], v[224:239]
    v_mfma_f32_32x32x16_bf16 v[208:223], v[136:139], v[204:207], v[208:223]
    s_nop 7
    s_nop 2
    ds_write_b128 v11, v[224:227] offset:0
    ds_write_b128 v11, v[228:231] offset:1024
    ds_write_b128 v11, v[232:235] offset:4096
    ds_write_b128 v11, v[236:239] offset:5120
    ds_write_b128 v10, v[216:219] offset:2048
    ds_write_b128 v10, v[220:223] offset:3072
    s_waitcnt lgkmcnt(0)
    s_barrier
    ds_read_b128 v[16:19], v10 offset:0
    ds_read_b128 v[20:23], v10 offset:1024
    ds_read_b128 v[24:27], v12 offset:0
    ds_read_b128 v[28:31], v12 offset:1024
    ds_read_b128 v[32:35], v12 offset:2048
    ds_read_b128 v[36:39], v12 offset:3072
    ds_read_b128 v[40:43], v12 offset:4096
    ds_read_b128 v[44:47], v12 offset:5120
    ds_read_b128 v[48:51], v12 offset:6144
    ds_read_b128 v[52:55], v12 offset:7168
    s_waitcnt lgkmcnt(8)
    v_pk_add_f32 v[208:209], v[208:209], v[16:17]
    v_pk_add_f32 v[210:211], v[210:211], v[18:19]
    v_pk_add_f32 v[212:213], v[212:213], v[20:21]
    v_pk_add_f32 v[214:215], v[214:215], v[22:23]
    s_waitcnt lgkmcnt(6)
    v_pk_add_f32 v[208:209], v[208:209], v[24:25]
    v_pk_add_f32 v[210:211], v[210:211], v[26:27]
    v_pk_add_f32 v[212:213], v[212:213], v[28:29]
    v_pk_add_f32 v[214:215], v[214:215], v[30:31]
    s_waitcnt lgkmcnt(4)
    v_pk_add_f32 v[208:209], v[208:209], v[32:33]
    v_pk_add_f32 v[210:211], v[210:211], v[34:35]
    v_pk_add_f32 v[212:213], v[212:213], v[36:37]
    v_pk_add_f32 v[214:215], v[214:215], v[38:39]
    s_waitcnt lgkmcnt(2)
    v_pk_add_f32 v[208:209], v[208:209], v[40:41]
    v_pk_add_f32 v[210:211], v[210:211], v[42:43]
    v_pk_add_f32 v[212:213], v[212:213], v[44:45]
    v_pk_add_f32 v[214:215], v[214:215], v[46:47]
    s_waitcnt lgkmcnt(0)
    v_pk_add_f32 v[208:209], v[208:209], v[48:49]
    v_pk_add_f32 v[210:211], v[210:211], v[50:51]
    v_pk_add_f32 v[212:213], v[212:213], v[52:53]
    v_pk_add_f32 v[214:215], v[214:215], v[54:55]
    v_cvt_pk_bf16_f32 v16, v208, v209
    v_cvt_pk_bf16_f32 v17, v210, v211
    v_cvt_pk_bf16_f32 v18, v212, v213
    v_cvt_pk_bf16_f32 v19, v214, v215
    s_nop 1
    v_permlane32_swap_b32 v16, v18
    v_permlane32_swap_b32 v17, v19
    buffer_store_dwordx4 v[16:19], v13, s[44:47], s76 offen offset:0
    s_endpgm
L_slow:
    v_mov_b32 v232, 0xff800000
    v_mov_b32 v233, 0xff800000
    s_mov_b32 s81, s79
    s_mov_b32 s69, 64
L_s1:
    buffer_load_dwordx4 v[16:19], v4, s[28:31], s81 offen offset:0 sc1
    s_waitcnt vmcnt(0)
    v_mfma_f32_32x32x16_bf16 v[64:79], v[16:19], v[8:11], 0
    v_mfma_f32_32x32x16_bf16 v[80:95], v[16:19], v[12:15], 0
    s_nop 7
    s_nop 3
    v_max3_f32 v232, v232, v64, v65
    v_max3_f32 v232, v232, v66, v67
    v_max3_f32 v232, v232, v68, v69
    v_max3_f32 v232, v232, v70, v71
    v_max3_f32 v232, v232, v72, v73
    v_max3_f32 v232, v232, v74, v75
    v_max3_f32 v232, v232, v76, v77
    v_max3_f32 v232, v232, v78, v79
    v_max3_f32 v233, v233, v80, v81
    v_max3_f32 v233, v233, v82, v83
    v_max3_f32 v233, v233, v84, v85
    v_max3_f32 v233, v233, v86, v87
    v_max3_f32 v233, v233, v88, v89
    v_max3_f32 v233, v233, v90, v91
    v_max3_f32 v233, v233, v92, v93
    v_max3_f32 v233, v233, v94, v95
    s_add_u32 s81, s81, 2048
    s_sub_u32 s69, s69, 1
    s_cmp_lg_u32 s69, 0
    s_cbranch_scc1 L_s1
    v_mov_b32 v234, v232
    s_nop 1
    v_permlane32_swap_b32 v232, v234
    v_max_f32 v232, v232, v234
    v_mov_b32 v234, v233
    s_nop 1
    v_permlane32_swap_b32 v233, v234
    v_max_f32 v233, v233, v234
    v_mov_b32 v200, 0
    v_mov_b32 v201, 0
    v_mov_b32 v202, 0
    v_mov_b32 v203, 0
    v_mov_b32 v204, 0
    v_mov_b32 v205, 0
    v_mov_b32 v206, 0
    v_mov_b32 v207, 0
    v_mov_b32 v208, 0
    v_mov_b32 v209, 0
    v_mov_b32 v210, 0
    v_mov_b32 v211, 0
    v_mov_b32 v212, 0
    v_mov_b32 v213, 0
    v_mov_b32 v214, 0
    v_mov_b32 v215, 0
    v_mov_b32 v216, 0
    v_mov_b32 v217, 0
    v_mov_b32 v218, 0
    v_mov_b32 v219, 0
    v_mov_b32 v220, 0
    v_mov_b32 v221, 0
    v_mov_b32 v222, 0
    v_mov_b32 v223, 0
    v_mov_b32 v224, 0
    v_mov_b32 v225, 0
    v_mov_b32 v226, 0
    v_mov_b32 v227, 0
    v_mov_b32 v228, 0
    v_mov_b32 v229, 0
    v_mov_b32 v230, 0
    v_mov_b32 v231, 0
    s_mov_b32 s81, s79
    s_mov_b32 s69, 64
L_s2:
    buffer_load_dwordx4 v[16:19], v4, s[28:31], s81 offen offset:0 sc1
    s_mov_b64 exec, s[86:87]
    buffer_load_dwordx4 v[160:163], v2, s[28:31], s81 offen offset:0 sc1
    buffer_load_dwordx4 v[164:167], v2, s[28:31], s81 offen offset:512 sc1
    s_mov_b64 exec, -1
    s_waitcnt vmcnt(0)
    v_mfma_f32_32x32x16_bf16 v[64:79], v[16:19], v[8:11], 0
    v_mfma_f32_32x32x16_bf16 v[80:95], v[16:19], v[12:15], 0
    s_nop 7
    s_nop 3
    v_sub_f32 v64, v64, v232
    v_sub_f32 v65, v65, v232
    v_sub_f32 v66, v66, v232
    v_sub_f32 v67, v67, v232
    v_sub_f32 v68, v68, v232
    v_sub_f32 v69, v69, v232
    v_sub_f32 v70, v70, v232
    v_sub_f32 v71, v71, v232
    v_sub_f32 v72, v72, v232
    v_sub_f32 v73, v73, v232
    v_sub_f32 v74, v74, v232
    v_sub_f32 v75, v75, v232
    v_sub_f32 v76, v76, v232
    v_sub_f32 v77, v77, v232
    v_sub_f32 v78, v78, v232
    v_sub_f32 v79, v79, v232
    v_exp_f32 v64, v64
    v_exp_f32 v65, v65
    v_exp_f32 v66, v66
    v_exp_f32 v67, v67
    v_exp_f32 v68, v68
    v_exp_f32 v69, v69
    v_exp_f32 v70, v70
    v_exp_f32 v71, v71
    v_exp_f32 v72, v72
    v_exp_f32 v73, v73
    v_exp_f32 v74, v74
    v_exp_f32 v75, v75
    v_exp_f32 v76, v76
    v_exp_f32 v77, v77
    v_exp_f32 v78, v78
    v_exp_f32 v79, v79
    v_sub_f32 v80, v80, v233
    v_sub_f32 v81, v81, v233
    v_sub_f32 v82, v82, v233
    v_sub_f32 v83, v83, v233
    v_sub_f32 v84, v84, v233
    v_sub_f32 v85, v85, v233
    v_sub_f32 v86, v86, v233
    v_sub_f32 v87, v87, v233
    v_sub_f32 v88, v88, v233
    v_sub_f32 v89, v89, v233
    v_sub_f32 v90, v90, v233
    v_sub_f32 v91, v91, v233
    v_sub_f32 v92, v92, v233
    v_sub_f32 v93, v93, v233
    v_sub_f32 v94, v94, v233
    v_sub_f32 v95, v95, v233
    v_exp_f32 v80, v80
    v_exp_f32 v81, v81
    v_exp_f32 v82, v82
    v_exp_f32 v83, v83
    v_exp_f32 v84, v84
    v_exp_f32 v85, v85
    v_exp_f32 v86, v86
    v_exp_f32 v87, v87
    v_exp_f32 v88, v88
    v_exp_f32 v89, v89
    v_exp_f32 v90, v90
    v_exp_f32 v91, v91
    v_exp_f32 v92, v92
    v_exp_f32 v93, v93
    v_exp_f32 v94, v94
    v_exp_f32 v95, v95
    s_nop 1
    v_smfmac_f32_32x32x32_bf16 v[200:215], v[160:163], v[64:71], v3
    v_smfmac_f32_32x32x32_bf16 v[200:215], v[164:167], v[72:79], v3
    v_smfmac_f32_32x32x32_bf16 v[216:231], v[160:163], v[80:87], v3
    v_smfmac_f32_32x32x32_bf16 v[216:231], v[164:167], v[88:95], v3
    s_add_u32 s81, s81, 2048
    s_sub_u32 s69, s69, 1
    s_cmp_lg_u32 s69, 0
    s_cbranch_scc1 L_s2
    s_nop 7
    s_nop 3
    s_branch L_afin
L_clear:
    v_mov_b32 v12, -1
    v_mov_b32 v13, -1
    v_mov_b32 v14, -1
    v_mov_b32 v15, -1
    v_mov_b32 v16, 0
    v_mul_u32_u24 v17, 256, v0
    v_lshlrev_b32 v18, 3, v0
    s_mul_i32 s59, s54, 16384
    s_add_u32 s59, s59, 23592960
    buffer_store_dword v16, v17, s[28:31], s59 offen sc1
    s_add_u32 s59, s59, 262144
    buffer_store_dword v16, v17, s[28:31], s59 offen sc1
    s_lshl_b32 s59, s54, 9
    s_add_u32 s59, s59, 23068672
    buffer_store_dwordx2 v[12:13], v18, s[28:31], s59 offen sc1
    s_mul_i32 s59, s54, 14336
    s_add_u32 s59, s59, 23134208
    buffer_store_dwordx4 v[12:15], v9, s[28:31], s59 offen offset:0 sc1
    buffer_store_dwordx4 v[12:15], v9, s[28:31], s59 offen offset:1024 sc1
    buffer_store_dwordx4 v[12:15], v9, s[28:31], s59 offen offset:2048 sc1
    buffer_store_dwordx4 v[12:15], v9, s[28:31], s59 offen offset:3072 sc1
    s_add_u32 s59, s59, 4096
    buffer_store_dwordx4 v[12:15], v9, s[28:31], s59 offen offset:0 sc1
    buffer_store_dwordx4 v[12:15], v9, s[28:31], s59 offen offset:1024 sc1
    buffer_store_dwordx4 v[12:15], v9, s[28:31], s59 offen offset:2048 sc1
    buffer_store_dwordx4 v[12:15], v9, s[28:31], s59 offen offset:3072 sc1
    s_add_u32 s59, s59, 4096
    buffer_store_dwordx4 v[12:15], v9, s[28:31], s59 offen offset:0 sc1
    buffer_store_dwordx4 v[12:15], v9, s[28:31], s59 offen offset:1024 sc1
    buffer_store_dwordx4 v[12:15], v9, s[28:31], s59 offen offset:2048 sc1
    buffer_store_dwordx4 v[12:15], v9, s[28:31], s59 offen offset:3072 sc1
    s_add_u32 s59, s59, 4096
    buffer_store_dwordx4 v[12:15], v9, s[28:31], s59 offen offset:0 sc1
    buffer_store_dwordx4 v[12:15], v9, s[28:31], s59 offen offset:1024 sc1
    v_mov_b32 v17, 1
    s_lshl_b32 s59, s54, 2
    s_waitcnt vmcnt(0)
    s_mov_b64 exec, 1
    buffer_store_dword v17, v16, s[32:35], s59 offen sc1
    s_mov_b64 exec, -1
    s_branch L_noclr
L_end:
    s_endpgm
.section .rodata,"a"
.p2align 6
.amdhsa_kernel gated_mix__softmax_full_mha__mixer_gmlp__prompt_kernel
  .amdhsa_next_free_vgpr 256
  .amdhsa_next_free_sgpr 102
  .amdhsa_accum_offset 256
  .amdhsa_group_segment_fixed_size 0
  .amdhsa_kernarg_size 96
  .amdhsa_user_sgpr_count 2
  .amdhsa_user_sgpr_kernarg_segment_ptr 1
  .amdhsa_system_sgpr_workgroup_id_x 1
  .amdhsa_float_denorm_mode_32 3
.end_amdhsa_kernel
```
